```python
import torch

def _softmax(x, axis=-1):
    return torch.softmax(x, dim=axis)
def _gelu(x):
    return torch.nn.functional.gelu(x, approximate="tanh")
def _silu(x):
    return torch.nn.functional.silu(x)
def _sigmoid(x):
    return torch.sigmoid(x)
def _layernorm(x, axis=-1, eps=1e-5):
    m = x.mean(dim=axis, keepdim=True)
    v = x.var(dim=axis, keepdim=True, unbiased=False)
    return (x - m) / torch.sqrt(v + eps)
def _scatter_add(tgt, idx, src, axis=0):
    return tgt.clone().index_add_(axis, idx, src)
def _segment_sum(src, seg, n):
    out = torch.zeros((n,) + src.shape[1:], dtype=src.dtype)
    return out.index_add_(0, seg, src)
def _pad(x, pw):
    flat = tuple(v for pair in reversed(pw) for v in pair)
    return torch.nn.functional.pad(x, flat)

kernel_name = 'interleave_layers__spectral_fnet__dense_activation_relu__prompt'

def setup_inputs():

    _w = (lambda a: (lambda t: t.to(torch.bfloat16) if t.is_floating_point() else t)(torch.as_tensor(a)))
    def _A_setup():
        B, S, D = 1, 2048, 640
        ns = torch.arange(S)[:, None] * torch.arange(S)[None, :]
        nd = torch.arange(D)[:, None] * torch.arange(D)[None, :]
        Ws_re = torch.cos(-2.0 * torch.pi * ns / S).to(float)
        Ws_im = torch.sin(-2.0 * torch.pi * ns / S).to(float)
        Wd_re = torch.cos(-2.0 * torch.pi * nd / D).to(float)
        Wd_im = torch.sin(-2.0 * torch.pi * nd / D).to(float)
        return {
            "x": _w((lambda *s: torch.randn(*s, dtype=torch.bfloat16) * 0.05)(B, S, D)),
            "dft_seq_re": _w(Ws_re),
            "dft_seq_im": _w(Ws_im),
            "dft_hid_re": _w(Wd_re),
            "dft_hid_im": _w(Wd_im),
        }
    _A_in = _A_setup()

    def _B_setup():
        B, S, D, Dff = 1, 2048, 640, 1536
        return {
            "x": _w((lambda *s: torch.randn(*s, dtype=torch.bfloat16) * 0.05)(B, S, D)),
            "w1": _w((lambda *s: torch.randn(*s, dtype=torch.bfloat16) * 1.6)(D, Dff)),
            "w2": _w((lambda *s: torch.randn(*s, dtype=torch.bfloat16) * 1.6)(Dff, D)),
        }
    _B_in = _B_setup()

    return {
        "A_x": _A_in["x"],
        "A_dft_seq_re": _A_in["dft_seq_re"],
        "A_dft_seq_im": _A_in["dft_seq_im"],
        "A_dft_hid_re": _A_in["dft_hid_re"],
        "A_dft_hid_im": _A_in["dft_hid_im"],
        "B_x": _B_in["x"],
        "B_w1": _B_in["w1"],
        "B_w2": _B_in["w2"],
    }

def reference(A_x, A_dft_seq_re, A_dft_seq_im, A_dft_hid_re, A_dft_hid_im, B_x, B_w1, B_w2):
    def _A_ref(x, dft_seq_re, dft_seq_im, dft_hid_re, dft_hid_im):
        a = torch.einsum("bsd,ed->bse", x, dft_hid_re)
        b = torch.einsum("bsd,ed->bse", x, dft_hid_im)
        y = torch.einsum("ts,bse->bte", dft_seq_re, a) - torch.einsum("ts,bse->bte", dft_seq_im, b)
        return y

    def _B_ref(x, w1, w2):
        h = torch.einsum("bsd,df->bsf", x, w1)
        zero = torch.zeros_like(h)
        h = torch.maximum(h, zero)
        return torch.einsum("bsf,fd->bsd", h, w2)

    x = A_x
    x = x + _A_ref(_layernorm(x, axis=-1), A_dft_seq_re, A_dft_seq_im, A_dft_hid_re, A_dft_hid_im)
    x = x + _B_ref(_layernorm(x, axis=-1), B_w1, B_w2)
    x = x + _A_ref(_layernorm(x, axis=-1), A_dft_seq_re, A_dft_seq_im, A_dft_hid_re, A_dft_hid_im)
    x = x + _B_ref(_layernorm(x, axis=-1), B_w1, B_w2)
    return x
```

```asm
; @launch kernel=ka_kernel grid=(256,1,1) block=(640,1,1) lds=34816
; @launch kernel=kp_kernel grid=(256,1,1) block=(256,1,1) lds=163840
.amdgcn_target "amdgcn-amd-amdhsa--gfx950"
.text
.p2align 8
code_start:
.globl ka_kernel
.p2align 8
.type ka_kernel,@function
ka_kernel:
    s_cmp_ge_u32 s2, 256
    s_cbranch_scc1 done_ka_kernel_1
    s_load_dwordx2 s[8:9], s[0:1], 0
    s_load_dwordx4 s[36:39], s[0:1], 48
    s_load_dwordx2 s[4:5], s[0:1], 80
    s_getpc_b64 s[16:17]
pc_ka_kernel_3:
    s_add_u32 s16, s16, tbl-pc_ka_kernel_3
    s_addc_u32 s17, s17, 0
    s_mov_b32 s18, 24576
    s_mov_b32 s19, 0x20000
    s_bfe_u32 s21, s2, 0x30003
    s_lshr_b32 s3, s2, 6
    s_bfe_u32 s24, s2, 0x30000
    s_lshl_b32 s22, s24, 2
    s_add_u32 s22, s22, s3
    s_lshr_b32 s25, s22, 1
    s_sub_u32 s26, 32, s25
    s_cmp_eq_u32 s25, 0
    s_cselect_b32 s26, 16, s26
    s_bitcmp1_b32 s3, 0
    s_cselect_b32 s23, s26, s25
    v_lshrrev_b32 v1, 6, v0
    v_and_b32 v0, 63, v0
    v_readfirstlane_b32 s20, v1
    s_mov_b32 s10, 2621440
    s_mov_b32 s11, 0x20000
    s_mov_b32 s6, 0x10000000
    s_mov_b32 s7, 0x20000
    s_sub_u32 s27, s20, 8
    s_cmp_lt_u32 s27, 2
    s_cbranch_scc1 prep_ka_kernel_2
    s_add_u32 s20, s20, s21
    s_and_b32 s20, s20, 7
    v_lshrrev_b32 v2, 4, v0
    v_mul_u32_u24 v2, 81920, v2
    v_and_b32 v3, 15, v0
    v_lshl_add_u32 v2, v3, 4, v2
    v_lshlrev_b32 v4, 4, v0
    s_lshr_b32 s27, s20, 2
    s_and_b32 s28, s20, 3
    s_lshl_b32 s24, s27, 5
    s_lshl_b32 s25, s28, 9
    s_add_u32 s24, s24, s25
    s_add_u32 s24, s24, s23
    s_mul_i32 s24, s24, 1280
    s_add_u32 s25, s24, 327680
    s_mul_i32 s26, s21, 160
    s_add_u32 s34, s24, s26
    s_add_u32 s35, s25, s26
    s_lshl_b32 s29, s28, 11
    s_waitcnt lgkmcnt(0)
    buffer_load_dwordx4 v[8:11], v2, s[8:11], s24 offen offset:0
    buffer_load_dwordx4 v[12:15], v2, s[8:11], s24 offen offset:256
    buffer_load_dwordx4 v[16:19], v2, s[8:11], s24 offen offset:512
    buffer_load_dwordx4 v[20:23], v2, s[8:11], s24 offen offset:768
    buffer_load_dwordx4 v[24:27], v2, s[8:11], s24 offen offset:1024
    buffer_load_dwordx4 v[28:31], v2, s[8:11], s25 offen offset:0
    buffer_load_dwordx4 v[32:35], v2, s[8:11], s25 offen offset:256
    buffer_load_dwordx4 v[36:39], v2, s[8:11], s25 offen offset:512
    buffer_load_dwordx4 v[40:43], v2, s[8:11], s25 offen offset:768
    buffer_load_dwordx4 v[44:47], v2, s[8:11], s25 offen offset:1024
    buffer_load_dwordx4 v[48:51], v2, s[8:11], s34 offen
    buffer_load_dwordx4 v[52:55], v2, s[8:11], s35 offen
    buffer_load_dwordx4 v[56:59], v4, s[16:19], s29 offen offset:0
    buffer_load_dwordx4 v[60:63], v4, s[16:19], s29 offen offset:1024
    v_lshrrev_b32 v64, 2, v0
    v_mul_u32_u24 v64, 160, v64
    v_and_b32 v65, 1, v0
    v_lshl_add_u32 v65, v65, 3, v64
    v_bfe_u32 v66, v0, 1, 1
    v_mul_u32_u24 v66, 80, v66
    v_add3_u32 v65, v65, v66, 64
    v_and_b32 v66, 3, v0
    v_lshl_add_u32 v64, v66, 3, v64
    v_bfe_u32 v66, v0, 1, 3
    v_mul_u32_u24 v66, 81920, v66
    v_and_b32 v67, 1, v0
    v_lshl_add_u32 v66, v67, 4, v66
    v_bfe_u32 v68, v0, 4, 1
    v_lshl_add_u32 v67, v68, 5, v66
    v_lshrrev_b32 v68, 5, v0
    v_lshl_add_u32 v67, v68, 3, v67
    v_lshrrev_b32 v68, 4, v0
    v_lshl_add_u32 v66, v68, 5, v66
    s_mul_i32 s30, s28, 655360
    s_add_u32 s30, s30, 0
    s_lshl_b32 s31, s23, 3
    s_add_u32 s31, s31, s21
    s_lshl_b32 s31, s31, 6
    s_add_u32 s32, s30, s31
    s_add_u32 s30, s32, s31
    s_add_u32 s32, s32, 65536
    s_lshl_b32 s31, s27, 5
    v_add_u32 v64, s31, v64
    s_lshl_b32 s31, s27, 15
    s_add_u32 s30, s30, s31
    s_mul_i32 s26, s20, 1280
    v_lshrrev_b32 v5, 4, v0
    v_mul_u32_u24 v5, 160, v5
    v_lshl_add_u32 v5, v3, 4, v5
    v_add_u32 v5, s26, v5
    v_mov_b32 v6, 0x3f803f80
    v_mov_b32 v84, 0
    v_mov_b32 v85, 0
    v_mov_b32 v86, 0
    v_mov_b32 v87, 0
    s_waitcnt vmcnt(13)
    v_dot2c_f32_bf16 v84, v8, v6
    v_dot2c_f32_bf16 v85, v8, v8
    v_dot2c_f32_bf16 v84, v9, v6
    v_dot2c_f32_bf16 v85, v9, v9
    v_dot2c_f32_bf16 v84, v10, v6
    v_dot2c_f32_bf16 v85, v10, v10
    v_dot2c_f32_bf16 v84, v11, v6
    v_dot2c_f32_bf16 v85, v11, v11
    s_waitcnt vmcnt(12)
    v_dot2c_f32_bf16 v84, v12, v6
    v_dot2c_f32_bf16 v85, v12, v12
    v_dot2c_f32_bf16 v84, v13, v6
    v_dot2c_f32_bf16 v85, v13, v13
    v_dot2c_f32_bf16 v84, v14, v6
    v_dot2c_f32_bf16 v85, v14, v14
    v_dot2c_f32_bf16 v84, v15, v6
    v_dot2c_f32_bf16 v85, v15, v15
    s_waitcnt vmcnt(11)
    v_dot2c_f32_bf16 v84, v16, v6
    v_dot2c_f32_bf16 v85, v16, v16
    v_dot2c_f32_bf16 v84, v17, v6
    v_dot2c_f32_bf16 v85, v17, v17
    v_dot2c_f32_bf16 v84, v18, v6
    v_dot2c_f32_bf16 v85, v18, v18
    v_dot2c_f32_bf16 v84, v19, v6
    v_dot2c_f32_bf16 v85, v19, v19
    s_waitcnt vmcnt(10)
    v_dot2c_f32_bf16 v84, v20, v6
    v_dot2c_f32_bf16 v85, v20, v20
    v_dot2c_f32_bf16 v84, v21, v6
    v_dot2c_f32_bf16 v85, v21, v21
    v_dot2c_f32_bf16 v84, v22, v6
    v_dot2c_f32_bf16 v85, v22, v22
    v_dot2c_f32_bf16 v84, v23, v6
    v_dot2c_f32_bf16 v85, v23, v23
    s_waitcnt vmcnt(9)
    v_dot2c_f32_bf16 v84, v24, v6
    v_dot2c_f32_bf16 v85, v24, v24
    v_dot2c_f32_bf16 v84, v25, v6
    v_dot2c_f32_bf16 v85, v25, v25
    v_dot2c_f32_bf16 v84, v26, v6
    v_dot2c_f32_bf16 v85, v26, v26
    v_dot2c_f32_bf16 v84, v27, v6
    v_dot2c_f32_bf16 v85, v27, v27
    s_waitcnt vmcnt(8)
    v_dot2c_f32_bf16 v86, v28, v6
    v_dot2c_f32_bf16 v87, v28, v28
    v_dot2c_f32_bf16 v86, v29, v6
    v_dot2c_f32_bf16 v87, v29, v29
    v_dot2c_f32_bf16 v86, v30, v6
    v_dot2c_f32_bf16 v87, v30, v30
    v_dot2c_f32_bf16 v86, v31, v6
    v_dot2c_f32_bf16 v87, v31, v31
    s_waitcnt vmcnt(7)
    v_dot2c_f32_bf16 v86, v32, v6
    v_dot2c_f32_bf16 v87, v32, v32
    v_dot2c_f32_bf16 v86, v33, v6
    v_dot2c_f32_bf16 v87, v33, v33
    v_dot2c_f32_bf16 v86, v34, v6
    v_dot2c_f32_bf16 v87, v34, v34
    v_dot2c_f32_bf16 v86, v35, v6
    v_dot2c_f32_bf16 v87, v35, v35
    s_waitcnt vmcnt(6)
    v_dot2c_f32_bf16 v86, v36, v6
    v_dot2c_f32_bf16 v87, v36, v36
    v_dot2c_f32_bf16 v86, v37, v6
    v_dot2c_f32_bf16 v87, v37, v37
    v_dot2c_f32_bf16 v86, v38, v6
    v_dot2c_f32_bf16 v87, v38, v38
    v_dot2c_f32_bf16 v86, v39, v6
    v_dot2c_f32_bf16 v87, v39, v39
    s_waitcnt vmcnt(5)
    v_dot2c_f32_bf16 v86, v40, v6
    v_dot2c_f32_bf16 v87, v40, v40
    v_dot2c_f32_bf16 v86, v41, v6
    v_dot2c_f32_bf16 v87, v41, v41
    v_dot2c_f32_bf16 v86, v42, v6
    v_dot2c_f32_bf16 v87, v42, v42
    v_dot2c_f32_bf16 v86, v43, v6
    v_dot2c_f32_bf16 v87, v43, v43
    s_waitcnt vmcnt(4)
    v_dot2c_f32_bf16 v86, v44, v6
    v_dot2c_f32_bf16 v87, v44, v44
    v_dot2c_f32_bf16 v86, v45, v6
    v_dot2c_f32_bf16 v87, v45, v45
    v_dot2c_f32_bf16 v86, v46, v6
    v_dot2c_f32_bf16 v87, v46, v46
    v_dot2c_f32_bf16 v86, v47, v6
    v_dot2c_f32_bf16 v87, v47, v47
    v_add_f32_dpp v84, v84, v84 quad_perm:[1,0,3,2] row_mask:0xf bank_mask:0xf
    v_add_f32_dpp v85, v85, v85 quad_perm:[1,0,3,2] row_mask:0xf bank_mask:0xf
    v_add_f32_dpp v86, v86, v86 quad_perm:[1,0,3,2] row_mask:0xf bank_mask:0xf
    v_add_f32_dpp v87, v87, v87 quad_perm:[1,0,3,2] row_mask:0xf bank_mask:0xf
    v_add_f32_dpp v84, v84, v84 quad_perm:[2,3,0,1] row_mask:0xf bank_mask:0xf
    v_add_f32_dpp v85, v85, v85 quad_perm:[2,3,0,1] row_mask:0xf bank_mask:0xf
    v_add_f32_dpp v86, v86, v86 quad_perm:[2,3,0,1] row_mask:0xf bank_mask:0xf
    v_add_f32_dpp v87, v87, v87 quad_perm:[2,3,0,1] row_mask:0xf bank_mask:0xf
    v_add_f32_dpp v84, v84, v84 row_half_mirror row_mask:0xf bank_mask:0xf
    v_add_f32_dpp v85, v85, v85 row_half_mirror row_mask:0xf bank_mask:0xf
    v_add_f32_dpp v86, v86, v86 row_half_mirror row_mask:0xf bank_mask:0xf
    v_add_f32_dpp v87, v87, v87 row_half_mirror row_mask:0xf bank_mask:0xf
    v_add_f32_dpp v84, v84, v84 row_mirror row_mask:0xf bank_mask:0xf
    v_add_f32_dpp v85, v85, v85 row_mirror row_mask:0xf bank_mask:0xf
    v_add_f32_dpp v86, v86, v86 row_mirror row_mask:0xf bank_mask:0xf
    v_add_f32_dpp v87, v87, v87 row_mirror row_mask:0xf bank_mask:0xf
    v_mul_f32 v84, 0x3acccccd, v84
    v_mul_f32 v85, 0x3acccccd, v85
    v_fma_f32 v85, -v84, v84, v85
    v_max_f32 v85, 0, v85
    v_add_f32 v85, 0x3727c5ac, v85
    v_rsq_f32 v85, v85
    v_mul_f32 v86, 0x3acccccd, v86
    v_mul_f32 v87, 0x3acccccd, v87
    v_fma_f32 v87, -v86, v86, v87
    v_max_f32 v87, 0, v87
    v_add_f32 v87, 0x3727c5ac, v87
    v_rsq_f32 v87, v87
    v_mul_f32 v84, v84, v85
    v_mul_f32 v86, v86, v87
    s_waitcnt vmcnt(2)
    v_lshlrev_b32 v8, 16, v48
    v_and_b32 v9, 0xffff0000, v48
    v_lshlrev_b32 v10, 16, v49
    v_and_b32 v11, 0xffff0000, v49
    v_lshlrev_b32 v12, 16, v50
    v_and_b32 v13, 0xffff0000, v50
    v_lshlrev_b32 v14, 16, v51
    v_and_b32 v15, 0xffff0000, v51
    v_pk_fma_f32 v[8:9], v[8:9], v[84:85], v[84:85] op_sel:[0,1,0] op_sel_hi:[1,1,0] neg_lo:[0,0,1] neg_hi:[0,0,1]
    v_pk_fma_f32 v[10:11], v[10:11], v[84:85], v[84:85] op_sel:[0,1,0] op_sel_hi:[1,1,0] neg_lo:[0,0,1] neg_hi:[0,0,1]
    v_pk_fma_f32 v[12:13], v[12:13], v[84:85], v[84:85] op_sel:[0,1,0] op_sel_hi:[1,1,0] neg_lo:[0,0,1] neg_hi:[0,0,1]
    v_pk_fma_f32 v[14:15], v[14:15], v[84:85], v[84:85] op_sel:[0,1,0] op_sel_hi:[1,1,0] neg_lo:[0,0,1] neg_hi:[0,0,1]
    v_cvt_pk_f16_f32 v48, v8, v9
    v_cvt_pk_f16_f32 v49, v10, v11
    v_cvt_pk_f16_f32 v50, v12, v13
    v_cvt_pk_f16_f32 v51, v14, v15
    v_lshlrev_b32 v16, 16, v52
    v_and_b32 v17, 0xffff0000, v52
    v_lshlrev_b32 v18, 16, v53
    v_and_b32 v19, 0xffff0000, v53
    v_lshlrev_b32 v20, 16, v54
    v_and_b32 v21, 0xffff0000, v54
    v_lshlrev_b32 v22, 16, v55
    v_and_b32 v23, 0xffff0000, v55
    v_pk_fma_f32 v[16:17], v[16:17], v[86:87], v[86:87] op_sel:[0,1,0] op_sel_hi:[1,1,0] neg_lo:[0,0,1] neg_hi:[0,0,1]
    v_pk_fma_f32 v[18:19], v[18:19], v[86:87], v[86:87] op_sel:[0,1,0] op_sel_hi:[1,1,0] neg_lo:[0,0,1] neg_hi:[0,0,1]
    v_pk_fma_f32 v[20:21], v[20:21], v[86:87], v[86:87] op_sel:[0,1,0] op_sel_hi:[1,1,0] neg_lo:[0,0,1] neg_hi:[0,0,1]
    v_pk_fma_f32 v[22:23], v[22:23], v[86:87], v[86:87] op_sel:[0,1,0] op_sel_hi:[1,1,0] neg_lo:[0,0,1] neg_hi:[0,0,1]
    v_cvt_pk_f16_f32 v52, v16, v17
    v_cvt_pk_f16_f32 v53, v18, v19
    v_cvt_pk_f16_f32 v54, v20, v21
    v_cvt_pk_f16_f32 v55, v22, v23
    v_cmp_gt_u32 vcc, 10, v3
    s_nop 0
    s_and_saveexec_b64 s[40:41], vcc
    ds_write_b128 v5, v[48:51] offset:0
    ds_write_b128 v5, v[52:55] offset:640
    s_mov_b64 exec, s[40:41]
    s_waitcnt vmcnt(0)
    s_waitcnt lgkmcnt(0)
    s_barrier
    ds_read_b64_tr_b16 v[68:69], v64 offset:0
    ds_read_b64_tr_b16 v[70:71], v64 offset:2560
    ds_read_b64_tr_b16 v[72:73], v64 offset:5120
    ds_read_b64_tr_b16 v[74:75], v64 offset:7680
    ds_read_b64_tr_b16 v[76:77], v64 offset:80
    ds_read_b64_tr_b16 v[78:79], v64 offset:2640
    ds_read_b64_tr_b16 v[80:81], v64 offset:5200
    ds_read_b64_tr_b16 v[82:83], v64 offset:7760
    s_waitcnt lgkmcnt(6)
    v_mfma_f32_16x16x32_f16 v[84:87], v[68:71], v[56:59], 0
    s_waitcnt lgkmcnt(4)
    v_mfma_f32_16x16x32_f16 v[84:87], v[72:75], v[60:63], v[84:87]
    s_waitcnt lgkmcnt(2)
    v_mfma_f32_16x16x32_f16 v[88:91], v[76:79], v[56:59], 0
    s_waitcnt lgkmcnt(0)
    v_mfma_f32_16x16x32_f16 v[88:91], v[80:83], v[60:63], v[88:91]
    s_nop 3
    v_cvt_pk_f16_f32 v92, v84, v85
    v_cvt_pk_f16_f32 v93, v86, v87
    s_nop 1
    v_cvt_pk_f16_f32 v94, v88, v89
    v_cvt_pk_f16_f32 v95, v90, v91
    buffer_store_dwordx4 v[92:95], v66, s[4:7], s30 offen
    s_cmp_eq_u32 s27, 0
    s_cbranch_scc1 sk_ka_kernel_4
    ds_read_b64_tr_b16 v[68:69], v65 offset:0
    ds_read_b64_tr_b16 v[70:71], v65 offset:2560
    ds_read_b64_tr_b16 v[72:73], v65 offset:5120
    ds_read_b64_tr_b16 v[74:75], v65 offset:7680
    s_waitcnt lgkmcnt(2)
    v_mfma_f32_16x16x32_f16 v[84:87], v[68:71], v[56:59], 0
    s_waitcnt lgkmcnt(0)
    v_mfma_f32_16x16x32_f16 v[84:87], v[72:75], v[60:63], v[84:87]
    s_nop 7
    v_cvt_pk_f16_f32 v96, v84, v85
    v_cvt_pk_f16_f32 v97, v86, v87
    buffer_store_dwordx2 v[96:97], v67, s[4:7], s32 offen
sk_ka_kernel_4:
    s_endpgm
prep_ka_kernel_2:
    s_sub_u32 s27, s20, 8
    s_lshl_b32 s24, s27, 8
    s_add_u32 s24, s24, s2
    s_mul_i32 s40, s27, 12288
    s_add_u32 s40, s40, 10240
    v_lshrrev_b32 v2, 3, v0
    v_bfe_u32 v3, v0, 4, 2
    v_lshlrev_b32 v3, 1, v3
    v_and_b32 v4, 7, v0
    v_xor_b32 v3, v3, v4
    v_lshlrev_b32 v3, 4, v3
    v_lshlrev_b32 v9, 4, v0
    v_and_b32 v10, 3, v0
    v_lshlrev_b32 v10, 3, v10
    v_add_u32 v10, s40, v10
    s_getpc_b64 s[44:45]
pc2_ka_kernel_8:
    s_sub_u32 s44, s44, pc2_ka_kernel_8-code_start
    s_subb_u32 s45, s45, 0
    s_mov_b32 s46, code_end-code_start
    s_mov_b32 s47, 0x20000
    s_lshr_b32 s25, s2, 3
    s_lshl_b32 s26, s27, 5
    s_add_u32 s25, s25, s26
    s_lshl_b32 s43, s25, 10
    buffer_load_dwordx4 v[100:103], v9, s[44:47], s43 offen
    s_waitcnt lgkmcnt(0)
    s_mov_b32 s48, s38
    s_mov_b32 s49, s39
    s_mov_b32 s38, 1966080
    s_mov_b32 s39, 0x20000
    s_mov_b32 s50, 1966080
    s_mov_b32 s51, 0x20000
    s_cmp_ge_u32 s24, 400
    s_cbranch_scc1 nou_ka_kernel_6
    s_cmp_ge_u32 s24, 240
    s_cbranch_scc1 w2p_ka_kernel_5
    s_mul_i32 s25, s24, 2731
    s_lshr_b32 s25, s25, 16
    s_mul_i32 s26, s25, 24
    s_sub_u32 s26, s24, s26
    s_mul_i32 s28, s25, 196608
    s_lshl_b32 s29, s26, 7
    s_add_u32 s28, s28, s29
    v_mul_u32_u24 v2, 3072, v2
    v_add_u32 v2, v2, v3
    s_mov_b32 m0, s40
    s_nop 0
    buffer_load_dwordx4 v2, s[36:39], s28 offen lds
    s_add_u32 s28, s28, 24576
    s_add_u32 m0, m0, 1024
    s_nop 0
    buffer_load_dwordx4 v2, s[36:39], s28 offen lds
    s_add_u32 s28, s28, 24576
    s_add_u32 m0, m0, 1024
    s_nop 0
    buffer_load_dwordx4 v2, s[36:39], s28 offen lds
    s_add_u32 s28, s28, 24576
    s_add_u32 m0, m0, 1024
    s_nop 0
    buffer_load_dwordx4 v2, s[36:39], s28 offen lds
    s_add_u32 s28, s28, 24576
    s_add_u32 m0, m0, 1024
    s_nop 0
    buffer_load_dwordx4 v2, s[36:39], s28 offen lds
    s_add_u32 s28, s28, 24576
    s_add_u32 m0, m0, 1024
    s_nop 0
    buffer_load_dwordx4 v2, s[36:39], s28 offen lds
    s_add_u32 s28, s28, 24576
    s_add_u32 m0, m0, 1024
    s_nop 0
    buffer_load_dwordx4 v2, s[36:39], s28 offen lds
    s_add_u32 s28, s28, 24576
    s_add_u32 m0, m0, 1024
    s_nop 0
    buffer_load_dwordx4 v2, s[36:39], s28 offen lds
    s_lshl_b32 s28, s22, 3
    s_add_u32 s28, s28, s21
    s_cmp_eq_u32 s27, 0
    s_cbranch_scc0 z_ka_kernel_9
    s_lshl_b32 s28, s28, 9
    s_add_u32 s28, s28, 20709376
    v_mov_b32 v12, -1
    v_mov_b32 v13, -1
    v_lshlrev_b32 v11, 3, v0
    buffer_store_dwordx2 v[12:13], v11, s[4:7], s28 offen
    s_branch e_ka_kernel_10
z_ka_kernel_9:
    s_lshl_b32 s28, s22, 12
    s_add_u32 s28, s28, 25165824
    s_lshl_b32 s29, s21, 17
    s_add_u32 s28, s28, s29
    s_add_u32 s29, s28, 1048576
    v_lshlrev_b32 v11, 3, v0
    v_mov_b32 v12, 0
    v_mov_b32 v13, 0
    buffer_store_dwordx2 v[12:13], v11, s[4:7], s28 offen
    buffer_store_dwordx2 v[12:13], v11, s[4:7], s29 offen
    s_lshl_b32 s28, s22, 3
    s_add_u32 s28, s28, s21
    s_lshl_b32 s28, s28, 10
    s_add_u32 s28, s28, 26476544
    buffer_store_dwordx2 v[12:13], v11, s[4:7], s28 offen
    buffer_store_dwordx2 v[12:13], v11, s[4:7], s28 offen offset:512
e_ka_kernel_10:
    s_barrier
    v_bfe_u32 v5, v0, 2, 2
    v_lshrrev_b32 v6, 4, v0
    v_lshl_add_u32 v6, v6, 3, v5
    v_lshl_add_u32 v10, v6, 7, v10
    v_lshrrev_b32 v5, 1, v5
    v_lshl_add_u32 v10, v5, 5, v10
    v_xor_b32 v11, 32, v10
    v_xor_b32 v12, 64, v10
    v_xor_b32 v13, 96, v10
    s_lshl_b32 s26, s26, 2
    s_mul_i32 s25, s25, 6
    s_waitcnt vmcnt(0)
    ds_read_b64_tr_b16 v[16:17], v10 offset:0
    ds_read_b64_tr_b16 v[18:19], v12 offset:512
    ds_read_b64_tr_b16 v[20:21], v10 offset:4096
    ds_read_b64_tr_b16 v[22:23], v12 offset:4608
    ds_read_b64_tr_b16 v[24:25], v11 offset:0
    ds_read_b64_tr_b16 v[26:27], v13 offset:512
    ds_read_b64_tr_b16 v[28:29], v11 offset:4096
    ds_read_b64_tr_b16 v[30:31], v13 offset:4608
    ds_read_b64_tr_b16 v[32:33], v12 offset:0
    ds_read_b64_tr_b16 v[34:35], v10 offset:512
    ds_read_b64_tr_b16 v[36:37], v12 offset:4096
    ds_read_b64_tr_b16 v[38:39], v10 offset:4608
    ds_read_b64_tr_b16 v[40:41], v13 offset:0
    ds_read_b64_tr_b16 v[42:43], v11 offset:512
    ds_read_b64_tr_b16 v[44:45], v13 offset:4096
    ds_read_b64_tr_b16 v[46:47], v11 offset:4608
    s_add_u32 s28, s26, 0
    s_mul_i32 s29, s28, 21846
    s_lshr_b32 s29, s29, 16
    s_mul_i32 s30, s29, 57
    s_add_u32 s28, s28, s30
    s_add_u32 s28, s28, s25
    s_lshl_b32 s28, s28, 10
    s_add_u32 s28, s28, 16777216
    s_waitcnt lgkmcnt(12)
    buffer_store_dwordx4 v[16:19], v9, s[4:7], s28 offen offset:0
    buffer_store_dwordx4 v[20:23], v9, s[4:7], s28 offen offset:3072
    s_add_u32 s28, s26, 1
    s_mul_i32 s29, s28, 21846
    s_lshr_b32 s29, s29, 16
    s_mul_i32 s30, s29, 57
    s_add_u32 s28, s28, s30
    s_add_u32 s28, s28, s25
    s_lshl_b32 s28, s28, 10
    s_add_u32 s28, s28, 16777216
    s_waitcnt lgkmcnt(8)
    buffer_store_dwordx4 v[24:27], v9, s[4:7], s28 offen offset:0
    buffer_store_dwordx4 v[28:31], v9, s[4:7], s28 offen offset:3072
    s_add_u32 s28, s26, 2
    s_mul_i32 s29, s28, 21846
    s_lshr_b32 s29, s29, 16
    s_mul_i32 s30, s29, 57
    s_add_u32 s28, s28, s30
    s_add_u32 s28, s28, s25
    s_lshl_b32 s28, s28, 10
    s_add_u32 s28, s28, 16777216
    s_waitcnt lgkmcnt(4)
    buffer_store_dwordx4 v[32:35], v9, s[4:7], s28 offen offset:0
    buffer_store_dwordx4 v[36:39], v9, s[4:7], s28 offen offset:3072
    s_add_u32 s28, s26, 3
    s_mul_i32 s29, s28, 21846
    s_lshr_b32 s29, s29, 16
    s_mul_i32 s30, s29, 57
    s_add_u32 s28, s28, s30
    s_add_u32 s28, s28, s25
    s_lshl_b32 s28, s28, 10
    s_add_u32 s28, s28, 16777216
    s_waitcnt lgkmcnt(0)
    buffer_store_dwordx4 v[40:43], v9, s[4:7], s28 offen offset:0
    buffer_store_dwordx4 v[44:47], v9, s[4:7], s28 offen offset:3072
    s_endpgm
w2p_ka_kernel_5:
    s_sub_u32 s24, s24, 240
    s_mul_i32 s25, s24, 6554
    s_lshr_b32 s25, s25, 16
    s_mul_i32 s26, s25, 10
    s_sub_u32 s26, s24, s26
    s_mul_i32 s28, s25, 122880
    s_lshl_b32 s29, s26, 7
    s_add_u32 s28, s28, s29
    v_mul_u32_u24 v2, 1280, v2
    v_add_u32 v2, v2, v3
    s_mov_b32 m0, s40
    s_nop 0
    buffer_load_dwordx4 v2, s[48:51], s28 offen lds
    s_add_u32 s28, s28, 10240
    s_add_u32 m0, m0, 1024
    s_nop 0
    buffer_load_dwordx4 v2, s[48:51], s28 offen lds
    s_add_u32 s28, s28, 10240
    s_add_u32 m0, m0, 1024
    s_nop 0
    buffer_load_dwordx4 v2, s[48:51], s28 offen lds
    s_add_u32 s28, s28, 10240
    s_add_u32 m0, m0, 1024
    s_nop 0
    buffer_load_dwordx4 v2, s[48:51], s28 offen lds
    s_add_u32 s28, s28, 10240
    s_add_u32 m0, m0, 1024
    s_nop 0
    buffer_load_dwordx4 v2, s[48:51], s28 offen lds
    s_add_u32 s28, s28, 10240
    s_add_u32 m0, m0, 1024
    s_nop 0
    buffer_load_dwordx4 v2, s[48:51], s28 offen lds
    s_add_u32 s28, s28, 10240
    s_add_u32 m0, m0, 1024
    s_nop 0
    buffer_load_dwordx4 v2, s[48:51], s28 offen lds
    s_add_u32 s28, s28, 10240
    s_add_u32 m0, m0, 1024
    s_nop 0
    buffer_load_dwordx4 v2, s[48:51], s28 offen lds
    s_add_u32 s28, s28, 10240
    s_add_u32 m0, m0, 1024
    s_nop 0
    buffer_load_dwordx4 v2, s[48:51], s28 offen lds
    s_add_u32 s28, s28, 10240
    s_add_u32 m0, m0, 1024
    s_nop 0
    buffer_load_dwordx4 v2, s[48:51], s28 offen lds
    s_add_u32 s28, s28, 10240
    s_add_u32 m0, m0, 1024
    s_nop 0
    buffer_load_dwordx4 v2, s[48:51], s28 offen lds
    s_add_u32 s28, s28, 10240
    s_add_u32 m0, m0, 1024
    s_nop 0
    buffer_load_dwordx4 v2, s[48:51], s28 offen lds
    s_lshl_b32 s28, s22, 3
    s_add_u32 s28, s28, s21
    s_cmp_eq_u32 s27, 0
    s_cbranch_scc0 z_ka_kernel_11
    s_lshl_b32 s28, s28, 9
    s_add_u32 s28, s28, 20709376
    v_mov_b32 v12, -1
    v_mov_b32 v13, -1
    v_lshlrev_b32 v11, 3, v0
    buffer_store_dwordx2 v[12:13], v11, s[4:7], s28 offen
    s_branch e_ka_kernel_12
z_ka_kernel_11:
    s_lshl_b32 s28, s22, 12
    s_add_u32 s28, s28, 25165824
    s_lshl_b32 s29, s21, 17
    s_add_u32 s28, s28, s29
    s_add_u32 s29, s28, 1048576
    v_lshlrev_b32 v11, 3, v0
    v_mov_b32 v12, 0
    v_mov_b32 v13, 0
    buffer_store_dwordx2 v[12:13], v11, s[4:7], s28 offen
    buffer_store_dwordx2 v[12:13], v11, s[4:7], s29 offen
    s_lshl_b32 s28, s22, 3
    s_add_u32 s28, s28, s21
    s_lshl_b32 s28, s28, 10
    s_add_u32 s28, s28, 26476544
    buffer_store_dwordx2 v[12:13], v11, s[4:7], s28 offen
    buffer_store_dwordx2 v[12:13], v11, s[4:7], s28 offen offset:512
e_ka_kernel_12:
    s_barrier
    v_lshrrev_b32 v6, 2, v0
    v_lshl_add_u32 v10, v6, 7, v10
    v_bfe_u32 v5, v0, 3, 2
    v_lshl_add_u32 v10, v5, 5, v10
    v_xor_b32 v11, 32, v10
    v_xor_b32 v12, 64, v10
    v_xor_b32 v13, 96, v10
    s_lshl_b32 s26, s26, 2
    s_lshr_b32 s30, s25, 1
    s_mul_i32 s30, s30, 30
    s_and_b32 s31, s25, 1
    s_mul_i32 s32, s31, 10
    s_add_u32 s32, s32, s30
    s_mul_i32 s33, s31, 5
    s_add_u32 s33, s33, s30
    s_add_u32 s33, s33, 20
    s_waitcnt vmcnt(0)
    ds_read_b64_tr_b16 v[16:17], v10 offset:0
    ds_read_b64_tr_b16 v[18:19], v10 offset:2048
    ds_read_b64_tr_b16 v[20:21], v10 offset:6144
    ds_read_b64_tr_b16 v[22:23], v10 offset:8192
    ds_read_b64_tr_b16 v[24:25], v10 offset:4096
    ds_read_b64_tr_b16 v[26:27], v10 offset:10240
    s_add_u32 s28, s26, 0
    s_mul_i32 s29, s28, 13108
    s_lshr_b32 s29, s29, 16
    s_mul_i32 s29, s29, 235
    s_add_u32 s28, s28, s29
    s_add_u32 s29, s28, s33
    s_add_u32 s28, s28, s32
    s_lshl_b32 s28, s28, 10
    s_lshl_b32 s29, s29, 10
    s_add_u32 s28, s28, 18743296
    s_add_u32 s29, s29, 18743296
    s_add_u32 s34, s28, 5120
    s_waitcnt lgkmcnt(0)
    buffer_store_dwordx4 v[16:19], v9, s[4:7], s28 offen
    buffer_store_dwordx4 v[20:23], v9, s[4:7], s34 offen
    buffer_store_dwordx4 v[24:27], v9, s[4:7], s29 offen
    ds_read_b64_tr_b16 v[28:29], v11 offset:0
    ds_read_b64_tr_b16 v[30:31], v11 offset:2048
    ds_read_b64_tr_b16 v[32:33], v11 offset:6144
    ds_read_b64_tr_b16 v[34:35], v11 offset:8192
    ds_read_b64_tr_b16 v[36:37], v11 offset:4096
    ds_read_b64_tr_b16 v[38:39], v11 offset:10240
    s_add_u32 s28, s26, 1
    s_mul_i32 s29, s28, 13108
    s_lshr_b32 s29, s29, 16
    s_mul_i32 s29, s29, 235
    s_add_u32 s28, s28, s29
    s_add_u32 s29, s28, s33
    s_add_u32 s28, s28, s32
    s_lshl_b32 s28, s28, 10
    s_lshl_b32 s29, s29, 10
    s_add_u32 s28, s28, 18743296
    s_add_u32 s29, s29, 18743296
    s_add_u32 s34, s28, 5120
    s_waitcnt lgkmcnt(0)
    buffer_store_dwordx4 v[28:31], v9, s[4:7], s28 offen
    buffer_store_dwordx4 v[32:35], v9, s[4:7], s34 offen
    buffer_store_dwordx4 v[36:39], v9, s[4:7], s29 offen
    ds_read_b64_tr_b16 v[40:41], v12 offset:0
    ds_read_b64_tr_b16 v[42:43], v12 offset:2048
    ds_read_b64_tr_b16 v[44:45], v12 offset:6144
    ds_read_b64_tr_b16 v[46:47], v12 offset:8192
    ds_read_b64_tr_b16 v[48:49], v12 offset:4096
    ds_read_b64_tr_b16 v[50:51], v12 offset:10240
    s_add_u32 s28, s26, 2
    s_mul_i32 s29, s28, 13108
    s_lshr_b32 s29, s29, 16
    s_mul_i32 s29, s29, 235
    s_add_u32 s28, s28, s29
    s_add_u32 s29, s28, s33
    s_add_u32 s28, s28, s32
    s_lshl_b32 s28, s28, 10
    s_lshl_b32 s29, s29, 10
    s_add_u32 s28, s28, 18743296
    s_add_u32 s29, s29, 18743296
    s_add_u32 s34, s28, 5120
    s_waitcnt lgkmcnt(0)
    buffer_store_dwordx4 v[40:43], v9, s[4:7], s28 offen
    buffer_store_dwordx4 v[44:47], v9, s[4:7], s34 offen
    buffer_store_dwordx4 v[48:51], v9, s[4:7], s29 offen
    ds_read_b64_tr_b16 v[52:53], v13 offset:0
    ds_read_b64_tr_b16 v[54:55], v13 offset:2048
    ds_read_b64_tr_b16 v[56:57], v13 offset:6144
    ds_read_b64_tr_b16 v[58:59], v13 offset:8192
    ds_read_b64_tr_b16 v[60:61], v13 offset:4096
    ds_read_b64_tr_b16 v[62:63], v13 offset:10240
    s_add_u32 s28, s26, 3
    s_mul_i32 s29, s28, 13108
    s_lshr_b32 s29, s29, 16
    s_mul_i32 s29, s29, 235
    s_add_u32 s28, s28, s29
    s_add_u32 s29, s28, s33
    s_add_u32 s28, s28, s32
    s_lshl_b32 s28, s28, 10
    s_lshl_b32 s29, s29, 10
    s_add_u32 s28, s28, 18743296
    s_add_u32 s29, s29, 18743296
    s_add_u32 s34, s28, 5120
    s_waitcnt lgkmcnt(0)
    buffer_store_dwordx4 v[52:55], v9, s[4:7], s28 offen
    buffer_store_dwordx4 v[56:59], v9, s[4:7], s34 offen
    buffer_store_dwordx4 v[60:63], v9, s[4:7], s29 offen
    s_endpgm
nou_ka_kernel_6:
    s_lshl_b32 s28, s22, 3
    s_add_u32 s28, s28, s21
    s_cmp_eq_u32 s27, 0
    s_cbranch_scc0 z_ka_kernel_13
    s_lshl_b32 s28, s28, 9
    s_add_u32 s28, s28, 20709376
    v_mov_b32 v12, -1
    v_mov_b32 v13, -1
    v_lshlrev_b32 v11, 3, v0
    buffer_store_dwordx2 v[12:13], v11, s[4:7], s28 offen
    s_branch e_ka_kernel_14
z_ka_kernel_13:
    s_lshl_b32 s28, s22, 12
    s_add_u32 s28, s28, 25165824
    s_lshl_b32 s29, s21, 17
    s_add_u32 s28, s28, s29
    s_add_u32 s29, s28, 1048576
    v_lshlrev_b32 v11, 3, v0
    v_mov_b32 v12, 0
    v_mov_b32 v13, 0
    buffer_store_dwordx2 v[12:13], v11, s[4:7], s28 offen
    buffer_store_dwordx2 v[12:13], v11, s[4:7], s29 offen
    s_lshl_b32 s28, s22, 3
    s_add_u32 s28, s28, s21
    s_lshl_b32 s28, s28, 10
    s_add_u32 s28, s28, 26476544
    buffer_store_dwordx2 v[12:13], v11, s[4:7], s28 offen
    buffer_store_dwordx2 v[12:13], v11, s[4:7], s28 offen offset:512
e_ka_kernel_14:
    s_barrier
done_ka_kernel_1:
    s_endpgm
.globl kp_kernel
.p2align 8
.type kp_kernel,@function
kp_kernel:
    s_load_dwordx2 s[4:5], s[0:1], 80
    s_load_dwordx2 s[8:9], s[0:1], 0
    s_load_dwordx2 s[12:13], s[0:1], 64
    s_cmp_ge_u32 s2, 256
    s_cbranch_scc1 done_kp_kernel_1
    s_bfe_u32 s21, s2, 0x30003
    s_lshr_b32 s3, s2, 6
    s_bfe_u32 s24, s2, 0x30000
    s_lshl_b32 s22, s24, 2
    s_add_u32 s22, s22, s3
    s_lshr_b32 s25, s22, 1
    s_sub_u32 s26, 32, s25
    s_cmp_eq_u32 s25, 0
    s_cselect_b32 s26, 16, s26
    s_bitcmp1_b32 s3, 0
    s_cselect_b32 s23, s26, s25
    v_lshrrev_b32 v1, 6, v0
    v_and_b32 v0, 63, v0
    v_readfirstlane_b32 s20, v1
    s_mov_b32 s6, 0x10000000
    s_mov_b32 s7, 0x20000
    s_lshr_b32 s24, s21, 2
    s_sub_u32 s25, 32, s23
    s_and_b32 s25, s25, 31
    s_cmp_eq_u32 s24, 0
    s_cselect_b32 s25, s23, s25
    s_mov_b32 s51, s25
    s_mul_i32 s25, s25, 81920
    s_lshl_b32 s27, s20, 13
    s_add_u32 s39, s25, 65536
    s_add_u32 s25, s25, s27
    s_add_u32 s25, s25, 0
    s_mul_i32 s29, s20, 8448
    v_lshlrev_b32 v3, 4, v0
    s_getpc_b64 s[16:17]
pc_kp_kernel_2:
    s_add_u32 s16, s16, tbl-pc_kp_kernel_2
    s_addc_u32 s17, s17, 0
    s_mov_b32 s18, 24576
    s_mov_b32 s19, 0x20000
    s_lshl_b32 s30, s20, 12
    s_add_u32 s28, s30, 8192
    s_add_u32 m0, s30, 118912
    s_lshl_b32 s27, s20, 9
    s_add_u32 s27, s27, 130176
    buffer_load_dwordx4 v3, s[16:19], s28 offen offset:0 lds
    buffer_load_dwordx4 v3, s[16:19], s28 offen offset:1024 lds
    buffer_load_dwordx4 v3, s[16:19], s28 offen offset:2048 lds
    buffer_load_dwordx4 v3, s[16:19], s28 offen offset:3072 lds
    s_mul_i32 s33, s22, 81920
    s_lshl_b32 s34, s21, 2
    s_add_u32 s34, s34, s20
    s_mov_b32 s10, 2621440
    s_mov_b32 s11, 0x20000
    s_mov_b32 s14, 2621440
    s_mov_b32 s15, 0x20000
    s_mul_i32 s36, s34, 61440
    s_add_u32 s52, s36, 18743296
    s_add_u32 s50, s36, 16777216
    s_mul_i32 s34, s34, 2560
    s_add_u32 s33, s33, s34
    s_and_b32 s35, s21, 3
    s_lshl_b32 s35, s35, 9
    s_lshl_b32 s36, s24, 5
    s_add_u32 s35, s35, s36
    s_add_u32 s35, s35, s23
    s_lshl_b32 s31, s20, 7
    s_add_u32 s31, s31, s35
    s_mul_i32 s31, s31, 1280
    s_mov_b32 s32, 81920
    s_waitcnt lgkmcnt(0)
    s_add_u32 m0, s29, 0
    s_nop 0
    buffer_load_dwordx4 v3, s[4:7], s25 offen offset:0 lds
    s_add_u32 m0, m0, 32
    s_nop 0
    buffer_load_dwordx4 v3, s[4:7], s25 offen offset:1024 lds
    s_add_u32 m0, m0, 32
    s_nop 0
    buffer_load_dwordx4 v3, s[4:7], s25 offen offset:2048 lds
    s_add_u32 m0, m0, 32
    s_nop 0
    buffer_load_dwordx4 v3, s[4:7], s25 offen offset:3072 lds
    s_add_u32 s25, s25, 4096
    s_add_u32 m0, m0, 4128
    s_nop 0
    buffer_load_dwordx4 v3, s[4:7], s25 offen offset:0 lds
    s_add_u32 m0, m0, 32
    s_nop 0
    buffer_load_dwordx4 v3, s[4:7], s25 offen offset:1024 lds
    s_add_u32 m0, m0, 32
    s_nop 0
    buffer_load_dwordx4 v3, s[4:7], s25 offen offset:2048 lds
    s_add_u32 m0, m0, 32
    s_nop 0
    buffer_load_dwordx4 v3, s[4:7], s25 offen offset:3072 lds
    s_add_u32 s25, s25, 28672
    v_lshrrev_b32 v4, 4, v0
    v_and_b32 v5, 7, v0
    v_lshl_add_u32 v5, v5, 6, s35
    v_cvt_f32_u32 v5, v5
    v_mul_f32 v5, 0x3a000000, v5
    v_lshlrev_b32 v6, 1, v4
    v_cvt_f32_u32 v6, v6
    v_bfe_u32 v7, v0, 3, 1
    v_lshl_add_u32 v2, v7, 2, v4
    v_lshl_add_u32 v2, v2, 6, s27
    v_cvt_f32_u32 v7, v7
    v_mul_f32 v7, 0x3e800000, v7
    v_fmac_f32 v7, v5, v6
    s_cmp_eq_u32 s23, 0
    s_cselect_b32 s36, 1, 0
    s_and_b32 s40, s36, s24
    s_cmp_eq_u32 s24, 0
    s_mov_b32 s42, 0xbe000000
    s_cselect_b32 s42, 0x3e000000, s42
    s_cmp_eq_u32 s36, 1
    s_cselect_b32 s42, 0, s42
    s_cmp_eq_u32 s40, 1
    s_cselect_b32 s41, 0, 0x3e000000
    s_cselect_b32 s42, 0x3e000000, s42
    s_cselect_b32 s43, 0, 0xbe800000
    v_fmamk_f32 v92, v5, 0x00000000, v7
    v_add_f32 v93, s43, v92
    v_cos_f32 v92, v92
    v_cos_f32 v93, v93
    v_fmamk_f32 v94, v5, 0x3f800000, v7
    v_add_f32 v95, s43, v94
    v_cos_f32 v94, v94
    v_cos_f32 v95, v95
    v_fmamk_f32 v96, v5, 0x41000000, v7
    v_add_f32 v97, s43, v96
    v_cos_f32 v96, v96
    v_cos_f32 v97, v97
    v_fmamk_f32 v98, v5, 0x41100000, v7
    v_add_f32 v99, s43, v98
    v_cos_f32 v98, v98
    v_cos_f32 v99, v99
    v_fmamk_f32 v100, v5, 0x41800000, v7
    v_add_f32 v101, s43, v100
    v_cos_f32 v100, v100
    v_cos_f32 v101, v101
    v_fmamk_f32 v102, v5, 0x41880000, v7
    v_add_f32 v103, s43, v102
    v_cos_f32 v102, v102
    v_cos_f32 v103, v103
    v_fmamk_f32 v104, v5, 0x41c00000, v7
    v_add_f32 v105, s43, v104
    v_cos_f32 v104, v104
    v_cos_f32 v105, v105
    v_fmamk_f32 v106, v5, 0x41c80000, v7
    v_add_f32 v107, s43, v106
    v_cos_f32 v106, v106
    v_cos_f32 v107, v107
    s_add_u32 m0, s29, 33792
    s_nop 0
    buffer_load_dwordx4 v3, s[4:7], s25 offen offset:0 lds
    s_add_u32 m0, m0, 32
    s_nop 0
    buffer_load_dwordx4 v3, s[4:7], s25 offen offset:1024 lds
    s_add_u32 m0, m0, 32
    s_nop 0
    buffer_load_dwordx4 v3, s[4:7], s25 offen offset:2048 lds
    s_add_u32 m0, m0, 32
    s_nop 0
    buffer_load_dwordx4 v3, s[4:7], s25 offen offset:3072 lds
    s_add_u32 s25, s25, 4096
    s_add_u32 m0, m0, 4128
    s_nop 0
    buffer_load_dwordx4 v3, s[4:7], s25 offen offset:0 lds
    s_add_u32 m0, m0, 32
    s_nop 0
    buffer_load_dwordx4 v3, s[4:7], s25 offen offset:1024 lds
    s_add_u32 m0, m0, 32
    s_nop 0
    buffer_load_dwordx4 v3, s[4:7], s25 offen offset:2048 lds
    s_add_u32 m0, m0, 32
    s_nop 0
    buffer_load_dwordx4 v3, s[4:7], s25 offen offset:3072 lds
    s_add_u32 s25, s25, 28672
    v_mul_f32 v92, s41, v92
    v_mul_f32 v93, s42, v93
    v_cvt_pk_f16_f32 v16, v92, v93
    v_mul_f32 v94, s41, v94
    v_mul_f32 v95, s42, v95
    v_cvt_pk_f16_f32 v17, v94, v95
    v_mul_f32 v96, s41, v96
    v_mul_f32 v97, s42, v97
    v_cvt_pk_f16_f32 v18, v96, v97
    v_mul_f32 v98, s41, v98
    v_mul_f32 v99, s42, v99
    v_cvt_pk_f16_f32 v19, v98, v99
    v_mul_f32 v100, s41, v100
    v_mul_f32 v101, s42, v101
    v_cvt_pk_f16_f32 v20, v100, v101
    v_mul_f32 v102, s41, v102
    v_mul_f32 v103, s42, v103
    v_cvt_pk_f16_f32 v21, v102, v103
    v_mul_f32 v104, s41, v104
    v_mul_f32 v105, s42, v105
    v_cvt_pk_f16_f32 v22, v104, v105
    v_mul_f32 v106, s41, v106
    v_mul_f32 v107, s42, v107
    v_cvt_pk_f16_f32 v23, v106, v107
    s_lshl_b32 s34, s20, 12
    s_add_u32 s39, s39, s34
    s_mul_i32 s40, s20, 4224
    s_add_u32 s40, s40, 67584
    v_lshrrev_b32 v7, 5, v0
    v_lshlrev_b32 v7, 7, v7
    v_xor_b32 v7, v7, v3
    v_and_b32 v14, 15, v0
    v_lshlrev_b32 v10, 5, v14
    v_cmp_gt_u32 vcc, 8, v14
    v_lshrrev_b32 v15, 5, v0
    v_lshl_add_u32 v15, v15, 4, v10
    v_bfe_u32 v13, v0, 4, 1
    v_mad_u32_u24 v11, v13, s32, v15
    v_mul_u32_u24 v13, 1280, v13
    v_add_u32 v13, v13, v15
    v_mov_b32 v15, 536870912
    v_cndmask_b32 v12, v15, v11, vcc
    v_cndmask_b32 v15, v15, v13, vcc
    v_and_b32 v1, 1, v0
    v_lshlrev_b32 v1, 3, v1
    v_bfe_u32 v5, v0, 2, 1
    v_lshl_add_u32 v1, v5, 4, v1
    s_lshl_b32 s30, s20, 5
    v_add_u32 v1, s30, v1
    v_bfe_u32 v8, v0, 1, 1
    v_mul_u32_u24 v5, 1056, v4
    v_lshl_add_u32 v5, v8, 6, v5
    v_lshl_add_u32 v9, v8, 7, v1
    v_add_u32 v5, v5, v1
    s_and_b32 s30, s30, 64
    v_subrev_u32 v5, s30, v5
    v_bfe_u32 v8, v0, 3, 1
    v_mul_u32_u24 v6, 384, v8
    v_mul_u32_u24 v8, 640, v8
    v_add_u32 v5, 67584, v5
    v_add3_u32 v6, v6, v5, 64
    v_add_u32 v6, 64, v6
    v_add_u32 v5, v5, v8
    v_lshrrev_b32 v1, 3, v0
    v_mul_u32_u24 v1, 1056, v1
    v_add_u32 v1, v1, v9
    v_and_b32 v8, 7, v0
    v_mul_u32_u24 v8, 2576, v8
    v_mul_u32_u24 v9, 320, v4
    v_add_u32 v8, v8, v9
    v_bfe_u32 v9, v0, 3, 1
    v_lshl_add_u32 v8, v9, 3, v8
    s_lshl_b32 s30, s20, 4
    s_add_u32 s30, s30, 98304
    v_add_u32 v8, s30, v8
    s_mul_i32 s30, s20, 5152
    s_add_u32 s30, s30, 98304
    v_mul_u32_u24 v9, 160, v14
    v_add_u32 v9, s30, v9
    v_bfe_u32 v10, v0, 4, 1
    v_lshl_add_u32 v10, v10, 4, v9
    v_lshl_add_u32 v9, v4, 4, v9
    v_add_u32 v14, 118912, v3
    s_waitcnt vmcnt(8)
    s_barrier
    ds_read_b64_tr_b16 v[60:61], v1 offset:0
    ds_read_b64_tr_b16 v[62:63], v1 offset:8448
    ds_read_b64_tr_b16 v[68:69], v1 offset:256
    ds_read_b64_tr_b16 v[70:71], v1 offset:8704
    ds_read_b64_tr_b16 v[76:77], v1 offset:512
    ds_read_b64_tr_b16 v[78:79], v1 offset:8960
    ds_read_b64_tr_b16 v[84:85], v1 offset:768
    ds_read_b64_tr_b16 v[86:87], v1 offset:9216
    ds_read_b64_tr_b16 v[64:65], v1 offset:16896
    ds_read_b64_tr_b16 v[66:67], v1 offset:25344
    ds_read_b64_tr_b16 v[72:73], v1 offset:17152
    ds_read_b64_tr_b16 v[74:75], v1 offset:25600
    ds_read_b64_tr_b16 v[80:81], v1 offset:17408
    ds_read_b64_tr_b16 v[82:83], v1 offset:25856
    ds_read_b64_tr_b16 v[88:89], v1 offset:17664
    ds_read_b64_tr_b16 v[90:91], v1 offset:26112
    ds_read_b128 v[24:27], v14 offset:0
    ds_read_b128 v[28:31], v14 offset:1024
    s_mov_b32 m0, s40
    s_nop 0
    buffer_load_dwordx4 v7, s[4:7], s39 offen offset:0 lds
    s_add_u32 m0, m0, 32
    s_nop 0
    buffer_load_dwordx4 v7, s[4:7], s39 offen offset:1024 lds
    ds_read_b128 v[32:35], v2 offset:0
    ds_read_b128 v[36:39], v2 offset:16
    ds_read_b128 v[40:43], v2 offset:32
    ds_read_b128 v[44:47], v2 offset:48
    s_waitcnt lgkmcnt(15)
    v_mfma_f32_16x16x32_f16 v[92:95], v[60:63], v[16:19], 0
    v_mfma_f32_16x16x32_f16 v[96:99], v[68:71], v[16:19], 0
    s_add_u32 m0, m0, 32
    s_nop 0
    buffer_load_dwordx4 v7, s[4:7], s39 offen offset:2048 lds
    v_mfma_f32_16x16x32_f16 v[100:103], v[76:79], v[16:19], 0
    s_waitcnt lgkmcnt(14)
    s_add_u32 m0, m0, 32
    s_nop 0
    buffer_load_dwordx4 v7, s[4:7], s39 offen offset:3072 lds
    v_mfma_f32_16x16x32_f16 v[104:107], v[84:87], v[16:19], 0
    s_waitcnt lgkmcnt(12)
    v_mfma_f32_16x16x32_f16 v[92:95], v[64:67], v[20:23], v[92:95]
    buffer_load_dwordx4 v[48:51], v11, s[8:11], s31 offen offset:0
    s_waitcnt lgkmcnt(10)
    v_mfma_f32_16x16x32_f16 v[96:99], v[72:75], v[20:23], v[96:99]
    s_waitcnt lgkmcnt(8)
    v_mfma_f32_16x16x32_f16 v[100:103], v[80:83], v[20:23], v[100:103]
    s_waitcnt lgkmcnt(6)
    v_mfma_f32_16x16x32_f16 v[104:107], v[88:91], v[20:23], v[104:107]
    buffer_load_dwordx4 v[52:55], v11, s[8:11], s31 offen offset:512
    s_nop 2
    v_cvt_pk_f16_f32 v108, v92, v96
    s_nop 2
    v_cvt_pk_f16_f32 v109, v100, v104
    buffer_load_dwordx4 v[56:59], v12, s[8:11], s31 offen offset:1024
    v_cvt_pk_f16_f32 v110, v93, v97
    v_cvt_pk_f16_f32 v111, v101, v105
    v_mov_b32 v116, v108
    v_mov_b32 v117, v109
    v_mov_b32_dpp v108, v110 row_ror:8 row_mask:0xf bank_mask:0xc
    v_mov_b32_dpp v109, v111 row_ror:8 row_mask:0xf bank_mask:0xc
    s_add_u32 s37, s50, 0
    buffer_load_dwordx4 a[0:3], v3, s[4:7], s37 offen offset:0
    v_mov_b32_dpp v110, v116 row_ror:8 row_mask:0xf bank_mask:0x3
    v_mov_b32_dpp v111, v117 row_ror:8 row_mask:0xf bank_mask:0x3
    s_waitcnt lgkmcnt(4)
    s_nop 0
    v_mfma_f32_16x16x32_f16 v[118:121], v[24:27], v[108:111], 0
    v_mfma_f32_16x16x32_f16 v[122:125], v[28:31], v[108:111], 0
    v_cvt_pk_f16_f32 v112, v94, v98
    v_cvt_pk_f16_f32 v113, v102, v106
    v_cvt_pk_f16_f32 v114, v95, v99
    buffer_load_dwordx4 a[4:7], v3, s[4:7], s37 offen offset:1024
    v_cvt_pk_f16_f32 v115, v103, v107
    v_mov_b32 v116, v112
    v_mov_b32 v117, v113
    v_mov_b32_dpp v112, v114 row_ror:8 row_mask:0xf bank_mask:0xc
    v_mov_b32_dpp v113, v115 row_ror:8 row_mask:0xf bank_mask:0xc
    v_mov_b32_dpp v114, v116 row_ror:8 row_mask:0xf bank_mask:0x3
    buffer_load_dwordx4 a[8:11], v3, s[4:7], s37 offen offset:2048
    v_mov_b32_dpp v115, v117 row_ror:8 row_mask:0xf bank_mask:0x3
    s_nop 1
    v_mfma_f32_16x16x32_f16 v[126:129], v[24:27], v[112:115], 0
    v_mfma_f32_16x16x32_f16 v[130:133], v[28:31], v[112:115], 0
    buffer_load_dwordx4 a[12:15], v3, s[4:7], s37 offen offset:3072
    s_waitcnt lgkmcnt(0)
    s_waitcnt vmcnt(11)
    s_barrier
    ds_read_b64_tr_b16 v[60:61], v1 offset:33792
    ds_read_b64_tr_b16 v[62:63], v1 offset:42240
    ds_read_b64_tr_b16 v[68:69], v1 offset:34048
    ds_read_b64_tr_b16 v[70:71], v1 offset:42496
    s_add_u32 s37, s50, 4096
    buffer_load_dwordx4 a[16:19], v3, s[4:7], s37 offen offset:0
    ds_read_b64_tr_b16 v[76:77], v1 offset:34304
    ds_read_b64_tr_b16 v[78:79], v1 offset:42752
    ds_read_b64_tr_b16 v[84:85], v1 offset:34560
    ds_read_b64_tr_b16 v[86:87], v1 offset:43008
    ds_read_b64_tr_b16 v[64:65], v1 offset:50688
    ds_read_b64_tr_b16 v[66:67], v1 offset:59136
    buffer_load_dwordx4 a[20:23], v3, s[4:7], s37 offen offset:1024
    ds_read_b64_tr_b16 v[72:73], v1 offset:50944
    ds_read_b64_tr_b16 v[74:75], v1 offset:59392
    ds_read_b64_tr_b16 v[80:81], v1 offset:51200
    ds_read_b64_tr_b16 v[82:83], v1 offset:59648
    ds_read_b64_tr_b16 v[88:89], v1 offset:51456
    ds_read_b64_tr_b16 v[90:91], v1 offset:59904
    buffer_load_dwordx4 a[24:27], v3, s[4:7], s37 offen offset:2048
    v_pk_mul_f32 v[92:93], v[118:119], v[32:33] op_sel_hi:[1,0]
    v_pk_mul_f32 v[100:101], v[126:127], v[40:41] op_sel_hi:[1,0]
    v_pk_fma_f32 v[92:93], v[118:119], v[32:33], v[92:93] op_sel:[1,1,0] op_sel_hi:[0,1,1] neg_hi:[1,0,0]
    v_pk_fma_f32 v[100:101], v[126:127], v[40:41], v[100:101] op_sel:[1,1,0] op_sel_hi:[0,1,1] neg_hi:[1,0,0]
    v_cvt_pk_f16_f32 v108, v92, v93
    v_cvt_pk_f16_f32 v109, v100, v101
    buffer_load_dwordx4 a[28:31], v3, s[4:7], s37 offen offset:3072
    ds_write_b64 v8, v[108:109] offset:0
    v_pk_mul_f32 v[94:95], v[120:121], v[34:35] op_sel_hi:[1,0]
    v_pk_mul_f32 v[102:103], v[128:129], v[42:43] op_sel_hi:[1,0]
    v_pk_fma_f32 v[94:95], v[120:121], v[34:35], v[94:95] op_sel:[1,1,0] op_sel_hi:[0,1,1] neg_hi:[1,0,0]
    v_pk_fma_f32 v[102:103], v[128:129], v[42:43], v[102:103] op_sel:[1,1,0] op_sel_hi:[0,1,1] neg_hi:[1,0,0]
    v_cvt_pk_f16_f32 v110, v94, v95
    s_add_u32 s37, s50, 8192
    buffer_load_dwordx4 a[32:35], v3, s[4:7], s37 offen offset:0
    v_cvt_pk_f16_f32 v111, v102, v103
    ds_write_b64 v8, v[110:111] offset:160
    v_pk_mul_f32 v[96:97], v[122:123], v[36:37] op_sel_hi:[1,0]
    v_pk_mul_f32 v[104:105], v[130:131], v[44:45] op_sel_hi:[1,0]
    v_pk_fma_f32 v[96:97], v[122:123], v[36:37], v[96:97] op_sel:[1,1,0] op_sel_hi:[0,1,1] neg_hi:[1,0,0]
    v_pk_fma_f32 v[104:105], v[130:131], v[44:45], v[104:105] op_sel:[1,1,0] op_sel_hi:[0,1,1] neg_hi:[1,0,0]
    buffer_load_dwordx4 a[36:39], v3, s[4:7], s37 offen offset:1024
    v_cvt_pk_f16_f32 v112, v96, v97
    v_cvt_pk_f16_f32 v113, v104, v105
    ds_write_b64 v8, v[112:113] offset:1280
    v_pk_mul_f32 v[98:99], v[124:125], v[38:39] op_sel_hi:[1,0]
    v_pk_mul_f32 v[106:107], v[132:133], v[46:47] op_sel_hi:[1,0]
    v_pk_fma_f32 v[98:99], v[124:125], v[38:39], v[98:99] op_sel:[1,1,0] op_sel_hi:[0,1,1] neg_hi:[1,0,0]
    buffer_load_dwordx4 a[40:43], v3, s[4:7], s37 offen offset:2048
    v_pk_fma_f32 v[106:107], v[132:133], v[46:47], v[106:107] op_sel:[1,1,0] op_sel_hi:[0,1,1] neg_hi:[1,0,0]
    v_cvt_pk_f16_f32 v114, v98, v99
    v_cvt_pk_f16_f32 v115, v106, v107
    ds_write_b64 v8, v[114:115] offset:1440
    ds_read_b128 v[32:35], v2 offset:2048
    ds_read_b128 v[36:39], v2 offset:2064
    buffer_load_dwordx4 a[44:47], v3, s[4:7], s37 offen offset:3072
    ds_read_b128 v[40:43], v2 offset:2080
    ds_read_b128 v[44:47], v2 offset:2096
    s_waitcnt lgkmcnt(15)
    v_mfma_f32_16x16x32_f16 v[92:95], v[60:63], v[16:19], 0
    v_mfma_f32_16x16x32_f16 v[96:99], v[68:71], v[16:19], 0
    s_add_u32 s37, s50, 12288
    buffer_load_dwordx4 a[48:51], v3, s[4:7], s37 offen offset:0
    v_mfma_f32_16x16x32_f16 v[100:103], v[76:79], v[16:19], 0
    v_mfma_f32_16x16x32_f16 v[104:107], v[84:87], v[16:19], 0
    s_waitcnt lgkmcnt(14)
    v_mfma_f32_16x16x32_f16 v[92:95], v[64:67], v[20:23], v[92:95]
    buffer_load_dwordx4 a[52:55], v3, s[4:7], s37 offen offset:1024
    s_waitcnt lgkmcnt(12)
    v_mfma_f32_16x16x32_f16 v[96:99], v[72:75], v[20:23], v[96:99]
    s_waitcnt lgkmcnt(10)
    buffer_load_dwordx4 a[56:59], v3, s[4:7], s37 offen offset:2048
    v_mfma_f32_16x16x32_f16 v[100:103], v[80:83], v[20:23], v[100:103]
    s_waitcnt lgkmcnt(8)
    v_mfma_f32_16x16x32_f16 v[104:107], v[88:91], v[20:23], v[104:107]
    buffer_load_dwordx4 a[60:63], v3, s[4:7], s37 offen offset:3072
    s_nop 1
    v_cvt_pk_f16_f32 v108, v92, v96
    s_nop 3
    v_cvt_pk_f16_f32 v109, v100, v104
    v_cvt_pk_f16_f32 v110, v93, v97
    v_cvt_pk_f16_f32 v111, v101, v105
    v_mov_b32 v116, v108
    s_add_u32 s37, s50, 16384
    buffer_load_dwordx4 a[64:67], v3, s[4:7], s37 offen offset:0
    v_mov_b32 v117, v109
    v_mov_b32_dpp v108, v110 row_ror:8 row_mask:0xf bank_mask:0xc
    v_mov_b32_dpp v109, v111 row_ror:8 row_mask:0xf bank_mask:0xc
    v_mov_b32_dpp v110, v116 row_ror:8 row_mask:0xf bank_mask:0x3
    v_mov_b32_dpp v111, v117 row_ror:8 row_mask:0xf bank_mask:0x3
    s_nop 1
    v_mfma_f32_16x16x32_f16 v[118:121], v[24:27], v[108:111], 0
    v_mfma_f32_16x16x32_f16 v[122:125], v[28:31], v[108:111], 0
    v_cvt_pk_f16_f32 v112, v94, v98
    buffer_load_dwordx4 a[68:71], v3, s[4:7], s37 offen offset:1024
    v_cvt_pk_f16_f32 v113, v102, v106
    v_cvt_pk_f16_f32 v114, v95, v99
    v_cvt_pk_f16_f32 v115, v103, v107
    v_mov_b32 v116, v112
    v_mov_b32 v117, v113
    v_mov_b32_dpp v112, v114 row_ror:8 row_mask:0xf bank_mask:0xc
    buffer_load_dwordx4 a[72:75], v3, s[4:7], s37 offen offset:2048
    v_mov_b32_dpp v113, v115 row_ror:8 row_mask:0xf bank_mask:0xc
    v_mov_b32_dpp v114, v116 row_ror:8 row_mask:0xf bank_mask:0x3
    v_mov_b32_dpp v115, v117 row_ror:8 row_mask:0xf bank_mask:0x3
    s_nop 1
    v_mfma_f32_16x16x32_f16 v[126:129], v[24:27], v[112:115], 0
    v_mfma_f32_16x16x32_f16 v[130:133], v[28:31], v[112:115], 0
    buffer_load_dwordx4 a[76:79], v3, s[4:7], s37 offen offset:3072
    s_waitcnt lgkmcnt(0)
    s_waitcnt vmcnt(20)
    s_barrier
    ds_read_b64_tr_b16 v[60:61], v5 offset:0
    ds_read_b64_tr_b16 v[62:63], v5 offset:4224
    s_add_u32 s37, s50, 20480
    buffer_load_dwordx4 a[80:83], v3, s[4:7], s37 offen offset:0
    ds_read_b64_tr_b16 v[68:69], v6 offset:0
    ds_read_b64_tr_b16 v[70:71], v6 offset:4224
    ds_read_b64_tr_b16 v[76:77], v5 offset:256
    ds_read_b64_tr_b16 v[78:79], v5 offset:4480
    ds_read_b64_tr_b16 v[84:85], v6 offset:256
    ds_read_b64_tr_b16 v[86:87], v6 offset:4480
    buffer_load_dwordx4 a[84:87], v3, s[4:7], s37 offen offset:1024
    ds_read_b64_tr_b16 v[64:65], v5 offset:8448
    ds_read_b64_tr_b16 v[66:67], v5 offset:12672
    ds_read_b64_tr_b16 v[72:73], v6 offset:8448
    ds_read_b64_tr_b16 v[74:75], v6 offset:12672
    ds_read_b64_tr_b16 v[80:81], v5 offset:8704
    ds_read_b64_tr_b16 v[82:83], v5 offset:12928
    buffer_load_dwordx4 a[88:91], v3, s[4:7], s37 offen offset:2048
    ds_read_b64_tr_b16 v[88:89], v6 offset:8704
    ds_read_b64_tr_b16 v[90:91], v6 offset:12928
    v_pk_mul_f32 v[92:93], v[118:119], v[32:33] op_sel_hi:[1,0]
    v_pk_mul_f32 v[100:101], v[126:127], v[40:41] op_sel_hi:[1,0]
    v_pk_fma_f32 v[92:93], v[118:119], v[32:33], v[92:93] op_sel:[1,1,0] op_sel_hi:[0,1,1] neg_hi:[1,0,0]
    v_pk_fma_f32 v[100:101], v[126:127], v[40:41], v[100:101] op_sel:[1,1,0] op_sel_hi:[0,1,1] neg_hi:[1,0,0]
    buffer_load_dwordx4 a[92:95], v3, s[4:7], s37 offen offset:3072
    v_cvt_pk_f16_f32 v108, v92, v93
    v_cvt_pk_f16_f32 v109, v100, v101
    ds_write_b64 v8, v[108:109] offset:64
    v_pk_mul_f32 v[94:95], v[120:121], v[34:35] op_sel_hi:[1,0]
    v_pk_mul_f32 v[102:103], v[128:129], v[42:43] op_sel_hi:[1,0]
    v_pk_fma_f32 v[94:95], v[120:121], v[34:35], v[94:95] op_sel:[1,1,0] op_sel_hi:[0,1,1] neg_hi:[1,0,0]
    s_add_u32 s37, s50, 24576
    buffer_load_dwordx4 a[96:99], v3, s[4:7], s37 offen offset:0
    v_pk_fma_f32 v[102:103], v[128:129], v[42:43], v[102:103] op_sel:[1,1,0] op_sel_hi:[0,1,1] neg_hi:[1,0,0]
    v_cvt_pk_f16_f32 v110, v94, v95
    v_cvt_pk_f16_f32 v111, v102, v103
    ds_write_b64 v8, v[110:111] offset:224
    v_pk_mul_f32 v[96:97], v[122:123], v[36:37] op_sel_hi:[1,0]
    v_pk_mul_f32 v[104:105], v[130:131], v[44:45] op_sel_hi:[1,0]
    buffer_load_dwordx4 a[100:103], v3, s[4:7], s37 offen offset:1024
    v_pk_fma_f32 v[96:97], v[122:123], v[36:37], v[96:97] op_sel:[1,1,0] op_sel_hi:[0,1,1] neg_hi:[1,0,0]
    v_pk_fma_f32 v[104:105], v[130:131], v[44:45], v[104:105] op_sel:[1,1,0] op_sel_hi:[0,1,1] neg_hi:[1,0,0]
    v_cvt_pk_f16_f32 v112, v96, v97
    v_cvt_pk_f16_f32 v113, v104, v105
    ds_write_b64 v8, v[112:113] offset:1344
    v_pk_mul_f32 v[98:99], v[124:125], v[38:39] op_sel_hi:[1,0]
    buffer_load_dwordx4 a[104:107], v3, s[4:7], s37 offen offset:2048
    v_pk_mul_f32 v[106:107], v[132:133], v[46:47] op_sel_hi:[1,0]
    v_pk_fma_f32 v[98:99], v[124:125], v[38:39], v[98:99] op_sel:[1,1,0] op_sel_hi:[0,1,1] neg_hi:[1,0,0]
    v_pk_fma_f32 v[106:107], v[132:133], v[46:47], v[106:107] op_sel:[1,1,0] op_sel_hi:[0,1,1] neg_hi:[1,0,0]
    v_cvt_pk_f16_f32 v114, v98, v99
    v_cvt_pk_f16_f32 v115, v106, v107
    ds_write_b64 v8, v[114:115] offset:1504
    buffer_load_dwordx4 a[108:111], v3, s[4:7], s37 offen offset:3072
    s_cmp_ge_u32 s20, 2
    s_cbranch_scc1 q2_kp_kernel_4
    ds_read_b128 v[32:35], v2 offset:4096
    ds_read_b128 v[36:39], v2 offset:4112
    s_waitcnt lgkmcnt(15)
    v_mfma_f32_16x16x32_f16 v[92:95], v[60:63], v[16:19], 0
    v_mfma_f32_16x16x32_f16 v[96:99], v[68:71], v[16:19], 0
    s_add_u32 s37, s50, 28672
    buffer_load_dwordx4 a[112:115], v3, s[4:7], s37 offen offset:0
    v_mfma_f32_16x16x32_f16 v[100:103], v[76:79], v[16:19], 0
    s_waitcnt lgkmcnt(14)
    v_mfma_f32_16x16x32_f16 v[104:107], v[84:87], v[16:19], 0
    s_waitcnt lgkmcnt(12)
    v_mfma_f32_16x16x32_f16 v[92:95], v[64:67], v[20:23], v[92:95]
    buffer_load_dwordx4 a[116:119], v3, s[4:7], s37 offen offset:1024
    s_waitcnt lgkmcnt(10)
    buffer_load_dwordx4 a[120:123], v3, s[4:7], s37 offen offset:2048
    v_mfma_f32_16x16x32_f16 v[96:99], v[72:75], v[20:23], v[96:99]
    s_waitcnt lgkmcnt(8)
    v_mfma_f32_16x16x32_f16 v[100:103], v[80:83], v[20:23], v[100:103]
    s_waitcnt lgkmcnt(6)
    v_mfma_f32_16x16x32_f16 v[104:107], v[88:91], v[20:23], v[104:107]
    buffer_load_dwordx4 a[124:127], v3, s[4:7], s37 offen offset:3072
    s_nop 2
    v_cvt_pk_f16_f32 v108, v92, v96
    s_nop 2
    v_cvt_pk_f16_f32 v109, v100, v104
    v_cvt_pk_f16_f32 v110, v93, v97
    v_cvt_pk_f16_f32 v111, v101, v105
    s_add_u32 s37, s50, 32768
    buffer_load_dwordx4 a[128:131], v3, s[4:7], s37 offen offset:0
    v_mov_b32 v116, v108
    v_mov_b32 v117, v109
    v_mov_b32_dpp v108, v110 row_ror:8 row_mask:0xf bank_mask:0xc
    v_mov_b32_dpp v109, v111 row_ror:8 row_mask:0xf bank_mask:0xc
    v_mov_b32_dpp v110, v116 row_ror:8 row_mask:0xf bank_mask:0x3
    v_mov_b32_dpp v111, v117 row_ror:8 row_mask:0xf bank_mask:0x3
    buffer_load_dwordx4 a[132:135], v3, s[4:7], s37 offen offset:1024
    s_nop 0
    v_mfma_f32_16x16x32_f16 v[118:121], v[24:27], v[108:111], 0
    v_mfma_f32_16x16x32_f16 v[122:125], v[28:31], v[108:111], 0
    buffer_load_dwordx4 a[136:139], v3, s[4:7], s37 offen offset:2048
    s_waitcnt lgkmcnt(0)
    s_nop 4
    v_pk_mul_f32 v[92:93], v[118:119], v[32:33] op_sel_hi:[1,0]
    v_pk_fma_f32 v[92:93], v[118:119], v[32:33], v[92:93] op_sel:[1,1,0] op_sel_hi:[0,1,1] neg_hi:[1,0,0]
    v_cvt_pk_f16_f32 v108, v92, v93
    ds_write_b32 v8, v108 offset:128
    v_pk_mul_f32 v[94:95], v[120:121], v[34:35] op_sel_hi:[1,0]
    buffer_load_dwordx4 a[140:143], v3, s[4:7], s37 offen offset:3072
    v_pk_fma_f32 v[94:95], v[120:121], v[34:35], v[94:95] op_sel:[1,1,0] op_sel_hi:[0,1,1] neg_hi:[1,0,0]
    v_cvt_pk_f16_f32 v110, v94, v95
    ds_write_b32 v8, v110 offset:288
    v_pk_mul_f32 v[96:97], v[122:123], v[36:37] op_sel_hi:[1,0]
    v_pk_fma_f32 v[96:97], v[122:123], v[36:37], v[96:97] op_sel:[1,1,0] op_sel_hi:[0,1,1] neg_hi:[1,0,0]
    v_cvt_pk_f16_f32 v112, v96, v97
    s_add_u32 s37, s50, 36864
    buffer_load_dwordx4 a[144:147], v3, s[4:7], s37 offen offset:0
    ds_write_b32 v8, v112 offset:1408
    v_pk_mul_f32 v[98:99], v[124:125], v[38:39] op_sel_hi:[1,0]
    v_pk_fma_f32 v[98:99], v[124:125], v[38:39], v[98:99] op_sel:[1,1,0] op_sel_hi:[0,1,1] neg_hi:[1,0,0]
    v_cvt_pk_f16_f32 v114, v98, v99
    ds_write_b32 v8, v114 offset:1568
    s_branch q2e_kp_kernel_5
q2_kp_kernel_4:
    v_subrev_u32 v2, 1024, v2
    ds_read_b128 v[40:43], v2 offset:4128
    ds_read_b128 v[44:47], v2 offset:4144
    s_waitcnt lgkmcnt(15)
    v_mfma_f32_16x16x32_f16 v[92:95], v[60:63], v[16:19], 0
    v_mfma_f32_16x16x32_f16 v[96:99], v[68:71], v[16:19], 0
    s_add_u32 s37, s50, 28672
    buffer_load_dwordx4 a[112:115], v3, s[4:7], s37 offen offset:0
    v_mfma_f32_16x16x32_f16 v[100:103], v[76:79], v[16:19], 0
    s_waitcnt lgkmcnt(14)
    v_mfma_f32_16x16x32_f16 v[104:107], v[84:87], v[16:19], 0
    s_waitcnt lgkmcnt(12)
    v_mfma_f32_16x16x32_f16 v[92:95], v[64:67], v[20:23], v[92:95]
    buffer_load_dwordx4 a[116:119], v3, s[4:7], s37 offen offset:1024
    s_waitcnt lgkmcnt(10)
    buffer_load_dwordx4 a[120:123], v3, s[4:7], s37 offen offset:2048
    v_mfma_f32_16x16x32_f16 v[96:99], v[72:75], v[20:23], v[96:99]
    s_waitcnt lgkmcnt(8)
    v_mfma_f32_16x16x32_f16 v[100:103], v[80:83], v[20:23], v[100:103]
    s_waitcnt lgkmcnt(6)
    v_mfma_f32_16x16x32_f16 v[104:107], v[88:91], v[20:23], v[104:107]
    buffer_load_dwordx4 a[124:127], v3, s[4:7], s37 offen offset:3072
    s_nop 2
    v_cvt_pk_f16_f32 v112, v94, v98
    s_nop 2
    v_cvt_pk_f16_f32 v113, v102, v106
    v_cvt_pk_f16_f32 v114, v95, v99
    v_cvt_pk_f16_f32 v115, v103, v107
    s_add_u32 s37, s50, 32768
    buffer_load_dwordx4 a[128:131], v3, s[4:7], s37 offen offset:0
    v_mov_b32 v116, v112
    v_mov_b32 v117, v113
    v_mov_b32_dpp v112, v114 row_ror:8 row_mask:0xf bank_mask:0xc
    v_mov_b32_dpp v113, v115 row_ror:8 row_mask:0xf bank_mask:0xc
    v_mov_b32_dpp v114, v116 row_ror:8 row_mask:0xf bank_mask:0x3
    v_mov_b32_dpp v115, v117 row_ror:8 row_mask:0xf bank_mask:0x3
    buffer_load_dwordx4 a[132:135], v3, s[4:7], s37 offen offset:1024
    s_nop 0
    v_mfma_f32_16x16x32_f16 v[126:129], v[24:27], v[112:115], 0
    v_mfma_f32_16x16x32_f16 v[130:133], v[28:31], v[112:115], 0
    buffer_load_dwordx4 a[136:139], v3, s[4:7], s37 offen offset:2048
    s_waitcnt lgkmcnt(0)
    s_nop 4
    v_pk_mul_f32 v[100:101], v[126:127], v[40:41] op_sel_hi:[1,0]
    v_pk_fma_f32 v[100:101], v[126:127], v[40:41], v[100:101] op_sel:[1,1,0] op_sel_hi:[0,1,1] neg_hi:[1,0,0]
    v_cvt_pk_f16_f32 v109, v100, v101
    ds_write_b32 v8, v109 offset:100
    v_pk_mul_f32 v[102:103], v[128:129], v[42:43] op_sel_hi:[1,0]
    buffer_load_dwordx4 a[140:143], v3, s[4:7], s37 offen offset:3072
    v_pk_fma_f32 v[102:103], v[128:129], v[42:43], v[102:103] op_sel:[1,1,0] op_sel_hi:[0,1,1] neg_hi:[1,0,0]
    v_cvt_pk_f16_f32 v111, v102, v103
    ds_write_b32 v8, v111 offset:260
    v_pk_mul_f32 v[104:105], v[130:131], v[44:45] op_sel_hi:[1,0]
    v_pk_fma_f32 v[104:105], v[130:131], v[44:45], v[104:105] op_sel:[1,1,0] op_sel_hi:[0,1,1] neg_hi:[1,0,0]
    v_cvt_pk_f16_f32 v113, v104, v105
    s_add_u32 s37, s50, 36864
    buffer_load_dwordx4 a[144:147], v3, s[4:7], s37 offen offset:0
    ds_write_b32 v8, v113 offset:1380
    v_pk_mul_f32 v[106:107], v[132:133], v[46:47] op_sel_hi:[1,0]
    v_pk_fma_f32 v[106:107], v[132:133], v[46:47], v[106:107] op_sel:[1,1,0] op_sel_hi:[0,1,1] neg_hi:[1,0,0]
    v_cvt_pk_f16_f32 v115, v106, v107
    ds_write_b32 v8, v115 offset:1540
q2e_kp_kernel_5:
    s_waitcnt lgkmcnt(0)
    s_barrier
    ds_read_b128 v[60:63], v9 offset:0
    ds_read_b128 v[72:75], v9 offset:2576
    ds_read_b128 v[16:19], v14 offset:2048
    ds_read_b128 v[28:31], v14 offset:5120
    ds_read_b128 v[40:43], v14 offset:8192
    ds_read_b128 v[64:67], v9 offset:64
    ds_read_b128 v[76:79], v9 offset:2640
    ds_read_b128 v[20:23], v14 offset:3072
    ds_read_b128 v[32:35], v14 offset:6144
    ds_read_b128 v[44:47], v14 offset:9216
    ds_read_b128 v[68:71], v10 offset:128
    ds_read_b128 v[80:83], v10 offset:2704
    ds_read_b128 v[24:27], v14 offset:4096
    ds_read_b128 v[36:39], v14 offset:7168
    ds_read_b128 v[84:87], v14 offset:10240
    s_add_u32 s37, s50, 36864
    buffer_load_dwordx4 a[148:151], v3, s[4:7], s37 offen offset:1024
    buffer_load_dwordx4 a[152:155], v3, s[4:7], s37 offen offset:2048
    v_permlane16_swap_b32 v48, v50
    buffer_load_dwordx4 a[156:159], v3, s[4:7], s37 offen offset:3072
    v_permlane16_swap_b32 v49, v51
    v_lshlrev_b32 v116, 16, v48
    v_and_b32 v117, 0xffff0000, v48
    v_lshlrev_b32 v118, 16, v49
    s_add_u32 s37, s50, 40960
    buffer_load_dwordx4 a[160:163], v3, s[4:7], s37 offen offset:0
    v_and_b32 v119, 0xffff0000, v49
    v_lshlrev_b32 v128, 16, v50
    v_and_b32 v129, 0xffff0000, v50
    v_lshlrev_b32 v130, 16, v51
    buffer_load_dwordx4 a[164:167], v3, s[4:7], s37 offen offset:1024
    v_and_b32 v131, 0xffff0000, v51
    v_permlane16_swap_b32 v52, v54
    v_permlane16_swap_b32 v53, v55
    v_lshlrev_b32 v120, 16, v52
    buffer_load_dwordx4 a[168:171], v3, s[4:7], s37 offen offset:2048
    v_and_b32 v121, 0xffff0000, v52
    v_lshlrev_b32 v122, 16, v53
    v_and_b32 v123, 0xffff0000, v53
    v_lshlrev_b32 v132, 16, v54
    buffer_load_dwordx4 a[172:175], v3, s[4:7], s37 offen offset:3072
    v_and_b32 v133, 0xffff0000, v54
    v_lshlrev_b32 v134, 16, v55
    v_and_b32 v135, 0xffff0000, v55
    v_permlane16_swap_b32 v56, v58
    s_add_u32 s37, s50, 45056
    buffer_load_dwordx4 a[176:179], v3, s[4:7], s37 offen offset:0
    v_permlane16_swap_b32 v57, v59
    v_lshlrev_b32 v124, 16, v56
    v_and_b32 v125, 0xffff0000, v56
    v_lshlrev_b32 v126, 16, v57
    buffer_load_dwordx4 a[180:183], v3, s[4:7], s37 offen offset:1024
    v_and_b32 v127, 0xffff0000, v57
    v_lshlrev_b32 v136, 16, v58
    v_and_b32 v137, 0xffff0000, v58
    v_lshlrev_b32 v138, 16, v59
    buffer_load_dwordx4 a[184:187], v3, s[4:7], s37 offen offset:2048
    v_and_b32 v139, 0xffff0000, v59
    s_waitcnt lgkmcnt(12)
    v_mfma_f32_16x16x32_f16 v[92:95], v[60:63], v[16:19], 0
    v_mfma_f32_16x16x32_f16 v[104:107], v[72:75], v[16:19], 0
    buffer_load_dwordx4 a[188:191], v3, s[4:7], s37 offen offset:3072
    s_waitcnt lgkmcnt(11)
    v_mfma_f32_16x16x32_f16 v[96:99], v[60:63], v[28:31], 0
    v_mfma_f32_16x16x32_f16 v[108:111], v[72:75], v[28:31], 0
    s_waitcnt lgkmcnt(10)
    s_add_u32 s37, s50, 49152
    buffer_load_dwordx4 a[192:195], v3, s[4:7], s37 offen offset:0
    v_mfma_f32_16x16x32_f16 v[100:103], v[60:63], v[40:43], 0
    buffer_load_dwordx4 a[196:199], v3, s[4:7], s37 offen offset:1024
    v_mfma_f32_16x16x32_f16 v[112:115], v[72:75], v[40:43], 0
    s_waitcnt lgkmcnt(7)
    v_mfma_f32_16x16x32_f16 v[92:95], v[64:67], v[20:23], v[92:95]
    v_mfma_f32_16x16x32_f16 v[104:107], v[76:79], v[20:23], v[104:107]
    buffer_load_dwordx4 a[200:203], v3, s[4:7], s37 offen offset:2048
    s_waitcnt lgkmcnt(6)
    v_mfma_f32_16x16x32_f16 v[96:99], v[64:67], v[32:35], v[96:99]
    v_mfma_f32_16x16x32_f16 v[108:111], v[76:79], v[32:35], v[108:111]
    s_waitcnt lgkmcnt(5)
    v_mfma_f32_16x16x32_f16 v[100:103], v[64:67], v[44:47], v[100:103]
    buffer_load_dwordx4 a[204:207], v3, s[4:7], s37 offen offset:3072
    v_mfma_f32_16x16x32_f16 v[112:115], v[76:79], v[44:47], v[112:115]
    s_waitcnt lgkmcnt(2)
    s_add_u32 s37, s50, 53248
    buffer_load_dwordx4 a[208:211], v3, s[4:7], s37 offen offset:0
    v_mfma_f32_16x16x32_f16 v[92:95], v[68:71], v[24:27], v[92:95]
    v_mfma_f32_16x16x32_f16 v[104:107], v[80:83], v[24:27], v[104:107]
    buffer_load_dwordx4 a[212:215], v3, s[4:7], s37 offen offset:1024
    s_waitcnt lgkmcnt(1)
    v_mfma_f32_16x16x32_f16 v[96:99], v[68:71], v[36:39], v[96:99]
    v_mfma_f32_16x16x32_f16 v[108:111], v[80:83], v[36:39], v[108:111]
    s_waitcnt lgkmcnt(0)
    v_mfma_f32_16x16x32_f16 v[100:103], v[68:71], v[84:87], v[100:103]
    buffer_load_dwordx4 a[216:219], v3, s[4:7], s37 offen offset:2048
    v_mfma_f32_16x16x32_f16 v[112:115], v[80:83], v[84:87], v[112:115]
    buffer_load_dwordx4 a[220:223], v3, s[4:7], s37 offen offset:3072
    s_mov_b32 s44, 0x41000000
    v_pk_fma_f32 v[92:93], v[92:93], s[44:45], v[116:117] op_sel_hi:[1,0,1]
    s_add_u32 s37, s50, 57344
    buffer_load_dwordx4 a[224:227], v3, s[4:7], s37 offen offset:0
    v_pk_fma_f32 v[104:105], v[104:105], s[44:45], v[128:129] op_sel_hi:[1,0,1]
    v_pk_fma_f32 v[94:95], v[94:95], s[44:45], v[118:119] op_sel_hi:[1,0,1]
    v_pk_fma_f32 v[106:107], v[106:107], s[44:45], v[130:131] op_sel_hi:[1,0,1]
    v_pk_fma_f32 v[96:97], v[96:97], s[44:45], v[120:121] op_sel_hi:[1,0,1]
    buffer_load_dwordx4 a[228:231], v3, s[4:7], s37 offen offset:1024
    v_pk_fma_f32 v[108:109], v[108:109], s[44:45], v[132:133] op_sel_hi:[1,0,1]
    v_pk_fma_f32 v[98:99], v[98:99], s[44:45], v[122:123] op_sel_hi:[1,0,1]
    v_pk_fma_f32 v[110:111], v[110:111], s[44:45], v[134:135] op_sel_hi:[1,0,1]
    v_pk_fma_f32 v[100:101], v[100:101], s[44:45], v[124:125] op_sel_hi:[1,0,1]
    buffer_load_dwordx4 a[232:235], v3, s[4:7], s37 offen offset:2048
    v_pk_fma_f32 v[112:113], v[112:113], s[44:45], v[136:137] op_sel_hi:[1,0,1]
    v_pk_fma_f32 v[102:103], v[102:103], s[44:45], v[126:127] op_sel_hi:[1,0,1]
    v_pk_fma_f32 v[114:115], v[114:115], s[44:45], v[138:139] op_sel_hi:[1,0,1]
    v_pk_mul_f32 v[52:53], v[92:93], v[92:93]
    v_pk_mul_f32 v[54:55], v[104:105], v[104:105]
    v_pk_add_f32 v[48:49], v[92:93], v[94:95]
    buffer_load_dwordx4 a[236:239], v3, s[4:7], s37 offen offset:3072
    v_pk_fma_f32 v[52:53], v[94:95], v[94:95], v[52:53]
    v_pk_add_f32 v[50:51], v[104:105], v[106:107]
    v_pk_fma_f32 v[54:55], v[106:107], v[106:107], v[54:55]
    v_pk_add_f32 v[48:49], v[48:49], v[96:97]
    v_pk_fma_f32 v[52:53], v[96:97], v[96:97], v[52:53]
    v_pk_add_f32 v[50:51], v[50:51], v[108:109]
    s_add_u32 s38, s52, 0
    buffer_load_dwordx4 v[140:143], v3, s[4:7], s38 offen offset:0
    v_pk_fma_f32 v[54:55], v[108:109], v[108:109], v[54:55]
    v_pk_add_f32 v[48:49], v[48:49], v[98:99]
    v_pk_fma_f32 v[52:53], v[98:99], v[98:99], v[52:53]
    v_pk_add_f32 v[50:51], v[50:51], v[110:111]
    v_pk_fma_f32 v[54:55], v[110:111], v[110:111], v[54:55]
    v_pk_add_f32 v[48:49], v[48:49], v[100:101]
    buffer_load_dwordx4 v[144:147], v3, s[4:7], s38 offen offset:1024
    v_pk_fma_f32 v[52:53], v[100:101], v[100:101], v[52:53]
    v_pk_add_f32 v[50:51], v[50:51], v[112:113]
    v_pk_fma_f32 v[54:55], v[112:113], v[112:113], v[54:55]
    v_pk_add_f32 v[48:49], v[48:49], v[102:103]
    v_pk_fma_f32 v[52:53], v[102:103], v[102:103], v[52:53]
    v_pk_add_f32 v[50:51], v[50:51], v[114:115]
    buffer_load_dwordx4 v[148:151], v3, s[4:7], s38 offen offset:2048
    v_pk_fma_f32 v[54:55], v[114:115], v[114:115], v[54:55]
    v_add_f32 v48, v48, v49
    v_add_f32 v50, v50, v51
    v_add_f32 v52, v52, v53
    v_add_f32 v54, v54, v55
    v_cvt_pk_bf16_f32 v60, v92, v93
    v_cvt_pk_bf16_f32 v61, v94, v95
    v_permlane32_swap_b32 v48, v50
    v_permlane32_swap_b32 v52, v54
    v_add_f32 v48, v48, v50
    v_add_f32 v52, v52, v54
    v_cvt_pk_bf16_f32 v62, v104, v105
    v_cvt_pk_bf16_f32 v63, v106, v107
    v_permlane16_swap_b32 v48, v52
    v_add_f32 v48, v48, v52
    v_cvt_pk_bf16_f32 v64, v96, v97
    v_cvt_pk_bf16_f32 v65, v98, v99
    v_add_f32_dpp v48, v48, v48 quad_perm:[1,0,3,2] row_mask:0xf bank_mask:0xf
    v_cvt_pk_bf16_f32 v66, v108, v109
    v_cvt_pk_bf16_f32 v67, v110, v111
    v_add_f32_dpp v48, v48, v48 quad_perm:[2,3,0,1] row_mask:0xf bank_mask:0xf
    v_cvt_pk_bf16_f32 v68, v100, v101
    v_cvt_pk_bf16_f32 v69, v102, v103
    v_add_f32_dpp v48, v48, v48 row_half_mirror row_mask:0xf bank_mask:0xf
    v_cvt_pk_bf16_f32 v70, v112, v113
    v_cvt_pk_bf16_f32 v71, v114, v115
    v_add_f32_dpp v48, v48, v48 row_mirror row_mask:0xf bank_mask:0xf
    v_mul_f32 v48, 0x3acccccd, v48
    v_mov_b32 v53, 0x3727c5ac
    v_readlane_b32 s46, v48, 0
    v_readlane_b32 s47, v48, 16
    v_readlane_b32 s48, v48, 32
    v_readlane_b32 s49, v48, 48
    v_mov_b32 v48, s46
    v_add_f32 v49, s47, v53
    v_mov_b32 v50, s48
    v_add_f32 v51, s49, v53
    v_fma_f32 v49, -v48, v48, v49
    v_fma_f32 v51, -v50, v50, v51
    v_max_f32 v49, v53, v49
    v_max_f32 v51, v53, v51
    v_rsq_f32 v49, v49
    v_rsq_f32 v51, v51
    s_add_u32 s30, s33, 2621440
    s_add_u32 s56, s33, 27262976
    v_mul_f32 v48, v48, v49
    v_mul_f32 v50, v50, v51
    v_pk_fma_f32 v[92:93], v[92:93], v[48:49], v[48:49] op_sel:[0,1,0] op_sel_hi:[1,1,0] neg_lo:[0,0,1] neg_hi:[0,0,1]
    v_pk_fma_f32 v[94:95], v[94:95], v[48:49], v[48:49] op_sel:[0,1,0] op_sel_hi:[1,1,0] neg_lo:[0,0,1] neg_hi:[0,0,1]
    v_pk_fma_f32 v[104:105], v[104:105], v[50:51], v[50:51] op_sel:[0,1,0] op_sel_hi:[1,1,0] neg_lo:[0,0,1] neg_hi:[0,0,1]
    v_pk_fma_f32 v[106:107], v[106:107], v[50:51], v[50:51] op_sel:[0,1,0] op_sel_hi:[1,1,0] neg_lo:[0,0,1] neg_hi:[0,0,1]
    v_cvt_pk_bf16_f32 v72, v92, v93
    v_cvt_pk_bf16_f32 v73, v94, v95
    v_cvt_pk_bf16_f32 v74, v104, v105
    v_cvt_pk_bf16_f32 v75, v106, v107
    s_nop 0
    v_permlane16_swap_b32 v72, v74
    v_permlane16_swap_b32 v73, v75
    s_waitcnt vmcnt(62)
    buffer_store_dwordx4 v[72:75], v13, s[4:7], s30 offen offset:0 sc1
    v_pk_fma_f32 v[96:97], v[96:97], v[48:49], v[48:49] op_sel:[0,1,0] op_sel_hi:[1,1,0] neg_lo:[0,0,1] neg_hi:[0,0,1]
    v_pk_fma_f32 v[98:99], v[98:99], v[48:49], v[48:49] op_sel:[0,1,0] op_sel_hi:[1,1,0] neg_lo:[0,0,1] neg_hi:[0,0,1]
    v_pk_fma_f32 v[108:109], v[108:109], v[50:51], v[50:51] op_sel:[0,1,0] op_sel_hi:[1,1,0] neg_lo:[0,0,1] neg_hi:[0,0,1]
    v_pk_fma_f32 v[110:111], v[110:111], v[50:51], v[50:51] op_sel:[0,1,0] op_sel_hi:[1,1,0] neg_lo:[0,0,1] neg_hi:[0,0,1]
    v_cvt_pk_bf16_f32 v76, v96, v97
    v_cvt_pk_bf16_f32 v77, v98, v99
    v_cvt_pk_bf16_f32 v78, v108, v109
    v_cvt_pk_bf16_f32 v79, v110, v111
    s_nop 0
    v_permlane16_swap_b32 v76, v78
    v_permlane16_swap_b32 v77, v79
    s_waitcnt vmcnt(62)
    buffer_store_dwordx4 v[76:79], v13, s[4:7], s30 offen offset:512 sc1
    v_pk_fma_f32 v[100:101], v[100:101], v[48:49], v[48:49] op_sel:[0,1,0] op_sel_hi:[1,1,0] neg_lo:[0,0,1] neg_hi:[0,0,1]
    v_pk_fma_f32 v[102:103], v[102:103], v[48:49], v[48:49] op_sel:[0,1,0] op_sel_hi:[1,1,0] neg_lo:[0,0,1] neg_hi:[0,0,1]
    v_pk_fma_f32 v[112:113], v[112:113], v[50:51], v[50:51] op_sel:[0,1,0] op_sel_hi:[1,1,0] neg_lo:[0,0,1] neg_hi:[0,0,1]
    v_pk_fma_f32 v[114:115], v[114:115], v[50:51], v[50:51] op_sel:[0,1,0] op_sel_hi:[1,1,0] neg_lo:[0,0,1] neg_hi:[0,0,1]
    v_cvt_pk_bf16_f32 v80, v100, v101
    v_cvt_pk_bf16_f32 v81, v102, v103
    v_cvt_pk_bf16_f32 v82, v112, v113
    v_cvt_pk_bf16_f32 v83, v114, v115
    s_nop 0
    v_permlane16_swap_b32 v80, v82
    v_permlane16_swap_b32 v81, v83
    s_waitcnt vmcnt(62)
    buffer_store_dwordx4 v[80:83], v15, s[4:7], s30 offen offset:1024 sc1
    s_waitcnt vmcnt(62)
    buffer_load_dwordx4 v[152:155], v3, s[4:7], s38 offen offset:3072
    s_add_u32 s38, s52, 4096
    s_waitcnt vmcnt(62)
    buffer_load_dwordx4 v[156:159], v3, s[4:7], s38 offen offset:0
    s_waitcnt vmcnt(62)
    buffer_load_dwordx4 v[160:163], v3, s[4:7], s38 offen offset:1024
    s_waitcnt vmcnt(62)
    buffer_load_dwordx4 v[164:167], v3, s[4:7], s38 offen offset:2048
    s_waitcnt vmcnt(62)
    buffer_load_dwordx4 v[168:171], v3, s[4:7], s38 offen offset:3072
    s_add_u32 s38, s52, 8192
    s_waitcnt vmcnt(62)
    buffer_load_dwordx4 v[172:175], v3, s[4:7], s38 offen offset:0
    s_waitcnt vmcnt(62)
    buffer_load_dwordx4 v[176:179], v3, s[4:7], s38 offen offset:1024
    s_waitcnt vmcnt(62)
    buffer_load_dwordx4 v[180:183], v3, s[4:7], s38 offen offset:2048
    s_waitcnt vmcnt(62)
    buffer_load_dwordx4 v[184:187], v3, s[4:7], s38 offen offset:3072
    s_add_u32 s38, s52, 12288
    s_waitcnt vmcnt(62)
    buffer_load_dwordx4 v[188:191], v3, s[4:7], s38 offen offset:0
    v_permlane16_swap_b32 v60, v62
    v_permlane16_swap_b32 v61, v63
    v_permlane16_swap_b32 v64, v66
    v_permlane16_swap_b32 v65, v67
    v_permlane16_swap_b32 v68, v70
    v_permlane16_swap_b32 v69, v71
    v_lshrrev_b32 v6, 3, v0
    v_and_b32 v7, 7, v0
    v_xor_b32 v7, v7, v6
    v_mul_u32_u24 v137, 1280, v6
    v_lshl_add_u32 v137, v7, 4, v137
    v_lshrrev_b32 v6, 4, v0
    v_and_b32 v7, 7, v0
    v_xor_b32 v6, v6, v7
    v_lshlrev_b32 v6, 4, v6
    v_lshl_add_u32 v6, v7, 7, v6
    v_bfe_u32 v7, v0, 3, 1
    v_lshl_add_u32 v1, v7, 10, v6
    v_xor_b32 v2, 64, v1
    v_and_b32 v0, 7, v0
    v_lshlrev_b32 v0, 2, v0
    v_mov_b32 v22, 1
    v_mov_b32 v138, v13
    v_mov_b32 v139, v15
    s_add_u32 s30, s33, 5242880
    s_lshr_b32 s26, s20, 1
    s_and_b32 s27, s20, 1
    s_mul_i32 s34, s22, 81920
    s_mul_i32 s29, s26, 10240
    s_add_u32 s28, s34, s29
    s_add_u32 s28, s28, 2621440
    s_mul_i32 s29, s27, 640
    s_add_u32 s39, s28, s29
    s_add_u32 s47, s39, 128
    s_add_u32 s90, s39, 256
    s_add_u32 s91, s39, 384
    s_add_u32 s58, s39, 512
    s_mul_i32 s29, s27, 10240
    s_lshl_b32 s31, s26, 10
    s_add_u32 s29, s29, s31
    s_mul_i32 s48, s20, 20480
    s_add_u32 s48, s48, s34
    s_mul_i32 s36, s21, 160
    s_add_u32 s48, s48, s36
    s_add_u32 s48, s48, 5242880
    s_lshl_b32 s31, s21, 2
    s_add_u32 s31, s31, s20
    s_mul_i32 s31, s31, 2560
    s_add_u32 s31, s31, s34
    s_add_u32 s31, s31, 7864320
    s_mov_b32 s32, 64
    s_lshl_b32 s33, s20, 11
    s_lshl_b32 s40, s22, 3
    s_add_u32 s41, s40, s21
    s_mul_i32 s41, s41, 24576
    s_add_u32 s41, s41, 10485760
    s_lshl_b32 s43, s20, 10
    s_add_u32 s41, s41, s43
    s_add_u32 s42, s41, 16384
    s_lshl_b32 s26, s20, 1
    s_add_u32 s26, s26, s40
    s_mul_i32 s26, s26, 24576
    s_add_u32 s26, s26, 10485760
    s_add_u32 s27, s26, 24576
    s_lshl_b32 s44, s22, 12
    s_add_u32 s44, s44, 25165824
    s_lshl_b32 s49, s21, 2
    s_add_u32 s49, s49, s44
    s_lshr_b32 s43, s21, 1
    s_lshl_b32 s43, s43, 5
    s_and_b32 s45, s21, 1
    s_lshl_b32 s45, s45, 2
    s_add_u32 s43, s43, s45
    s_add_u32 s43, s43, s20
    s_lshl_b32 s43, s43, 2
    s_add_u32 s43, s43, s44
    s_add_u32 s43, s43, 131072
    s_lshl_b32 s45, s20, 7
    s_add_u32 s45, s45, s44
    s_add_u32 s45, s45, 131072
    s_mov_b32 m0, s29
    s_waitcnt vmcnt(10)
    s_barrier
    s_cmp_lg_u32 s20, 0
    s_cbranch_scc1 nf_kp_kernel_6
    s_mov_b64 exec, 1
    buffer_store_dword v22, off, s[4:7], s49 sc1
    s_mov_b64 exec, -1
nf_kp_kernel_6:
    buffer_load_dwordx4 v[192:195], v3, s[4:7], s38 offen offset:1024
    buffer_load_dwordx4 v[196:199], v3, s[4:7], s38 offen offset:2048
    buffer_load_dwordx4 v[200:203], v3, s[4:7], s38 offen offset:3072
    s_add_u32 s38, s52, 16384
    buffer_load_dwordx4 v[204:207], v3, s[4:7], s38 offen offset:0
    buffer_load_dwordx4 v[208:211], v3, s[4:7], s38 offen offset:1024
    buffer_load_dwordx4 v[212:215], v3, s[4:7], s38 offen offset:2048
    buffer_load_dwordx4 v[216:219], v3, s[4:7], s38 offen offset:3072
    s_add_u32 s38, s52, 20480
    buffer_load_dwordx4 v[220:223], v3, s[4:7], s38 offen offset:0
    buffer_load_dwordx4 v[224:227], v3, s[4:7], s38 offen offset:1024
    buffer_load_dwordx4 v[228:231], v3, s[4:7], s38 offen offset:2048
    buffer_load_dwordx4 v[232:235], v3, s[4:7], s38 offen offset:3072
    s_add_u32 s38, s52, 24576
    buffer_load_dwordx4 v[236:239], v3, s[4:7], s38 offen offset:0
    s_cmp_lg_u32 s20, 0
    s_cbranch_scc1 ok1_kp_kernel_7
    s_mov_b32 s57, 0
sp_kp_kernel_8:
    s_buffer_load_dwordx8 s[92:99], s[4:7], s44 glc
    s_waitcnt lgkmcnt(0)
    s_min_u32 s92, s92, s93
    s_min_u32 s94, s94, s95
    s_min_u32 s96, s96, s97
    s_min_u32 s98, s98, s99
    s_min_u32 s92, s92, s94
    s_min_u32 s96, s96, s98
    s_min_u32 s92, s92, s96
    s_cmp_eq_u32 s92, 0
    s_cbranch_scc1 ag_kp_kernel_9
    s_branch ok1_kp_kernel_7
ag_kp_kernel_9:
    s_add_u32 s57, s57, 1
    s_cmp_lt_u32 s57, 48
    s_cbranch_scc1 sp_kp_kernel_8
    s_mov_b32 s57, 0
poll_kp_kernel_10:
    buffer_load_dword v22, v0, s[4:7], s44 offen sc1
    s_add_u32 s57, s57, 1
    s_waitcnt vmcnt(0)
    s_cmp_gt_u32 s57, 524288
    s_cbranch_scc1 ok1_kp_kernel_7
    v_cmp_gt_u32 vcc, 1, v22
    s_cbranch_vccnz poll_kp_kernel_10
ok1_kp_kernel_7:
    s_barrier
    buffer_load_dwordx4 v137, s[4:7], s39 offen sc1 lds
    s_add_u32 m0, m0, 2048
    s_nop 0
    buffer_load_dwordx4 v137, s[4:7], s47 offen sc1 lds
    s_add_u32 m0, m0, 2048
    s_nop 0
    buffer_load_dwordx4 v137, s[4:7], s90 offen sc1 lds
    s_add_u32 m0, m0, 2048
    s_nop 0
    buffer_load_dwordx4 v137, s[4:7], s91 offen sc1 lds
    s_add_u32 m0, m0, 2048
    s_nop 0
    buffer_load_dwordx4 v137, s[4:7], s58 offen sc1 lds
    v_add_u32 v137, 20480, v137
    s_add_u32 m0, m0, 12288
    s_nop 0
    buffer_load_dwordx4 v137, s[4:7], s39 offen sc1 lds
    s_add_u32 m0, m0, 2048
    s_nop 0
    buffer_load_dwordx4 v137, s[4:7], s47 offen sc1 lds
    s_add_u32 m0, m0, 2048
    s_nop 0
    buffer_load_dwordx4 v137, s[4:7], s90 offen sc1 lds
    s_add_u32 m0, m0, 2048
    s_nop 0
    buffer_load_dwordx4 v137, s[4:7], s91 offen sc1 lds
    s_add_u32 m0, m0, 2048
    s_nop 0
    buffer_load_dwordx4 v137, s[4:7], s58 offen sc1 lds
    v_add_u32 v137, 20480, v137
    s_add_u32 m0, m0, 12288
    s_nop 0
    buffer_load_dwordx4 v137, s[4:7], s39 offen sc1 lds
    s_add_u32 m0, m0, 2048
    s_waitcnt vmcnt(6)
    s_barrier
    ds_read_b128 v[4:7], v1 offset:0
    ds_read_b128 v[8:11], v2 offset:0
    ds_read_b128 v[12:15], v1 offset:2048
    ds_read_b128 v[16:19], v2 offset:2048
    s_waitcnt lgkmcnt(3)
    v_mfma_f32_16x16x32_bf16 v[20:23], a[0:3], v[4:7], 0
    buffer_load_dwordx4 v137, s[4:7], s47 offen sc1 lds
    s_add_u32 m0, m0, 2048
    v_mfma_f32_16x16x32_bf16 v[24:27], a[4:7], v[4:7], 0
    v_mfma_f32_16x16x32_bf16 v[28:31], a[8:11], v[4:7], 0
    ds_read_b128 v[4:7], v1 offset:4096
    s_waitcnt lgkmcnt(3)
    v_mfma_f32_16x16x32_bf16 v[20:23], a[12:15], v[8:11], v[20:23]
    v_mfma_f32_16x16x32_bf16 v[24:27], a[16:19], v[8:11], v[24:27]
    buffer_load_dwordx4 v137, s[4:7], s90 offen sc1 lds
    s_add_u32 m0, m0, 2048
    v_mfma_f32_16x16x32_bf16 v[28:31], a[20:23], v[8:11], v[28:31]
    ds_read_b128 v[8:11], v2 offset:4096
    s_waitcnt lgkmcnt(3)
    v_mfma_f32_16x16x32_bf16 v[20:23], a[24:27], v[12:15], v[20:23]
    v_mfma_f32_16x16x32_bf16 v[24:27], a[28:31], v[12:15], v[24:27]
    v_mfma_f32_16x16x32_bf16 v[28:31], a[32:35], v[12:15], v[28:31]
    buffer_load_dwordx4 v137, s[4:7], s91 offen sc1 lds
    s_add_u32 m0, m0, 2048
    ds_read_b128 v[12:15], v1 offset:6144
    s_waitcnt lgkmcnt(3)
    v_mfma_f32_16x16x32_bf16 v[20:23], a[36:39], v[16:19], v[20:23]
    v_mfma_f32_16x16x32_bf16 v[24:27], a[40:43], v[16:19], v[24:27]
    v_mfma_f32_16x16x32_bf16 v[28:31], a[44:47], v[16:19], v[28:31]
    ds_read_b128 v[16:19], v2 offset:6144
    s_waitcnt lgkmcnt(3)
    v_mfma_f32_16x16x32_bf16 v[20:23], a[48:51], v[4:7], v[20:23]
    buffer_load_dwordx4 v137, s[4:7], s58 offen sc1 lds
    v_add_u32 v137, 20480, v137
    s_add_u32 m0, m0, 12288
    v_mfma_f32_16x16x32_bf16 v[24:27], a[52:55], v[4:7], v[24:27]
    v_mfma_f32_16x16x32_bf16 v[28:31], a[56:59], v[4:7], v[28:31]
    ds_read_b128 v[4:7], v1 offset:8192
    s_waitcnt lgkmcnt(3)
    v_mfma_f32_16x16x32_bf16 v[20:23], a[60:63], v[8:11], v[20:23]
    v_mfma_f32_16x16x32_bf16 v[24:27], a[64:67], v[8:11], v[24:27]
    buffer_load_dwordx4 v137, s[4:7], s39 offen sc1 lds
    s_add_u32 m0, m0, 2048
    v_mfma_f32_16x16x32_bf16 v[28:31], a[68:71], v[8:11], v[28:31]
    ds_read_b128 v[8:11], v2 offset:8192
    s_waitcnt lgkmcnt(3)
    v_mfma_f32_16x16x32_bf16 v[20:23], a[72:75], v[12:15], v[20:23]
    v_mfma_f32_16x16x32_bf16 v[24:27], a[76:79], v[12:15], v[24:27]
    v_mfma_f32_16x16x32_bf16 v[28:31], a[80:83], v[12:15], v[28:31]
    buffer_load_dwordx4 v137, s[4:7], s47 offen sc1 lds
    s_add_u32 m0, m0, 2048
    ds_read_b128 v[12:15], v1 offset:10240
    s_waitcnt lgkmcnt(3)
    v_mfma_f32_16x16x32_bf16 v[20:23], a[84:87], v[16:19], v[20:23]
    v_mfma_f32_16x16x32_bf16 v[24:27], a[88:91], v[16:19], v[24:27]
    v_mfma_f32_16x16x32_bf16 v[28:31], a[92:95], v[16:19], v[28:31]
    ds_read_b128 v[16:19], v2 offset:10240
    s_waitcnt lgkmcnt(3)
    v_mfma_f32_16x16x32_bf16 v[20:23], a[96:99], v[4:7], v[20:23]
    buffer_load_dwordx4 v137, s[4:7], s90 offen sc1 lds
    s_add_u32 m0, m0, 2048
    v_mfma_f32_16x16x32_bf16 v[24:27], a[100:103], v[4:7], v[24:27]
    v_mfma_f32_16x16x32_bf16 v[28:31], a[104:107], v[4:7], v[28:31]
    ds_read_b128 v[4:7], v1 offset:12288
    s_waitcnt lgkmcnt(3)
    v_mfma_f32_16x16x32_bf16 v[20:23], a[108:111], v[8:11], v[20:23]
    v_mfma_f32_16x16x32_bf16 v[24:27], a[112:115], v[8:11], v[24:27]
    buffer_load_dwordx4 v137, s[4:7], s91 offen sc1 lds
    s_add_u32 m0, m0, 2048
    v_mfma_f32_16x16x32_bf16 v[28:31], a[116:119], v[8:11], v[28:31]
    ds_read_b128 v[8:11], v2 offset:12288
    s_waitcnt lgkmcnt(3)
    v_mfma_f32_16x16x32_bf16 v[20:23], a[120:123], v[12:15], v[20:23]
    v_mfma_f32_16x16x32_bf16 v[24:27], a[124:127], v[12:15], v[24:27]
    v_mfma_f32_16x16x32_bf16 v[28:31], a[128:131], v[12:15], v[28:31]
    buffer_load_dwordx4 v137, s[4:7], s58 offen sc1 lds
    ds_read_b128 v[12:15], v1 offset:14336
    s_waitcnt lgkmcnt(3)
    v_mfma_f32_16x16x32_bf16 v[20:23], a[132:135], v[16:19], v[20:23]
    v_mfma_f32_16x16x32_bf16 v[24:27], a[136:139], v[16:19], v[24:27]
    v_mfma_f32_16x16x32_bf16 v[28:31], a[140:143], v[16:19], v[28:31]
    ds_read_b128 v[16:19], v2 offset:14336
    s_waitcnt lgkmcnt(3)
    v_mfma_f32_16x16x32_bf16 v[20:23], a[144:147], v[4:7], v[20:23]
    buffer_store_dwordx4 v[60:63], v138, s[4:7], s30 offen offset:0 sc1
    v_mfma_f32_16x16x32_bf16 v[24:27], a[148:151], v[4:7], v[24:27]
    v_mfma_f32_16x16x32_bf16 v[28:31], a[152:155], v[4:7], v[28:31]
    ds_read_b128 v[4:7], v1 offset:16384
    s_waitcnt lgkmcnt(3)
    v_mfma_f32_16x16x32_bf16 v[20:23], a[156:159], v[8:11], v[20:23]
    v_mfma_f32_16x16x32_bf16 v[24:27], a[160:163], v[8:11], v[24:27]
    buffer_store_dwordx4 v[64:67], v138, s[4:7], s30 offen offset:512 sc1
    v_mfma_f32_16x16x32_bf16 v[28:31], a[164:167], v[8:11], v[28:31]
    ds_read_b128 v[8:11], v2 offset:16384
    s_waitcnt lgkmcnt(3)
    v_mfma_f32_16x16x32_bf16 v[20:23], a[168:171], v[12:15], v[20:23]
    v_mfma_f32_16x16x32_bf16 v[24:27], a[172:175], v[12:15], v[24:27]
    v_mfma_f32_16x16x32_bf16 v[28:31], a[176:179], v[12:15], v[28:31]
    buffer_store_dwordx4 v[68:71], v139, s[4:7], s30 offen offset:1024 sc1
    ds_read_b128 v[12:15], v1 offset:18432
    s_waitcnt lgkmcnt(3)
    v_mfma_f32_16x16x32_bf16 v[20:23], a[180:183], v[16:19], v[20:23]
    v_mfma_f32_16x16x32_bf16 v[24:27], a[184:187], v[16:19], v[24:27]
    v_mfma_f32_16x16x32_bf16 v[28:31], a[188:191], v[16:19], v[28:31]
    s_waitcnt vmcnt(13)
    s_barrier
    ds_read_b128 v[16:19], v2 offset:18432
    s_waitcnt lgkmcnt(3)
    v_mfma_f32_16x16x32_bf16 v[20:23], a[192:195], v[4:7], v[20:23]
    v_mov_b32 v138, 1
    buffer_load_dwordx4 v[240:243], v3, s[4:7], s38 offen offset:1024
    v_mfma_f32_16x16x32_bf16 v[24:27], a[196:199], v[4:7], v[24:27]
    v_mfma_f32_16x16x32_bf16 v[28:31], a[200:203], v[4:7], v[28:31]
    ds_read_b128 v[4:7], v1 offset:20480
    s_waitcnt lgkmcnt(3)
    v_mfma_f32_16x16x32_bf16 v[20:23], a[204:207], v[8:11], v[20:23]
    buffer_load_dwordx4 v[244:247], v3, s[4:7], s38 offen offset:2048
    v_mfma_f32_16x16x32_bf16 v[24:27], a[208:211], v[8:11], v[24:27]
    v_mfma_f32_16x16x32_bf16 v[28:31], a[212:215], v[8:11], v[28:31]
    ds_read_b128 v[8:11], v2 offset:20480
    s_waitcnt lgkmcnt(3)
    v_mfma_f32_16x16x32_bf16 v[20:23], a[216:219], v[12:15], v[20:23]
    v_mfma_f32_16x16x32_bf16 v[24:27], a[220:223], v[12:15], v[24:27]
    buffer_load_dwordx4 v[248:251], v3, s[4:7], s38 offen offset:3072
    v_mfma_f32_16x16x32_bf16 v[28:31], a[224:227], v[12:15], v[28:31]
    ds_read_b128 v[12:15], v1 offset:22528
    s_waitcnt lgkmcnt(3)
    v_mfma_f32_16x16x32_bf16 v[20:23], a[228:231], v[16:19], v[20:23]
    v_mfma_f32_16x16x32_bf16 v[24:27], a[232:235], v[16:19], v[24:27]
    v_mfma_f32_16x16x32_bf16 v[28:31], a[236:239], v[16:19], v[28:31]
    s_add_u32 s38, s52, 28672
    buffer_load_dwordx4 v[252:255], v3, s[4:7], s38 offen offset:0
    ds_read_b128 v[16:19], v2 offset:22528
    s_waitcnt lgkmcnt(3)
    v_mfma_f32_16x16x32_bf16 v[32:35], a[0:3], v[4:7], 0
    v_mfma_f32_16x16x32_bf16 v[36:39], a[4:7], v[4:7], 0
    v_mfma_f32_16x16x32_bf16 v[40:43], a[8:11], v[4:7], 0
    v_cvt_pk_bf16_f32 v44, v20, v21
    v_cvt_pk_bf16_f32 v45, v22, v23
    buffer_load_dwordx4 a[240:243], v3, s[4:7], s38 offen offset:1024
    ds_read_b128 v[4:7], v1 offset:24576
    s_waitcnt lgkmcnt(3)
    v_mfma_f32_16x16x32_bf16 v[32:35], a[12:15], v[8:11], v[32:35]
    v_cvt_pk_bf16_f32 v46, v24, v25
    v_cvt_pk_bf16_f32 v47, v26, v27
    v_mfma_f32_16x16x32_bf16 v[36:39], a[16:19], v[8:11], v[36:39]
    v_pk_max_i16 v44, v44, 0
    v_pk_max_i16 v45, v45, 0
    v_mfma_f32_16x16x32_bf16 v[40:43], a[20:23], v[8:11], v[40:43]
    v_pk_max_i16 v46, v46, 0
    v_pk_max_i16 v47, v47, 0
    ds_read_b128 v[8:11], v2 offset:24576
    s_waitcnt lgkmcnt(3)
    v_mfma_f32_16x16x32_bf16 v[32:35], a[24:27], v[12:15], v[32:35]
    v_cvt_pk_bf16_f32 v48, v28, v29
    v_cvt_pk_bf16_f32 v49, v30, v31
    buffer_load_dwordx4 a[244:247], v3, s[4:7], s38 offen offset:2048
    v_mfma_f32_16x16x32_bf16 v[36:39], a[28:31], v[12:15], v[36:39]
    buffer_store_dwordx4 v[44:47], v3, s[4:7], s41 offen sc1
    v_pk_max_i16 v48, v48, 0
    v_mfma_f32_16x16x32_bf16 v[40:43], a[32:35], v[12:15], v[40:43]
    v_pk_max_i16 v49, v49, 0
    ds_read_b128 v[12:15], v1 offset:26624
    s_waitcnt lgkmcnt(3)
    v_mfma_f32_16x16x32_bf16 v[32:35], a[36:39], v[16:19], v[32:35]
    s_add_u32 s41, s41, 4096
    v_mfma_f32_16x16x32_bf16 v[36:39], a[40:43], v[16:19], v[36:39]
    buffer_load_dwordx4 a[248:251], v3, s[4:7], s38 offen offset:3072
    v_mfma_f32_16x16x32_bf16 v[40:43], a[44:47], v[16:19], v[40:43]
    ds_read_b128 v[16:19], v2 offset:26624
    s_waitcnt lgkmcnt(3)
    v_mfma_f32_16x16x32_bf16 v[32:35], a[48:51], v[4:7], v[32:35]
    v_mfma_f32_16x16x32_bf16 v[36:39], a[52:55], v[4:7], v[36:39]
    v_mfma_f32_16x16x32_bf16 v[40:43], a[56:59], v[4:7], v[40:43]
    s_add_u32 s38, s52, 32768
    buffer_load_dwordx4 a[252:255], v3, s[4:7], s38 offen offset:0
    ds_read_b128 v[4:7], v1 offset:28672
    s_waitcnt lgkmcnt(3)
    v_mfma_f32_16x16x32_bf16 v[32:35], a[60:63], v[8:11], v[32:35]
    v_mfma_f32_16x16x32_bf16 v[36:39], a[64:67], v[8:11], v[36:39]
    v_mfma_f32_16x16x32_bf16 v[40:43], a[68:71], v[8:11], v[40:43]
    buffer_load_dwordx4 v[52:55], v3, s[4:7], s38 offen offset:1024
    ds_read_b128 v[8:11], v2 offset:28672
    s_waitcnt lgkmcnt(3)
    v_mfma_f32_16x16x32_bf16 v[32:35], a[72:75], v[12:15], v[32:35]
    v_mfma_f32_16x16x32_bf16 v[36:39], a[76:79], v[12:15], v[36:39]
    v_mfma_f32_16x16x32_bf16 v[40:43], a[80:83], v[12:15], v[40:43]
    ds_read_b128 v[12:15], v1 offset:30720
    s_waitcnt lgkmcnt(3)
    v_mfma_f32_16x16x32_bf16 v[32:35], a[84:87], v[16:19], v[32:35]
    buffer_load_dwordx4 v[56:59], v3, s[4:7], s38 offen offset:2048
    v_mfma_f32_16x16x32_bf16 v[36:39], a[88:91], v[16:19], v[36:39]
    v_mfma_f32_16x16x32_bf16 v[40:43], a[92:95], v[16:19], v[40:43]
    ds_read_b128 v[16:19], v2 offset:30720
    s_waitcnt lgkmcnt(3)
    v_mfma_f32_16x16x32_bf16 v[32:35], a[96:99], v[4:7], v[32:35]
    v_mfma_f32_16x16x32_bf16 v[36:39], a[100:103], v[4:7], v[36:39]
    buffer_load_dwordx4 v[60:63], v3, s[4:7], s38 offen offset:3072
    v_mfma_f32_16x16x32_bf16 v[40:43], a[104:107], v[4:7], v[40:43]
    ds_read_b128 v[4:7], v1 offset:32768
    s_waitcnt lgkmcnt(3)
    v_mfma_f32_16x16x32_bf16 v[32:35], a[108:111], v[8:11], v[32:35]
    v_mfma_f32_16x16x32_bf16 v[36:39], a[112:115], v[8:11], v[36:39]
    s_add_u32 s38, s52, 36864
    buffer_load_dwordx4 v[64:67], v3, s[4:7], s38 offen offset:0
    v_mfma_f32_16x16x32_bf16 v[40:43], a[116:119], v[8:11], v[40:43]
    ds_read_b128 v[8:11], v2 offset:32768
    s_waitcnt lgkmcnt(3)
    v_mfma_f32_16x16x32_bf16 v[32:35], a[120:123], v[12:15], v[32:35]
    v_mfma_f32_16x16x32_bf16 v[36:39], a[124:127], v[12:15], v[36:39]
    v_mfma_f32_16x16x32_bf16 v[40:43], a[128:131], v[12:15], v[40:43]
    buffer_load_dwordx4 v[68:71], v3, s[4:7], s38 offen offset:1024
    ds_read_b128 v[12:15], v1 offset:34816
    s_waitcnt lgkmcnt(3)
    v_mfma_f32_16x16x32_bf16 v[32:35], a[132:135], v[16:19], v[32:35]
    v_mfma_f32_16x16x32_bf16 v[36:39], a[136:139], v[16:19], v[36:39]
    v_mfma_f32_16x16x32_bf16 v[40:43], a[140:143], v[16:19], v[40:43]
    ds_read_b128 v[16:19], v2 offset:34816
    s_waitcnt lgkmcnt(3)
    v_mfma_f32_16x16x32_bf16 v[32:35], a[144:147], v[4:7], v[32:35]
    buffer_load_dwordx4 v[72:75], v3, s[4:7], s38 offen offset:2048
    v_mfma_f32_16x16x32_bf16 v[36:39], a[148:151], v[4:7], v[36:39]
    v_mfma_f32_16x16x32_bf16 v[40:43], a[152:155], v[4:7], v[40:43]
    ds_read_b128 v[4:7], v1 offset:36864
    s_waitcnt lgkmcnt(3)
    v_mfma_f32_16x16x32_bf16 v[32:35], a[156:159], v[8:11], v[32:35]
    v_mfma_f32_16x16x32_bf16 v[36:39], a[160:163], v[8:11], v[36:39]
    buffer_load_dwordx4 v[76:79], v3, s[4:7], s38 offen offset:3072
    v_mfma_f32_16x16x32_bf16 v[40:43], a[164:167], v[8:11], v[40:43]
    ds_read_b128 v[8:11], v2 offset:36864
    s_waitcnt lgkmcnt(3)
    v_mfma_f32_16x16x32_bf16 v[32:35], a[168:171], v[12:15], v[32:35]
    v_mfma_f32_16x16x32_bf16 v[36:39], a[172:175], v[12:15], v[36:39]
    s_add_u32 s38, s52, 40960
    buffer_load_dwordx4 v[80:83], v3, s[4:7], s38 offen offset:0
    v_mfma_f32_16x16x32_bf16 v[40:43], a[176:179], v[12:15], v[40:43]
    ds_read_b128 v[12:15], v1 offset:38912
    s_waitcnt lgkmcnt(3)
    v_mfma_f32_16x16x32_bf16 v[32:35], a[180:183], v[16:19], v[32:35]
    v_mfma_f32_16x16x32_bf16 v[36:39], a[184:187], v[16:19], v[36:39]
    v_mfma_f32_16x16x32_bf16 v[40:43], a[188:191], v[16:19], v[40:43]
    buffer_load_dwordx4 v[84:87], v3, s[4:7], s38 offen offset:1024
    s_waitcnt vmcnt(26)
    s_barrier
    ds_read_b128 v[16:19], v2 offset:38912
    s_waitcnt lgkmcnt(3)
    v_mfma_f32_16x16x32_bf16 v[32:35], a[192:195], v[4:7], v[32:35]
    v_mfma_f32_16x16x32_bf16 v[36:39], a[196:199], v[4:7], v[36:39]
    v_mfma_f32_16x16x32_bf16 v[40:43], a[200:203], v[4:7], v[40:43]
    ds_read_b128 v[4:7], v1 offset:40960
    s_waitcnt lgkmcnt(3)
    v_mfma_f32_16x16x32_bf16 v[32:35], a[204:207], v[8:11], v[32:35]
    buffer_load_dwordx4 v[88:91], v3, s[4:7], s38 offen offset:2048
    v_mfma_f32_16x16x32_bf16 v[36:39], a[208:211], v[8:11], v[36:39]
    v_mfma_f32_16x16x32_bf16 v[40:43], a[212:215], v[8:11], v[40:43]
    s_waitcnt vmcnt(12)
    s_mov_b64 exec, 1
    buffer_store_dword v138, off, s[4:7], s43 sc1
    s_mov_b64 exec, -1
    ds_read_b128 v[8:11], v2 offset:40960
    s_waitcnt lgkmcnt(3)
    v_mfma_f32_16x16x32_bf16 v[32:35], a[216:219], v[12:15], v[32:35]
    s_add_u32 s43, s43, 131072
    v_mfma_f32_16x16x32_bf16 v[36:39], a[220:223], v[12:15], v[36:39]
    buffer_load_dwordx4 v[92:95], v3, s[4:7], s38 offen offset:3072
    v_mfma_f32_16x16x32_bf16 v[40:43], a[224:227], v[12:15], v[40:43]
    ds_read_b128 v[12:15], v1 offset:43008
    s_waitcnt lgkmcnt(3)
    v_mfma_f32_16x16x32_bf16 v[32:35], a[228:231], v[16:19], v[32:35]
    v_mfma_f32_16x16x32_bf16 v[36:39], a[232:235], v[16:19], v[36:39]
    s_add_u32 s38, s52, 45056
    buffer_load_dwordx4 v[96:99], v3, s[4:7], s38 offen offset:0
    v_mfma_f32_16x16x32_bf16 v[40:43], a[236:239], v[16:19], v[40:43]
    ds_read_b128 v[16:19], v2 offset:43008
    s_waitcnt lgkmcnt(3)
    v_mfma_f32_16x16x32_bf16 v[20:23], a[0:3], v[4:7], 0
    v_mfma_f32_16x16x32_bf16 v[24:27], a[4:7], v[4:7], 0
    v_mfma_f32_16x16x32_bf16 v[28:31], a[8:11], v[4:7], 0
    v_cvt_pk_bf16_f32 v44, v32, v33
    v_cvt_pk_bf16_f32 v45, v34, v35
    buffer_load_dwordx4 v[100:103], v3, s[4:7], s38 offen offset:1024
    ds_read_b128 v[4:7], v1 offset:45056
    s_waitcnt lgkmcnt(3)
    v_mfma_f32_16x16x32_bf16 v[20:23], a[12:15], v[8:11], v[20:23]
    v_cvt_pk_bf16_f32 v46, v36, v37
    v_cvt_pk_bf16_f32 v47, v38, v39
    v_mfma_f32_16x16x32_bf16 v[24:27], a[16:19], v[8:11], v[24:27]
    v_pk_max_i16 v44, v44, 0
    v_pk_max_i16 v45, v45, 0
    v_mfma_f32_16x16x32_bf16 v[28:31], a[20:23], v[8:11], v[28:31]
    v_pk_max_i16 v46, v46, 0
    v_pk_max_i16 v47, v47, 0
    ds_read_b128 v[8:11], v2 offset:45056
    s_waitcnt lgkmcnt(3)
    v_mfma_f32_16x16x32_bf16 v[20:23], a[24:27], v[12:15], v[20:23]
    v_cvt_pk_bf16_f32 v50, v40, v41
    v_cvt_pk_bf16_f32 v51, v42, v43
    buffer_load_dwordx4 v[104:107], v3, s[4:7], s38 offen offset:2048
    v_mfma_f32_16x16x32_bf16 v[24:27], a[28:31], v[12:15], v[24:27]
    buffer_store_dwordx4 v[44:47], v3, s[4:7], s41 offen sc1
    v_pk_max_i16 v50, v50, 0
    v_mfma_f32_16x16x32_bf16 v[28:31], a[32:35], v[12:15], v[28:31]
    v_pk_max_i16 v51, v51, 0
    buffer_store_dwordx4 v[48:51], v3, s[4:7], s42 offen sc1
    ds_read_b128 v[12:15], v1 offset:47104
    s_waitcnt lgkmcnt(3)
    v_mfma_f32_16x16x32_bf16 v[20:23], a[36:39], v[16:19], v[20:23]
    s_add_u32 s41, s41, 4096
    s_add_u32 s42, s42, 4096
    buffer_load_dwordx4 v[108:111], v3, s[4:7], s38 offen offset:3072
    v_mfma_f32_16x16x32_bf16 v[24:27], a[40:43], v[16:19], v[24:27]
    v_mfma_f32_16x16x32_bf16 v[28:31], a[44:47], v[16:19], v[28:31]
    ds_read_b128 v[16:19], v2 offset:47104
    s_waitcnt lgkmcnt(3)
    v_mfma_f32_16x16x32_bf16 v[20:23], a[48:51], v[4:7], v[20:23]
    v_mfma_f32_16x16x32_bf16 v[24:27], a[52:55], v[4:7], v[24:27]
    s_add_u32 s38, s52, 49152
    buffer_load_dwordx4 v[112:115], v3, s[4:7], s38 offen offset:0
    v_mfma_f32_16x16x32_bf16 v[28:31], a[56:59], v[4:7], v[28:31]
    ds_read_b128 v[4:7], v1 offset:49152
    s_waitcnt lgkmcnt(3)
    v_mfma_f32_16x16x32_bf16 v[20:23], a[60:63], v[8:11], v[20:23]
    v_mfma_f32_16x16x32_bf16 v[24:27], a[64:67], v[8:11], v[24:27]
    v_mfma_f32_16x16x32_bf16 v[28:31], a[68:71], v[8:11], v[28:31]
    buffer_load_dwordx4 v[116:119], v3, s[4:7], s38 offen offset:1024
    ds_read_b128 v[8:11], v2 offset:49152
    s_waitcnt lgkmcnt(3)
    v_mfma_f32_16x16x32_bf16 v[20:23], a[72:75], v[12:15], v[20:23]
    v_mfma_f32_16x16x32_bf16 v[24:27], a[76:79], v[12:15], v[24:27]
    v_mfma_f32_16x16x32_bf16 v[28:31], a[80:83], v[12:15], v[28:31]
    ds_read_b128 v[12:15], v1 offset:51200
    s_waitcnt lgkmcnt(3)
    v_mfma_f32_16x16x32_bf16 v[20:23], a[84:87], v[16:19], v[20:23]
    buffer_load_dwordx4 v[120:123], v3, s[4:7], s38 offen offset:2048
    v_mfma_f32_16x16x32_bf16 v[24:27], a[88:91], v[16:19], v[24:27]
    v_mfma_f32_16x16x32_bf16 v[28:31], a[92:95], v[16:19], v[28:31]
    ds_read_b128 v[16:19], v2 offset:51200
    s_waitcnt lgkmcnt(3)
    v_mfma_f32_16x16x32_bf16 v[20:23], a[96:99], v[4:7], v[20:23]
    buffer_load_dwordx4 v[124:127], v3, s[4:7], s38 offen offset:3072
    v_mfma_f32_16x16x32_bf16 v[24:27], a[100:103], v[4:7], v[24:27]
    v_mfma_f32_16x16x32_bf16 v[28:31], a[104:107], v[4:7], v[28:31]
    s_buffer_load_dwordx8 s[92:99], s[4:7], s45 glc
    ds_read_b128 v[4:7], v1 offset:53248
    s_waitcnt lgkmcnt(3)
    v_mfma_f32_16x16x32_bf16 v[20:23], a[108:111], v[8:11], v[20:23]
    v_mfma_f32_16x16x32_bf16 v[24:27], a[112:115], v[8:11], v[24:27]
    s_add_u32 s38, s52, 53248
    buffer_load_dwordx4 v[128:131], v3, s[4:7], s38 offen offset:0
    v_mfma_f32_16x16x32_bf16 v[28:31], a[116:119], v[8:11], v[28:31]
    ds_read_b128 v[8:11], v2 offset:53248
    s_waitcnt lgkmcnt(3)
    v_mfma_f32_16x16x32_bf16 v[20:23], a[120:123], v[12:15], v[20:23]
    v_mfma_f32_16x16x32_bf16 v[24:27], a[124:127], v[12:15], v[24:27]
    v_mfma_f32_16x16x32_bf16 v[28:31], a[128:131], v[12:15], v[28:31]
    buffer_load_dwordx4 v[132:135], v3, s[4:7], s38 offen offset:1024
    ds_read_b128 v[12:15], v1 offset:55296
    s_waitcnt lgkmcnt(3)
    v_mfma_f32_16x16x32_bf16 v[20:23], a[132:135], v[16:19], v[20:23]
    v_mfma_f32_16x16x32_bf16 v[24:27], a[136:139], v[16:19], v[24:27]
    v_mfma_f32_16x16x32_bf16 v[28:31], a[140:143], v[16:19], v[28:31]
    ds_read_b128 v[16:19], v2 offset:55296
    s_waitcnt lgkmcnt(3)
    v_mfma_f32_16x16x32_bf16 v[20:23], a[144:147], v[4:7], v[20:23]
    v_mfma_f32_16x16x32_bf16 v[24:27], a[148:151], v[4:7], v[24:27]
    v_mfma_f32_16x16x32_bf16 v[28:31], a[152:155], v[4:7], v[28:31]
    ds_read_b128 v[4:7], v1 offset:57344
    s_waitcnt lgkmcnt(3)
    v_mfma_f32_16x16x32_bf16 v[20:23], a[156:159], v[8:11], v[20:23]
    v_mfma_f32_16x16x32_bf16 v[24:27], a[160:163], v[8:11], v[24:27]
    v_mfma_f32_16x16x32_bf16 v[28:31], a[164:167], v[8:11], v[28:31]
    ds_read_b128 v[8:11], v2 offset:57344
    s_waitcnt lgkmcnt(3)
    v_mfma_f32_16x16x32_bf16 v[20:23], a[168:171], v[12:15], v[20:23]
    v_mfma_f32_16x16x32_bf16 v[24:27], a[172:175], v[12:15], v[24:27]
    v_mfma_f32_16x16x32_bf16 v[28:31], a[176:179], v[12:15], v[28:31]
    ds_read_b128 v[12:15], v1 offset:59392
    s_waitcnt lgkmcnt(3)
    v_mfma_f32_16x16x32_bf16 v[20:23], a[180:183], v[16:19], v[20:23]
    v_mfma_f32_16x16x32_bf16 v[24:27], a[184:187], v[16:19], v[24:27]
    v_mfma_f32_16x16x32_bf16 v[28:31], a[188:191], v[16:19], v[28:31]
    s_barrier
    ds_read_b128 v[16:19], v2 offset:59392
    s_waitcnt lgkmcnt(3)
    v_mfma_f32_16x16x32_bf16 v[20:23], a[192:195], v[4:7], v[20:23]
    v_mfma_f32_16x16x32_bf16 v[24:27], a[196:199], v[4:7], v[24:27]
    v_mfma_f32_16x16x32_bf16 v[28:31], a[200:203], v[4:7], v[28:31]
    v_add_u32 v1, 61440, v1
    v_add_u32 v2, 61440, v2
    ds_read_b128 v[4:7], v1 offset:0
    s_waitcnt lgkmcnt(3)
    v_mfma_f32_16x16x32_bf16 v[20:23], a[204:207], v[8:11], v[20:23]
    v_mfma_f32_16x16x32_bf16 v[24:27], a[208:211], v[8:11], v[24:27]
    v_mfma_f32_16x16x32_bf16 v[28:31], a[212:215], v[8:11], v[28:31]
    s_waitcnt vmcnt(7)
    s_mov_b64 exec, 1
    buffer_store_dword v138, off, s[4:7], s43 sc1
    s_mov_b64 exec, -1
    ds_read_b128 v[8:11], v2 offset:0
    s_waitcnt lgkmcnt(3)
    v_mfma_f32_16x16x32_bf16 v[20:23], a[216:219], v[12:15], v[20:23]
    s_add_u32 s43, s43, 131072
    v_mfma_f32_16x16x32_bf16 v[24:27], a[220:223], v[12:15], v[24:27]
    v_mfma_f32_16x16x32_bf16 v[28:31], a[224:227], v[12:15], v[28:31]
    ds_read_b128 v[12:15], v1 offset:2048
    s_waitcnt lgkmcnt(3)
    v_mfma_f32_16x16x32_bf16 v[20:23], a[228:231], v[16:19], v[20:23]
    v_mfma_f32_16x16x32_bf16 v[24:27], a[232:235], v[16:19], v[24:27]
    v_mfma_f32_16x16x32_bf16 v[28:31], a[236:239], v[16:19], v[28:31]
    ds_read_b128 v[16:19], v2 offset:2048
    s_waitcnt lgkmcnt(3)
    v_mfma_f32_16x16x32_bf16 v[32:35], a[0:3], v[4:7], 0
    v_mfma_f32_16x16x32_bf16 v[36:39], a[4:7], v[4:7], 0
    v_mfma_f32_16x16x32_bf16 v[40:43], a[8:11], v[4:7], 0
    s_waitcnt lgkmcnt(0)
    s_min_u32 s92, s92, s93
    s_min_u32 s94, s94, s95
    s_min_u32 s96, s96, s97
    s_min_u32 s98, s98, s99
    s_min_u32 s92, s92, s94
    s_min_u32 s96, s96, s98
    s_min_u32 s92, s92, s96
    s_cmp_eq_u32 s92, 0
    s_cbranch_scc1 slow_kp_kernel_11
back_kp_kernel_12:
    s_add_u32 s45, s45, 131072
    buffer_load_dwordx4 a[0:3], v3, s[4:7], s26 offen offset:0 sc1
    ds_read_b128 v[4:7], v1 offset:4096
    s_waitcnt lgkmcnt(3)
    v_mfma_f32_16x16x32_bf16 v[32:35], a[12:15], v[8:11], v[32:35]
    v_cvt_pk_bf16_f32 v44, v20, v21
    v_cvt_pk_bf16_f32 v45, v22, v23
    v_mfma_f32_16x16x32_bf16 v[36:39], a[16:19], v[8:11], v[36:39]
    v_cvt_pk_bf16_f32 v46, v24, v25
    v_cvt_pk_bf16_f32 v47, v26, v27
    v_mfma_f32_16x16x32_bf16 v[40:43], a[20:23], v[8:11], v[40:43]
    v_pk_max_i16 v44, v44, 0
    v_pk_max_i16 v45, v45, 0
    ds_read_b128 v[8:11], v2 offset:4096
    s_waitcnt lgkmcnt(3)
    v_mfma_f32_16x16x32_bf16 v[32:35], a[24:27], v[12:15], v[32:35]
    buffer_load_dwordx4 a[4:7], v3, s[4:7], s26 offen offset:1024 sc1
    v_pk_max_i16 v46, v46, 0
    v_mfma_f32_16x16x32_bf16 v[36:39], a[28:31], v[12:15], v[36:39]
    v_pk_max_i16 v47, v47, 0
    v_cvt_pk_bf16_f32 v48, v28, v29
    v_mfma_f32_16x16x32_bf16 v[40:43], a[32:35], v[12:15], v[40:43]
    v_cvt_pk_bf16_f32 v49, v30, v31
    buffer_store_dwordx4 v[44:47], v3, s[4:7], s41 offen sc1
    ds_read_b128 v[12:15], v1 offset:6144
    s_waitcnt lgkmcnt(3)
    v_mfma_f32_16x16x32_bf16 v[32:35], a[36:39], v[16:19], v[32:35]
    v_pk_max_i16 v48, v48, 0
    v_pk_max_i16 v49, v49, 0
    v_mfma_f32_16x16x32_bf16 v[36:39], a[40:43], v[16:19], v[36:39]
    buffer_load_dwordx4 a[8:11], v3, s[4:7], s26 offen offset:2048 sc1
    s_add_u32 s41, s41, 4096
    v_mfma_f32_16x16x32_bf16 v[40:43], a[44:47], v[16:19], v[40:43]
    ds_read_b128 v[16:19], v2 offset:6144
    s_waitcnt lgkmcnt(3)
    v_mfma_f32_16x16x32_bf16 v[32:35], a[48:51], v[4:7], v[32:35]
    v_mfma_f32_16x16x32_bf16 v[36:39], a[52:55], v[4:7], v[36:39]
    v_mfma_f32_16x16x32_bf16 v[40:43], a[56:59], v[4:7], v[40:43]
    buffer_load_dwordx4 a[12:15], v3, s[4:7], s26 offen offset:3072 sc1
    ds_read_b128 v[4:7], v1 offset:8192
    s_waitcnt lgkmcnt(3)
    v_mfma_f32_16x16x32_bf16 v[32:35], a[60:63], v[8:11], v[32:35]
    v_mfma_f32_16x16x32_bf16 v[36:39], a[64:67], v[8:11], v[36:39]
    v_mfma_f32_16x16x32_bf16 v[40:43], a[68:71], v[8:11], v[40:43]
    ds_read_b128 v[8:11], v2 offset:8192
    s_waitcnt lgkmcnt(3)
    v_mfma_f32_16x16x32_bf16 v[32:35], a[72:75], v[12:15], v[32:35]
    buffer_load_dwordx4 a[16:19], v3, s[4:7], s27 offen offset:0 sc1
    v_mfma_f32_16x16x32_bf16 v[36:39], a[76:79], v[12:15], v[36:39]
    v_mfma_f32_16x16x32_bf16 v[40:43], a[80:83], v[12:15], v[40:43]
    ds_read_b128 v[12:15], v1 offset:10240
    s_waitcnt lgkmcnt(3)
    v_mfma_f32_16x16x32_bf16 v[32:35], a[84:87], v[16:19], v[32:35]
    v_mfma_f32_16x16x32_bf16 v[36:39], a[88:91], v[16:19], v[36:39]
    buffer_load_dwordx4 a[20:23], v3, s[4:7], s27 offen offset:1024 sc1
    v_mfma_f32_16x16x32_bf16 v[40:43], a[92:95], v[16:19], v[40:43]
    s_buffer_load_dwordx8 s[92:99], s[4:7], s45 glc
    ds_read_b128 v[16:19], v2 offset:10240
    s_waitcnt lgkmcnt(3)
    v_mfma_f32_16x16x32_bf16 v[32:35], a[96:99], v[4:7], v[32:35]
    v_mfma_f32_16x16x32_bf16 v[36:39], a[100:103], v[4:7], v[36:39]
    v_mfma_f32_16x16x32_bf16 v[40:43], a[104:107], v[4:7], v[40:43]
    buffer_load_dwordx4 a[24:27], v3, s[4:7], s27 offen offset:2048 sc1
    ds_read_b128 v[4:7], v1 offset:12288
    s_waitcnt lgkmcnt(3)
    v_mfma_f32_16x16x32_bf16 v[32:35], a[108:111], v[8:11], v[32:35]
    v_mfma_f32_16x16x32_bf16 v[36:39], a[112:115], v[8:11], v[36:39]
    v_mfma_f32_16x16x32_bf16 v[40:43], a[116:119], v[8:11], v[40:43]
    ds_read_b128 v[8:11], v2 offset:12288
    s_waitcnt lgkmcnt(3)
    v_mfma_f32_16x16x32_bf16 v[32:35], a[120:123], v[12:15], v[32:35]
    buffer_load_dwordx4 a[28:31], v3, s[4:7], s27 offen offset:3072 sc1
    v_mfma_f32_16x16x32_bf16 v[36:39], a[124:127], v[12:15], v[36:39]
    v_mfma_f32_16x16x32_bf16 v[40:43], a[128:131], v[12:15], v[40:43]
    ds_read_b128 v[12:15], v1 offset:14336
    s_waitcnt lgkmcnt(3)
    v_mfma_f32_16x16x32_bf16 v[32:35], a[132:135], v[16:19], v[32:35]
    s_add_u32 s26, s26, 4096
    s_add_u32 s27, s27, 4096
    v_mfma_f32_16x16x32_bf16 v[36:39], a[136:139], v[16:19], v[36:39]
    v_mfma_f32_16x16x32_bf16 v[40:43], a[140:143], v[16:19], v[40:43]
    ds_read_b128 v[16:19], v2 offset:14336
    s_waitcnt lgkmcnt(3)
    v_mfma_f32_16x16x32_bf16 v[32:35], a[144:147], v[4:7], v[32:35]
    v_mfma_f32_16x16x32_bf16 v[36:39], a[148:151], v[4:7], v[36:39]
    v_mfma_f32_16x16x32_bf16 v[40:43], a[152:155], v[4:7], v[40:43]
    buffer_load_dwordx4 a[32:35], v3, s[4:7], s38 offen offset:2048
    ds_read_b128 v[4:7], v1 offset:16384
    s_waitcnt lgkmcnt(3)
    v_mfma_f32_16x16x32_bf16 v[32:35], a[156:159], v[8:11], v[32:35]
    v_mfma_f32_16x16x32_bf16 v[36:39], a[160:163], v[8:11], v[36:39]
    v_mfma_f32_16x16x32_bf16 v[40:43], a[164:167], v[8:11], v[40:43]
    ds_read_b128 v[8:11], v2 offset:16384
    s_waitcnt lgkmcnt(3)
    v_mfma_f32_16x16x32_bf16 v[32:35], a[168:171], v[12:15], v[32:35]
    buffer_load_dwordx4 a[36:39], v3, s[4:7], s38 offen offset:3072
    v_mfma_f32_16x16x32_bf16 v[36:39], a[172:175], v[12:15], v[36:39]
    v_mfma_f32_16x16x32_bf16 v[40:43], a[176:179], v[12:15], v[40:43]
    ds_read_b128 v[12:15], v1 offset:18432
    s_waitcnt lgkmcnt(3)
    v_mfma_f32_16x16x32_bf16 v[32:35], a[180:183], v[16:19], v[32:35]
    v_mfma_f32_16x16x32_bf16 v[36:39], a[184:187], v[16:19], v[36:39]
    s_add_u32 s38, s52, 57344
    buffer_load_dwordx4 a[40:43], v3, s[4:7], s38 offen offset:0
    v_mfma_f32_16x16x32_bf16 v[40:43], a[188:191], v[16:19], v[40:43]
    ds_read_b128 v[16:19], v2 offset:18432
    s_waitcnt lgkmcnt(3)
    v_mfma_f32_16x16x32_bf16 v[32:35], a[192:195], v[4:7], v[32:35]
    v_mfma_f32_16x16x32_bf16 v[36:39], a[196:199], v[4:7], v[36:39]
    v_mfma_f32_16x16x32_bf16 v[40:43], a[200:203], v[4:7], v[40:43]
    buffer_load_dwordx4 a[44:47], v3, s[4:7], s38 offen offset:1024
    s_waitcnt lgkmcnt(2)
    v_mfma_f32_16x16x32_bf16 v[32:35], a[204:207], v[8:11], v[32:35]
    v_mfma_f32_16x16x32_bf16 v[36:39], a[208:211], v[8:11], v[36:39]
    v_mfma_f32_16x16x32_bf16 v[40:43], a[212:215], v[8:11], v[40:43]
    s_waitcnt lgkmcnt(1)
    v_mfma_f32_16x16x32_bf16 v[32:35], a[216:219], v[12:15], v[32:35]
    buffer_load_dwordx4 a[48:51], v3, s[4:7], s38 offen offset:2048
    s_waitcnt vmcnt(11)
    s_mov_b64 exec, 1
    buffer_store_dword v138, off, s[4:7], s43 sc1
    s_mov_b64 exec, -1
    v_mfma_f32_16x16x32_bf16 v[36:39], a[220:223], v[12:15], v[36:39]
    s_add_u32 s43, s43, 131072
    v_mfma_f32_16x16x32_bf16 v[40:43], a[224:227], v[12:15], v[40:43]
    s_waitcnt lgkmcnt(0)
    v_mfma_f32_16x16x32_bf16 v[32:35], a[228:231], v[16:19], v[32:35]
    v_mfma_f32_16x16x32_bf16 v[36:39], a[232:235], v[16:19], v[36:39]
    buffer_load_dwordx4 a[52:55], v3, s[4:7], s38 offen offset:3072
    v_mfma_f32_16x16x32_bf16 v[40:43], a[236:239], v[16:19], v[40:43]
    s_waitcnt lgkmcnt(0)
    s_min_u32 s92, s92, s93
    s_min_u32 s94, s94, s95
    s_min_u32 s96, s96, s97
    s_min_u32 s98, s98, s99
    s_min_u32 s92, s92, s94
    s_min_u32 s96, s96, s98
    s_min_u32 s92, s92, s96
    s_cmp_eq_u32 s92, 0
    s_cbranch_scc1 slow_kp_kernel_13
back_kp_kernel_14:
    s_add_u32 s45, s45, 131072
    buffer_load_dwordx4 a[60:63], v3, s[4:7], s26 offen offset:0 sc1
    v_mfma_f32_16x16x32_bf16 a[128:131], v[140:143], a[0:3], 0
    v_mfma_f32_16x16x32_bf16 a[132:135], v[144:147], a[0:3], 0
    v_mfma_f32_16x16x32_bf16 a[136:139], v[148:151], a[0:3], 0
    v_cvt_pk_bf16_f32 v44, v32, v33
    v_cvt_pk_bf16_f32 v45, v34, v35
    v_cvt_pk_bf16_f32 v46, v36, v37
    v_mfma_f32_16x16x32_bf16 a[140:143], v[152:155], a[0:3], 0
    buffer_load_dwordx4 a[64:67], v3, s[4:7], s26 offen offset:1024 sc1
    v_cvt_pk_bf16_f32 v47, v38, v39
    v_pk_max_i16 v44, v44, 0
    v_mfma_f32_16x16x32_bf16 a[144:147], v[156:159], a[0:3], 0
    v_pk_max_i16 v45, v45, 0
    v_pk_max_i16 v46, v46, 0
    v_pk_max_i16 v47, v47, 0
    v_mfma_f32_16x16x32_bf16 a[128:131], v[160:163], a[4:7], a[128:131]
    v_cvt_pk_bf16_f32 v50, v40, v41
    v_cvt_pk_bf16_f32 v51, v42, v43
    buffer_store_dwordx4 v[44:47], v3, s[4:7], s41 offen sc1
    v_mfma_f32_16x16x32_bf16 a[132:135], v[164:167], a[4:7], a[132:135]
    v_pk_max_i16 v50, v50, 0
    v_pk_max_i16 v51, v51, 0
    buffer_store_dwordx4 v[48:51], v3, s[4:7], s42 offen sc1
    v_mfma_f32_16x16x32_bf16 a[136:139], v[168:171], a[4:7], a[136:139]
    buffer_load_dwordx4 a[68:71], v3, s[4:7], s26 offen offset:2048 sc1
    s_add_u32 s41, s41, 4096
    v_mfma_f32_16x16x32_bf16 a[140:143], v[172:175], a[4:7], a[140:143]
    s_add_u32 s42, s42, 4096
    v_mfma_f32_16x16x32_bf16 a[144:147], v[176:179], a[4:7], a[144:147]
    s_waitcnt vmcnt(17)
    v_mfma_f32_16x16x32_bf16 a[128:131], v[180:183], a[8:11], a[128:131]
    v_mfma_f32_16x16x32_bf16 a[132:135], v[184:187], a[8:11], a[132:135]
    buffer_load_dwordx4 a[72:75], v3, s[4:7], s26 offen offset:3072 sc1
    v_mfma_f32_16x16x32_bf16 a[136:139], v[188:191], a[8:11], a[136:139]
    v_mfma_f32_16x16x32_bf16 a[140:143], v[192:195], a[8:11], a[140:143]
    v_mfma_f32_16x16x32_bf16 a[144:147], v[196:199], a[8:11], a[144:147]
    s_waitcnt vmcnt(17)
    v_mfma_f32_16x16x32_bf16 a[128:131], v[200:203], a[12:15], a[128:131]
    buffer_load_dwordx4 a[76:79], v3, s[4:7], s27 offen offset:0 sc1
    v_mfma_f32_16x16x32_bf16 a[132:135], v[204:207], a[12:15], a[132:135]
    v_mfma_f32_16x16x32_bf16 a[136:139], v[208:211], a[12:15], a[136:139]
    v_mfma_f32_16x16x32_bf16 a[140:143], v[212:215], a[12:15], a[140:143]
    v_mfma_f32_16x16x32_bf16 a[144:147], v[216:219], a[12:15], a[144:147]
    buffer_load_dwordx4 a[80:83], v3, s[4:7], s27 offen offset:1024 sc1
    s_waitcnt vmcnt(18)
    v_mfma_f32_16x16x32_bf16 a[128:131], a[244:247], a[16:19], a[128:131]
    v_mfma_f32_16x16x32_bf16 a[132:135], a[248:251], a[16:19], a[132:135]
    v_mfma_f32_16x16x32_bf16 a[136:139], a[252:255], a[16:19], a[136:139]
    v_bfe_u32 v39, v3, 4, 4
    v_mfma_f32_16x16x32_bf16 a[140:143], v[52:55], a[16:19], a[140:143]
    buffer_load_dwordx4 a[84:87], v3, s[4:7], s27 offen offset:2048 sc1
    v_mfma_f32_16x16x32_bf16 a[144:147], v[56:59], a[16:19], a[144:147]
    s_buffer_load_dwordx8 s[92:99], s[4:7], s45 glc
    s_waitcnt vmcnt(18)
    v_mfma_f32_16x16x32_bf16 a[128:131], v[60:63], a[20:23], a[128:131]
    v_bfe_u32 v38, v3, 8, 1
    v_mfma_f32_16x16x32_bf16 a[132:135], v[64:67], a[20:23], a[132:135]
    v_lshrrev_b32 v37, 9, v3
    v_mfma_f32_16x16x32_bf16 a[136:139], v[68:71], a[20:23], a[136:139]
    buffer_load_dwordx4 a[88:91], v3, s[4:7], s27 offen offset:3072 sc1
    v_mfma_f32_16x16x32_bf16 a[140:143], v[72:75], a[20:23], a[140:143]
    v_lshlrev_b32 v37, 4, v37
    v_mfma_f32_16x16x32_bf16 a[144:147], v[76:79], a[20:23], a[144:147]
    v_lshl_add_u32 v38, v38, 5, v37
    s_waitcnt vmcnt(18)
    v_mfma_f32_16x16x32_bf16 a[128:131], v[80:83], a[24:27], a[128:131]
    s_add_u32 s26, s26, 4096
    s_add_u32 s27, s27, 4096
    v_mfma_f32_16x16x32_bf16 a[132:135], v[84:87], a[24:27], a[132:135]
    s_add_u32 s46, s26, 8192
    buffer_load_dwordx4 v[4:7], v3, s[4:7], s46 offen offset:0 sc1
    v_mfma_f32_16x16x32_bf16 a[136:139], v[88:91], a[24:27], a[136:139]
    v_mul_u32_u24 v37, 1280, v39
    v_mfma_f32_16x16x32_bf16 a[140:143], v[92:95], a[24:27], a[140:143]
    v_lshrrev_b32 v36, 8, v3
    v_mfma_f32_16x16x32_bf16 a[144:147], v[96:99], a[24:27], a[144:147]
    v_lshl_add_u32 v50, v36, 3, v37
    s_waitcnt vmcnt(18)
    v_mfma_f32_16x16x32_bf16 a[128:131], v[100:103], a[28:31], a[128:131]
    buffer_load_dwordx4 v[8:11], v3, s[4:7], s46 offen offset:1024 sc1
    v_mfma_f32_16x16x32_bf16 a[132:135], v[104:107], a[28:31], a[132:135]
    v_add_u32 v37, v37, v38
    v_mfma_f32_16x16x32_bf16 a[136:139], v[108:111], a[28:31], a[136:139]
    v_mul_lo_u32 v51, v39, s32
    v_mfma_f32_16x16x32_bf16 a[140:143], v[112:115], a[28:31], a[140:143]
    v_add_u32 v38, v51, v38
    v_mfma_f32_16x16x32_bf16 a[144:147], v[116:119], a[28:31], a[144:147]
    buffer_load_dwordx4 v[12:15], v3, s[4:7], s46 offen offset:2048 sc1
    s_waitcnt vmcnt(12)
    v_mfma_f32_16x16x32_bf16 a[148:151], v[140:143], a[60:63], 0
    v_lshrrev_b32 v51, 1, v51
    v_mfma_f32_16x16x32_bf16 a[152:155], v[144:147], a[60:63], 0
    v_lshl_add_u32 v51, v36, 3, v51
    v_mfma_f32_16x16x32_bf16 a[156:159], v[148:151], a[60:63], 0
    v_mfma_f32_16x16x32_bf16 a[160:163], v[152:155], a[60:63], 0
    buffer_load_dwordx4 v[16:19], v3, s[4:7], s46 offen offset:3072 sc1
    v_mfma_f32_16x16x32_bf16 a[164:167], v[156:159], a[60:63], 0
    s_waitcnt vmcnt(12)
    v_mfma_f32_16x16x32_bf16 a[148:151], v[160:163], a[64:67], a[148:151]
    v_mfma_f32_16x16x32_bf16 a[152:155], v[164:167], a[64:67], a[152:155]
    v_mfma_f32_16x16x32_bf16 a[156:159], v[168:171], a[64:67], a[156:159]
    s_add_u32 s46, s27, 8192
    buffer_load_dwordx4 v[20:23], v3, s[4:7], s46 offen offset:0 sc1
    v_mfma_f32_16x16x32_bf16 a[160:163], v[172:175], a[64:67], a[160:163]
    v_mfma_f32_16x16x32_bf16 a[164:167], v[176:179], a[64:67], a[164:167]
    s_waitcnt vmcnt(10)
    v_mfma_f32_16x16x32_bf16 a[148:151], v[180:183], a[68:71], a[148:151]
    v_mfma_f32_16x16x32_bf16 a[152:155], v[184:187], a[68:71], a[152:155]
    buffer_load_dwordx4 v[24:27], v3, s[4:7], s46 offen offset:1024 sc1
    s_mov_b64 exec, 1
    buffer_store_dword v138, off, s[4:7], s43 sc1
    s_mov_b64 exec, -1
    v_mfma_f32_16x16x32_bf16 a[156:159], v[188:191], a[68:71], a[156:159]
    s_add_u32 s43, s43, 131072
    v_mfma_f32_16x16x32_bf16 a[160:163], v[192:195], a[68:71], a[160:163]
    v_mfma_f32_16x16x32_bf16 a[164:167], v[196:199], a[68:71], a[164:167]
    s_waitcnt vmcnt(11)
    v_mfma_f32_16x16x32_bf16 a[148:151], v[200:203], a[72:75], a[148:151]
    buffer_load_dwordx4 v[28:31], v3, s[4:7], s46 offen offset:2048 sc1
    v_mfma_f32_16x16x32_bf16 a[152:155], v[204:207], a[72:75], a[152:155]
    v_mfma_f32_16x16x32_bf16 a[156:159], v[208:211], a[72:75], a[156:159]
    v_mfma_f32_16x16x32_bf16 a[160:163], v[212:215], a[72:75], a[160:163]
    v_mfma_f32_16x16x32_bf16 a[164:167], v[216:219], a[72:75], a[164:167]
    buffer_load_dwordx4 v[32:35], v3, s[4:7], s46 offen offset:3072 sc1
    s_waitcnt vmcnt(12)
    v_mfma_f32_16x16x32_bf16 a[148:151], a[244:247], a[76:79], a[148:151]
    s_waitcnt lgkmcnt(0)
    s_min_u32 s92, s92, s93
    s_min_u32 s94, s94, s95
    s_min_u32 s96, s96, s97
    s_min_u32 s98, s98, s99
    s_min_u32 s92, s92, s94
    s_min_u32 s96, s96, s98
    s_min_u32 s92, s92, s96
    s_cmp_eq_u32 s92, 0
    s_cbranch_scc1 slow_kp_kernel_15
back_kp_kernel_16:
    s_add_u32 s45, s45, 131072
    buffer_load_dwordx4 a[0:3], v3, s[4:7], s26 offen offset:0 sc1
    v_mfma_f32_16x16x32_bf16 a[152:155], a[248:251], a[76:79], a[152:155]
    v_bfe_u32 v137, v3, 5, 3
    v_mfma_f32_16x16x32_bf16 a[156:159], a[252:255], a[76:79], a[156:159]
    v_mul_u32_u24 v137, 81920, v137
    v_mfma_f32_16x16x32_bf16 a[160:163], v[52:55], a[76:79], a[160:163]
    v_and_b32 v139, 16, v3
    v_mfma_f32_16x16x32_bf16 a[164:167], v[56:59], a[76:79], a[164:167]
    buffer_load_dwordx4 a[4:7], v3, s[4:7], s26 offen offset:1024 sc1
    s_waitcnt vmcnt(13)
    v_mfma_f32_16x16x32_bf16 a[148:151], v[60:63], a[80:83], a[148:151]
    v_add_u32 v137, v137, v139
    v_mfma_f32_16x16x32_bf16 a[152:155], v[64:67], a[80:83], a[152:155]
    v_bfe_u32 v44, v3, 8, 1
    v_mfma_f32_16x16x32_bf16 a[156:159], v[68:71], a[80:83], a[156:159]
    v_lshl_add_u32 v139, v44, 5, v137
    v_mfma_f32_16x16x32_bf16 a[160:163], v[72:75], a[80:83], a[160:163]
    buffer_load_dwordx4 a[8:11], v3, s[4:7], s26 offen offset:2048 sc1
    v_mfma_f32_16x16x32_bf16 a[164:167], v[76:79], a[80:83], a[164:167]
    v_lshrrev_b32 v44, 9, v3
    s_waitcnt vmcnt(13)
    v_mfma_f32_16x16x32_bf16 a[148:151], v[80:83], a[84:87], a[148:151]
    v_lshl_add_u32 v139, v44, 3, v139
    v_mfma_f32_16x16x32_bf16 a[152:155], v[84:87], a[84:87], a[152:155]
    v_lshrrev_b32 v44, 8, v3
    v_mfma_f32_16x16x32_bf16 a[156:159], v[88:91], a[84:87], a[156:159]
    buffer_load_dwordx4 a[12:15], v3, s[4:7], s26 offen offset:3072 sc1
    v_mfma_f32_16x16x32_bf16 a[160:163], v[92:95], a[84:87], a[160:163]
    v_lshl_add_u32 v137, v44, 5, v137
    v_mfma_f32_16x16x32_bf16 a[164:167], v[96:99], a[84:87], a[164:167]
    v_mov_b32 v44, -1
    s_waitcnt vmcnt(13)
    v_mfma_f32_16x16x32_bf16 a[148:151], v[100:103], a[88:91], a[148:151]
    v_mov_b32 v45, -1
    v_mfma_f32_16x16x32_bf16 a[152:155], v[104:107], a[88:91], a[152:155]
    buffer_load_dwordx4 a[16:19], v3, s[4:7], s27 offen offset:0 sc1
    v_mfma_f32_16x16x32_bf16 a[156:159], v[108:111], a[88:91], a[156:159]
    v_mov_b32 v46, -1
    s_waitcnt vmcnt(12)
    v_mfma_f32_16x16x32_bf16 a[160:163], v[112:115], a[88:91], a[160:163]
    v_mov_b32 v47, -1
    v_swap_b32 v6, v8
    v_swap_b32 v7, v9
    v_mfma_f32_16x16x32_bf16 a[164:167], v[116:119], a[88:91], a[164:167]
    s_mul_i32 s54, s20, 655360
    s_lshl_b32 s55, s23, 3
    s_add_u32 s55, s55, s21
    s_lshl_b32 s55, s55, 6
    v_mfma_f32_16x16x32_bf16 a[128:131], v[220:223], v[4:7], a[128:131]
    buffer_load_dwordx4 a[20:23], v3, s[4:7], s27 offen offset:1024 sc1
    v_mfma_f32_16x16x32_bf16 a[132:135], v[224:227], v[4:7], a[132:135]
    s_buffer_load_dwordx8 s[92:99], s[4:7], s45 glc
    v_mfma_f32_16x16x32_bf16 a[136:139], v[228:231], v[4:7], a[136:139]
    s_add_u32 s54, s54, 22020096
    s_add_u32 s56, s54, s55
    s_add_u32 s54, s56, s55
    s_add_u32 s55, s54, 32768
    s_add_u32 s56, s56, 65536
    s_waitcnt vmcnt(11)
    v_mfma_f32_16x16x32_bf16 a[140:143], v[232:235], v[4:7], a[140:143]
    v_swap_b32 v14, v16
    v_swap_b32 v15, v17
    v_mfma_f32_16x16x32_bf16 a[144:147], v[236:239], v[4:7], a[144:147]
    buffer_load_dwordx4 a[24:27], v3, s[4:7], s27 offen offset:2048 sc1
    v_mfma_f32_16x16x32_bf16 a[128:131], v[240:243], v[12:15], a[128:131]
    v_mfma_f32_16x16x32_bf16 a[132:135], v[244:247], v[12:15], a[132:135]
    v_mfma_f32_16x16x32_bf16 a[136:139], v[248:251], v[12:15], a[136:139]
    s_waitcnt vmcnt(10)
    v_mfma_f32_16x16x32_bf16 a[140:143], v[252:255], v[12:15], a[140:143]
    buffer_load_dwordx4 a[28:31], v3, s[4:7], s27 offen offset:3072 sc1
    v_swap_b32 v22, v24
    v_swap_b32 v23, v25
    v_mfma_f32_16x16x32_bf16 a[144:147], a[240:243], v[12:15], a[144:147]
    s_nop 0
    v_mfma_f32_16x16x32_bf16 a[128:131], v[120:123], v[20:23], a[128:131]
    v_mfma_f32_16x16x32_bf16 a[132:135], v[124:127], v[20:23], a[132:135]
    s_add_u32 s26, s26, 4096
    s_add_u32 s27, s27, 4096
    v_mfma_f32_16x16x32_bf16 a[136:139], v[128:131], v[20:23], a[136:139]
    s_waitcnt vmcnt(8)
    v_mfma_f32_16x16x32_bf16 a[140:143], v[132:135], v[20:23], a[140:143]
    v_swap_b32 v30, v32
    v_swap_b32 v31, v33
    v_mfma_f32_16x16x32_bf16 a[144:147], a[32:35], v[20:23], a[144:147]
    buffer_store_dwordx4 v[44:47], v137, s[4:7], s54 offen sc1
    v_mfma_f32_16x16x32_bf16 a[128:131], a[36:39], v[28:31], a[128:131]
    v_mfma_f32_16x16x32_bf16 a[132:135], a[40:43], v[28:31], a[132:135]
    v_mfma_f32_16x16x32_bf16 a[136:139], a[44:47], v[28:31], a[136:139]
    v_mfma_f32_16x16x32_bf16 a[140:143], a[48:51], v[28:31], a[140:143]
    v_mfma_f32_16x16x32_bf16 a[144:147], a[52:55], v[28:31], a[144:147]
    buffer_store_dwordx4 v[44:47], v137, s[4:7], s55 offen sc1
    v_mfma_f32_16x16x32_bf16 a[148:151], v[220:223], v[8:11], a[148:151]
    s_sub_u32 s34, s20, 1
    s_and_b32 s34, s34, 3
    s_mul_i32 s34, s34, 5120
    s_add_u32 s34, s34, 81920
    v_add_u32 v36, s34, v3
    v_mfma_f32_16x16x32_bf16 a[152:155], v[224:227], v[8:11], a[152:155]
    v_mfma_f32_16x16x32_bf16 a[156:159], v[228:231], v[8:11], a[156:159]
    v_mfma_f32_16x16x32_bf16 a[160:163], v[232:235], v[8:11], a[160:163]
    v_mfma_f32_16x16x32_bf16 a[164:167], v[236:239], v[8:11], a[164:167]
    buffer_store_dwordx2 v[44:45], v139, s[4:7], s56 offen sc1
    ds_write_b128 v36, a[128:131] offset:0
    v_mfma_f32_16x16x32_bf16 a[148:151], v[240:243], v[16:19], a[148:151]
    v_mfma_f32_16x16x32_bf16 a[152:155], v[244:247], v[16:19], a[152:155]
    v_mfma_f32_16x16x32_bf16 a[156:159], v[248:251], v[16:19], a[156:159]
    ds_write_b128 v36, a[132:135] offset:1024
    v_mfma_f32_16x16x32_bf16 a[160:163], v[252:255], v[16:19], a[160:163]
    v_mfma_f32_16x16x32_bf16 a[164:167], a[240:243], v[16:19], a[164:167]
    v_mfma_f32_16x16x32_bf16 a[148:151], v[120:123], v[24:27], a[148:151]
    ds_write_b128 v36, a[136:139] offset:2048
    v_mfma_f32_16x16x32_bf16 a[152:155], v[124:127], v[24:27], a[152:155]
    v_mfma_f32_16x16x32_bf16 a[156:159], v[128:131], v[24:27], a[156:159]
    v_mfma_f32_16x16x32_bf16 a[160:163], v[132:135], v[24:27], a[160:163]
    ds_write_b128 v36, a[140:143] offset:3072
    v_mfma_f32_16x16x32_bf16 a[164:167], a[32:35], v[24:27], a[164:167]
    v_mfma_f32_16x16x32_bf16 a[148:151], a[36:39], v[32:35], a[148:151]
    v_mfma_f32_16x16x32_bf16 a[152:155], a[40:43], v[32:35], a[152:155]
    ds_write_b128 v36, a[144:147] offset:4096
    v_mfma_f32_16x16x32_bf16 a[156:159], a[44:47], v[32:35], a[156:159]
    s_waitcnt lgkmcnt(0)
    s_min_u32 s92, s92, s93
    s_min_u32 s94, s94, s95
    s_min_u32 s96, s96, s97
    s_min_u32 s98, s98, s99
    s_min_u32 s92, s92, s94
    s_min_u32 s96, s96, s98
    s_min_u32 s92, s92, s96
    s_cmp_eq_u32 s92, 0
    s_cbranch_scc1 slow_kp_kernel_17
back_kp_kernel_18:
    s_add_u32 s45, s45, 131072
    buffer_load_dwordx4 a[60:63], v3, s[4:7], s26 offen offset:0 sc1
    v_mfma_f32_16x16x32_bf16 a[160:163], a[48:51], v[32:35], a[160:163]
    v_mfma_f32_16x16x32_bf16 a[164:167], a[52:55], v[32:35], a[164:167]
    s_waitcnt vmcnt(11)
    v_mfma_f32_16x16x32_bf16 a[168:171], v[140:143], a[0:3], 0
    s_sub_u32 s34, s20, 2
    s_and_b32 s34, s34, 3
    s_mul_i32 s34, s34, 5120
    s_add_u32 s34, s34, 102400
    v_add_u32 v36, s34, v3
    v_mfma_f32_16x16x32_bf16 a[172:175], v[144:147], a[0:3], 0
    buffer_load_dwordx4 a[64:67], v3, s[4:7], s26 offen offset:1024 sc1
    v_mfma_f32_16x16x32_bf16 a[176:179], v[148:151], a[0:3], 0
    v_mfma_f32_16x16x32_bf16 a[180:183], v[152:155], a[0:3], 0
    v_mfma_f32_16x16x32_bf16 a[184:187], v[156:159], a[0:3], 0
    ds_write_b128 v36, a[148:151] offset:0
    s_waitcnt vmcnt(11)
    v_mfma_f32_16x16x32_bf16 a[168:171], v[160:163], a[4:7], a[168:171]
    buffer_load_dwordx4 a[68:71], v3, s[4:7], s26 offen offset:2048 sc1
    v_mfma_f32_16x16x32_bf16 a[172:175], v[164:167], a[4:7], a[172:175]
    v_mfma_f32_16x16x32_bf16 a[176:179], v[168:171], a[4:7], a[176:179]
    ds_write_b128 v36, a[152:155] offset:1024
    v_mfma_f32_16x16x32_bf16 a[180:183], v[172:175], a[4:7], a[180:183]
    v_mfma_f32_16x16x32_bf16 a[184:187], v[176:179], a[4:7], a[184:187]
    buffer_load_dwordx4 a[72:75], v3, s[4:7], s26 offen offset:3072 sc1
    s_waitcnt vmcnt(12)
    v_mfma_f32_16x16x32_bf16 a[168:171], v[180:183], a[8:11], a[168:171]
    ds_write_b128 v36, a[156:159] offset:2048
    v_mfma_f32_16x16x32_bf16 a[172:175], v[184:187], a[8:11], a[172:175]
    v_mfma_f32_16x16x32_bf16 a[176:179], v[188:191], a[8:11], a[176:179]
    v_mfma_f32_16x16x32_bf16 a[180:183], v[192:195], a[8:11], a[180:183]
    buffer_load_dwordx4 a[76:79], v3, s[4:7], s27 offen offset:0 sc1
    ds_write_b128 v36, a[160:163] offset:3072
    v_mfma_f32_16x16x32_bf16 a[184:187], v[196:199], a[8:11], a[184:187]
    s_waitcnt vmcnt(12)
    v_mfma_f32_16x16x32_bf16 a[168:171], v[200:203], a[12:15], a[168:171]
    v_mfma_f32_16x16x32_bf16 a[172:175], v[204:207], a[12:15], a[172:175]
    ds_write_b128 v36, a[164:167] offset:4096
    v_mfma_f32_16x16x32_bf16 a[176:179], v[208:211], a[12:15], a[176:179]
    buffer_load_dwordx4 a[80:83], v3, s[4:7], s27 offen offset:1024 sc1
    v_mfma_f32_16x16x32_bf16 a[180:183], v[212:215], a[12:15], a[180:183]
    v_mfma_f32_16x16x32_bf16 a[184:187], v[216:219], a[12:15], a[184:187]
    s_waitcnt vmcnt(12)
    v_mfma_f32_16x16x32_bf16 a[168:171], a[244:247], a[16:19], a[168:171]
    v_mfma_f32_16x16x32_bf16 a[172:175], a[248:251], a[16:19], a[172:175]
    buffer_load_dwordx4 a[84:87], v3, s[4:7], s27 offen offset:2048 sc1
    v_mfma_f32_16x16x32_bf16 a[176:179], a[252:255], a[16:19], a[176:179]
    v_mfma_f32_16x16x32_bf16 a[180:183], v[52:55], a[16:19], a[180:183]
    v_mfma_f32_16x16x32_bf16 a[184:187], v[56:59], a[16:19], a[184:187]
    s_waitcnt vmcnt(12)
    v_mfma_f32_16x16x32_bf16 a[168:171], v[60:63], a[20:23], a[168:171]
    buffer_load_dwordx4 a[88:91], v3, s[4:7], s27 offen offset:3072 sc1
    v_mfma_f32_16x16x32_bf16 a[172:175], v[64:67], a[20:23], a[172:175]
    v_mfma_f32_16x16x32_bf16 a[176:179], v[68:71], a[20:23], a[176:179]
    v_mfma_f32_16x16x32_bf16 a[180:183], v[72:75], a[20:23], a[180:183]
    s_add_u32 s26, s26, 4096
    s_add_u32 s27, s27, 4096
    v_mfma_f32_16x16x32_bf16 a[184:187], v[76:79], a[20:23], a[184:187]
    s_add_u32 s46, s26, 4096
    buffer_load_dwordx4 v[4:7], v3, s[4:7], s46 offen offset:0 sc1
    s_waitcnt vmcnt(13)
    v_mfma_f32_16x16x32_bf16 a[168:171], v[80:83], a[24:27], a[168:171]
    v_mfma_f32_16x16x32_bf16 a[172:175], v[84:87], a[24:27], a[172:175]
    v_mfma_f32_16x16x32_bf16 a[176:179], v[88:91], a[24:27], a[176:179]
    v_mfma_f32_16x16x32_bf16 a[180:183], v[92:95], a[24:27], a[180:183]
    buffer_load_dwordx4 v[8:11], v3, s[4:7], s46 offen offset:1024 sc1
    v_mfma_f32_16x16x32_bf16 a[184:187], v[96:99], a[24:27], a[184:187]
    s_waitcnt vmcnt(13)
    v_mfma_f32_16x16x32_bf16 a[168:171], v[100:103], a[28:31], a[168:171]
    v_mfma_f32_16x16x32_bf16 a[172:175], v[104:107], a[28:31], a[172:175]
    v_mfma_f32_16x16x32_bf16 a[176:179], v[108:111], a[28:31], a[176:179]
    buffer_load_dwordx4 v[12:15], v3, s[4:7], s46 offen offset:2048 sc1
    v_mfma_f32_16x16x32_bf16 a[180:183], v[112:115], a[28:31], a[180:183]
    v_mfma_f32_16x16x32_bf16 a[184:187], v[116:119], a[28:31], a[184:187]
    s_waitcnt vmcnt(10)
    v_mfma_f32_16x16x32_bf16 a[188:191], v[140:143], a[60:63], 0
    v_mfma_f32_16x16x32_bf16 a[192:195], v[144:147], a[60:63], 0
    buffer_load_dwordx4 v[16:19], v3, s[4:7], s46 offen offset:3072 sc1
    v_mfma_f32_16x16x32_bf16 a[196:199], v[148:151], a[60:63], 0
    v_mfma_f32_16x16x32_bf16 a[200:203], v[152:155], a[60:63], 0
    v_mfma_f32_16x16x32_bf16 a[204:207], v[156:159], a[60:63], 0
    s_waitcnt vmcnt(10)
    v_mfma_f32_16x16x32_bf16 a[188:191], v[160:163], a[64:67], a[188:191]
    s_add_u32 s46, s27, 4096
    buffer_load_dwordx4 v[20:23], v3, s[4:7], s46 offen offset:0 sc1
    v_mfma_f32_16x16x32_bf16 a[192:195], v[164:167], a[64:67], a[192:195]
    v_mfma_f32_16x16x32_bf16 a[196:199], v[168:171], a[64:67], a[196:199]
    v_mfma_f32_16x16x32_bf16 a[200:203], v[172:175], a[64:67], a[200:203]
    v_mfma_f32_16x16x32_bf16 a[204:207], v[176:179], a[64:67], a[204:207]
    buffer_load_dwordx4 v[24:27], v3, s[4:7], s46 offen offset:1024 sc1
    s_waitcnt vmcnt(11)
    v_mfma_f32_16x16x32_bf16 a[188:191], v[180:183], a[68:71], a[188:191]
    v_mfma_f32_16x16x32_bf16 a[192:195], v[184:187], a[68:71], a[192:195]
    v_mfma_f32_16x16x32_bf16 a[196:199], v[188:191], a[68:71], a[196:199]
    v_mfma_f32_16x16x32_bf16 a[200:203], v[192:195], a[68:71], a[200:203]
    buffer_load_dwordx4 v[28:31], v3, s[4:7], s46 offen offset:2048 sc1
    v_mfma_f32_16x16x32_bf16 a[204:207], v[196:199], a[68:71], a[204:207]
    s_waitcnt vmcnt(11)
    v_mfma_f32_16x16x32_bf16 a[188:191], v[200:203], a[72:75], a[188:191]
    v_mfma_f32_16x16x32_bf16 a[192:195], v[204:207], a[72:75], a[192:195]
    v_mfma_f32_16x16x32_bf16 a[196:199], v[208:211], a[72:75], a[196:199]
    buffer_load_dwordx4 v[32:35], v3, s[4:7], s46 offen offset:3072 sc1
    v_mfma_f32_16x16x32_bf16 a[200:203], v[212:215], a[72:75], a[200:203]
    v_mfma_f32_16x16x32_bf16 a[204:207], v[216:219], a[72:75], a[204:207]
    s_waitcnt vmcnt(11)
    v_mfma_f32_16x16x32_bf16 a[188:191], a[244:247], a[76:79], a[188:191]
    v_mfma_f32_16x16x32_bf16 a[192:195], a[248:251], a[76:79], a[192:195]
    v_mfma_f32_16x16x32_bf16 a[196:199], a[252:255], a[76:79], a[196:199]
    v_mfma_f32_16x16x32_bf16 a[200:203], v[52:55], a[76:79], a[200:203]
    buffer_load_dwordx4 v[40:43], v37, s[4:7], s48 offen offset:0 sc1
    v_mfma_f32_16x16x32_bf16 a[204:207], v[56:59], a[76:79], a[204:207]
    s_waitcnt vmcnt(11)
    v_mfma_f32_16x16x32_bf16 a[188:191], v[60:63], a[80:83], a[188:191]
    v_mfma_f32_16x16x32_bf16 a[192:195], v[64:67], a[80:83], a[192:195]
    buffer_load_dwordx4 v[44:47], v37, s[4:7], s48 offen offset:64 sc1
    v_mfma_f32_16x16x32_bf16 a[196:199], v[68:71], a[80:83], a[196:199]
    v_mfma_f32_16x16x32_bf16 a[200:203], v[72:75], a[80:83], a[200:203]
    v_mfma_f32_16x16x32_bf16 a[204:207], v[76:79], a[80:83], a[204:207]
    buffer_load_dwordx2 v[48:49], v50, s[4:7], s48 offen offset:128 sc1
    s_waitcnt vmcnt(12)
    v_mfma_f32_16x16x32_bf16 a[188:191], v[80:83], a[84:87], a[188:191]
    v_mfma_f32_16x16x32_bf16 a[192:195], v[84:87], a[84:87], a[192:195]
    v_mfma_f32_16x16x32_bf16 a[196:199], v[88:91], a[84:87], a[196:199]
    s_add_u32 s37, s50, 0
    buffer_load_dwordx4 a[0:3], v3, s[4:7], s37 offen offset:0
    v_mfma_f32_16x16x32_bf16 a[200:203], v[92:95], a[84:87], a[200:203]
    v_mfma_f32_16x16x32_bf16 a[204:207], v[96:99], a[84:87], a[204:207]
    s_waitcnt vmcnt(12)
    v_mfma_f32_16x16x32_bf16 a[188:191], v[100:103], a[88:91], a[188:191]
    v_mfma_f32_16x16x32_bf16 a[192:195], v[104:107], a[88:91], a[192:195]
    v_mfma_f32_16x16x32_bf16 a[196:199], v[108:111], a[88:91], a[196:199]
    buffer_load_dwordx4 a[4:7], v3, s[4:7], s37 offen offset:1024
    s_waitcnt vmcnt(11)
    v_mfma_f32_16x16x32_bf16 a[200:203], v[112:115], a[88:91], a[200:203]
    v_swap_b32 v6, v8
    v_swap_b32 v7, v9
    v_mfma_f32_16x16x32_bf16 a[204:207], v[116:119], a[88:91], a[204:207]
    s_nop 0
    v_mfma_f32_16x16x32_bf16 a[168:171], v[220:223], v[4:7], a[168:171]
    v_mfma_f32_16x16x32_bf16 a[172:175], v[224:227], v[4:7], a[172:175]
    v_mfma_f32_16x16x32_bf16 a[176:179], v[228:231], v[4:7], a[176:179]
    buffer_load_dwordx4 a[8:11], v3, s[4:7], s37 offen offset:2048
    s_waitcnt vmcnt(10)
    v_mfma_f32_16x16x32_bf16 a[180:183], v[232:235], v[4:7], a[180:183]
    v_swap_b32 v14, v16
    v_swap_b32 v15, v17
    v_mfma_f32_16x16x32_bf16 a[184:187], v[236:239], v[4:7], a[184:187]
    s_nop 0
    v_mfma_f32_16x16x32_bf16 a[168:171], v[240:243], v[12:15], a[168:171]
    v_mfma_f32_16x16x32_bf16 a[172:175], v[244:247], v[12:15], a[172:175]
    v_mfma_f32_16x16x32_bf16 a[176:179], v[248:251], v[12:15], a[176:179]
    buffer_load_dwordx4 a[12:15], v3, s[4:7], s37 offen offset:3072
    s_waitcnt vmcnt(9)
    v_mfma_f32_16x16x32_bf16 a[180:183], v[252:255], v[12:15], a[180:183]
    v_swap_b32 v22, v24
    v_swap_b32 v23, v25
    v_mfma_f32_16x16x32_bf16 a[184:187], a[240:243], v[12:15], a[184:187]
    s_nop 0
    v_mfma_f32_16x16x32_bf16 a[168:171], v[120:123], v[20:23], a[168:171]
    v_mfma_f32_16x16x32_bf16 a[172:175], v[124:127], v[20:23], a[172:175]
    v_mfma_f32_16x16x32_bf16 a[176:179], v[128:131], v[20:23], a[176:179]
    s_add_u32 s37, s50, 4096
    buffer_load_dwordx4 a[16:19], v3, s[4:7], s37 offen offset:0
    s_waitcnt vmcnt(8)
    v_mfma_f32_16x16x32_bf16 a[180:183], v[132:135], v[20:23], a[180:183]
    v_swap_b32 v30, v32
    v_swap_b32 v31, v33
    v_mfma_f32_16x16x32_bf16 a[184:187], a[32:35], v[20:23], a[184:187]
    s_nop 0
    v_mfma_f32_16x16x32_bf16 a[168:171], a[36:39], v[28:31], a[168:171]
    v_mfma_f32_16x16x32_bf16 a[172:175], a[40:43], v[28:31], a[172:175]
    v_mfma_f32_16x16x32_bf16 a[176:179], a[44:47], v[28:31], a[176:179]
    buffer_load_dwordx4 a[20:23], v3, s[4:7], s37 offen offset:1024
    v_mfma_f32_16x16x32_bf16 a[180:183], a[48:51], v[28:31], a[180:183]
    v_mfma_f32_16x16x32_bf16 a[184:187], a[52:55], v[28:31], a[184:187]
    v_mfma_f32_16x16x32_bf16 a[188:191], v[220:223], v[8:11], a[188:191]
    s_sub_u32 s34, s20, 3
    s_and_b32 s34, s34, 3
    s_mul_i32 s34, s34, 5120
    s_add_u32 s34, s34, 122880
    v_add_u32 v36, s34, v3
    v_mfma_f32_16x16x32_bf16 a[192:195], v[224:227], v[8:11], a[192:195]
    v_mfma_f32_16x16x32_bf16 a[196:199], v[228:231], v[8:11], a[196:199]
    buffer_load_dwordx4 a[24:27], v3, s[4:7], s37 offen offset:2048
    v_mfma_f32_16x16x32_bf16 a[200:203], v[232:235], v[8:11], a[200:203]
    v_mfma_f32_16x16x32_bf16 a[204:207], v[236:239], v[8:11], a[204:207]
    ds_write_b128 v36, a[168:171] offset:0
    v_mfma_f32_16x16x32_bf16 a[188:191], v[240:243], v[16:19], a[188:191]
    v_mfma_f32_16x16x32_bf16 a[192:195], v[244:247], v[16:19], a[192:195]
    v_mfma_f32_16x16x32_bf16 a[196:199], v[248:251], v[16:19], a[196:199]
    buffer_load_dwordx4 a[28:31], v3, s[4:7], s37 offen offset:3072
    ds_write_b128 v36, a[172:175] offset:1024
    v_mfma_f32_16x16x32_bf16 a[200:203], v[252:255], v[16:19], a[200:203]
    v_mfma_f32_16x16x32_bf16 a[204:207], a[240:243], v[16:19], a[204:207]
    v_mfma_f32_16x16x32_bf16 a[188:191], v[120:123], v[24:27], a[188:191]
    ds_write_b128 v36, a[176:179] offset:2048
    v_mfma_f32_16x16x32_bf16 a[192:195], v[124:127], v[24:27], a[192:195]
    v_mfma_f32_16x16x32_bf16 a[196:199], v[128:131], v[24:27], a[196:199]
    v_mfma_f32_16x16x32_bf16 a[200:203], v[132:135], v[24:27], a[200:203]
    ds_write_b128 v36, a[180:183] offset:3072
    v_mfma_f32_16x16x32_bf16 a[204:207], a[32:35], v[24:27], a[204:207]
    v_mfma_f32_16x16x32_bf16 a[188:191], a[36:39], v[32:35], a[188:191]
    v_mfma_f32_16x16x32_bf16 a[192:195], a[40:43], v[32:35], a[192:195]
    ds_write_b128 v36, a[184:187] offset:4096
    v_mfma_f32_16x16x32_bf16 a[196:199], a[44:47], v[32:35], a[196:199]
    v_mfma_f32_16x16x32_bf16 a[200:203], a[48:51], v[32:35], a[200:203]
    s_sub_u32 s34, s20, 4
    s_and_b32 s34, s34, 3
    s_mul_i32 s34, s34, 5120
    s_add_u32 s34, s34, 143360
    v_add_u32 v36, s34, v3
    v_mfma_f32_16x16x32_bf16 a[204:207], a[52:55], v[32:35], a[204:207]
    ds_write_b128 v36, a[188:191] offset:0
    ds_write_b128 v36, a[192:195] offset:1024
    ds_write_b128 v36, a[196:199] offset:2048
    ds_write_b128 v36, a[200:203] offset:3072
    s_nop 3
    ds_write_b128 v36, a[204:207] offset:4096
    buffer_load_dwordx4 v[24:27], v3, s[16:19], s33 offen offset:0
    buffer_load_dwordx4 v[28:31], v3, s[16:19], s33 offen offset:1024
own_kp_kernel_19:
    s_cmp_lg_u32 s20, 0
    s_cbranch_scc1 own_kp_kernel_20
    v_accvgpr_read_b32 v52, a128
    v_accvgpr_read_b32 v53, a129
    v_accvgpr_read_b32 v54, a130
    v_accvgpr_read_b32 v55, a131
    v_accvgpr_read_b32 v56, a132
    v_accvgpr_read_b32 v57, a133
    v_accvgpr_read_b32 v58, a134
    v_accvgpr_read_b32 v59, a135
    v_accvgpr_read_b32 v60, a136
    v_accvgpr_read_b32 v61, a137
    v_accvgpr_read_b32 v62, a138
    v_accvgpr_read_b32 v63, a139
    v_accvgpr_read_b32 v64, a140
    v_accvgpr_read_b32 v65, a141
    v_accvgpr_read_b32 v66, a142
    v_accvgpr_read_b32 v67, a143
    v_accvgpr_read_b32 v68, a144
    v_accvgpr_read_b32 v69, a145
    v_accvgpr_read_b32 v70, a146
    v_accvgpr_read_b32 v71, a147
    s_branch own_kp_kernel_23
own_kp_kernel_20:
    s_cmp_lg_u32 s20, 1
    s_cbranch_scc1 own_kp_kernel_21
    v_accvgpr_read_b32 v52, a148
    v_accvgpr_read_b32 v53, a149
    v_accvgpr_read_b32 v54, a150
    v_accvgpr_read_b32 v55, a151
    v_accvgpr_read_b32 v56, a152
    v_accvgpr_read_b32 v57, a153
    v_accvgpr_read_b32 v58, a154
    v_accvgpr_read_b32 v59, a155
    v_accvgpr_read_b32 v60, a156
    v_accvgpr_read_b32 v61, a157
    v_accvgpr_read_b32 v62, a158
    v_accvgpr_read_b32 v63, a159
    v_accvgpr_read_b32 v64, a160
    v_accvgpr_read_b32 v65, a161
    v_accvgpr_read_b32 v66, a162
    v_accvgpr_read_b32 v67, a163
    v_accvgpr_read_b32 v68, a164
    v_accvgpr_read_b32 v69, a165
    v_accvgpr_read_b32 v70, a166
    v_accvgpr_read_b32 v71, a167
    s_branch own_kp_kernel_23
own_kp_kernel_21:
    s_cmp_lg_u32 s20, 2
    s_cbranch_scc1 own_kp_kernel_22
    v_accvgpr_read_b32 v52, a168
    v_accvgpr_read_b32 v53, a169
    v_accvgpr_read_b32 v54, a170
    v_accvgpr_read_b32 v55, a171
    v_accvgpr_read_b32 v56, a172
    v_accvgpr_read_b32 v57, a173
    v_accvgpr_read_b32 v58, a174
    v_accvgpr_read_b32 v59, a175
    v_accvgpr_read_b32 v60, a176
    v_accvgpr_read_b32 v61, a177
    v_accvgpr_read_b32 v62, a178
    v_accvgpr_read_b32 v63, a179
    v_accvgpr_read_b32 v64, a180
    v_accvgpr_read_b32 v65, a181
    v_accvgpr_read_b32 v66, a182
    v_accvgpr_read_b32 v67, a183
    v_accvgpr_read_b32 v68, a184
    v_accvgpr_read_b32 v69, a185
    v_accvgpr_read_b32 v70, a186
    v_accvgpr_read_b32 v71, a187
    s_branch own_kp_kernel_23
own_kp_kernel_22:
    v_accvgpr_read_b32 v52, a188
    v_accvgpr_read_b32 v53, a189
    v_accvgpr_read_b32 v54, a190
    v_accvgpr_read_b32 v55, a191
    v_accvgpr_read_b32 v56, a192
    v_accvgpr_read_b32 v57, a193
    v_accvgpr_read_b32 v58, a194
    v_accvgpr_read_b32 v59, a195
    v_accvgpr_read_b32 v60, a196
    v_accvgpr_read_b32 v61, a197
    v_accvgpr_read_b32 v62, a198
    v_accvgpr_read_b32 v63, a199
    v_accvgpr_read_b32 v64, a200
    v_accvgpr_read_b32 v65, a201
    v_accvgpr_read_b32 v66, a202
    v_accvgpr_read_b32 v67, a203
    v_accvgpr_read_b32 v68, a204
    v_accvgpr_read_b32 v69, a205
    v_accvgpr_read_b32 v70, a206
    v_accvgpr_read_b32 v71, a207
own_kp_kernel_23:
    s_mul_i32 s34, s20, 20480
    s_add_u32 s34, s34, 81920
    v_add_u32 v36, s34, v3
    s_waitcnt vmcnt(10)
    s_waitcnt lgkmcnt(0)
    s_barrier
    ds_read_b128 v[72:75], v36 offset:0
    ds_read_b128 v[76:79], v36 offset:1024
    ds_read_b128 v[80:83], v36 offset:2048
    ds_read_b128 v[84:87], v36 offset:3072
    ds_read_b128 v[88:91], v36 offset:4096
    ds_read_b128 v[92:95], v36 offset:5120
    ds_read_b128 v[96:99], v36 offset:6144
    ds_read_b128 v[100:103], v36 offset:7168
    ds_read_b128 v[104:107], v36 offset:8192
    ds_read_b128 v[108:111], v36 offset:9216
    ds_read_b128 v[112:115], v36 offset:10240
    ds_read_b128 v[116:119], v36 offset:11264
    ds_read_b128 v[120:123], v36 offset:12288
    ds_read_b128 v[124:127], v36 offset:13312
    ds_read_b128 v[128:131], v36 offset:14336
    v_permlane16_swap_b32 v40, v42
    v_permlane16_swap_b32 v41, v43
    v_permlane16_swap_b32 v44, v46
    v_permlane16_swap_b32 v45, v47
    v_lshlrev_b32 v4, 16, v40
    v_and_b32 v5, 0xffff0000, v40
    v_lshlrev_b32 v6, 16, v41
    v_and_b32 v7, 0xffff0000, v41
    v_lshlrev_b32 v8, 16, v42
    v_and_b32 v9, 0xffff0000, v42
    v_lshlrev_b32 v10, 16, v43
    v_and_b32 v11, 0xffff0000, v43
    v_lshlrev_b32 v12, 16, v44
    v_and_b32 v13, 0xffff0000, v44
    v_lshlrev_b32 v14, 16, v45
    v_and_b32 v15, 0xffff0000, v45
    v_lshlrev_b32 v16, 16, v46
    v_and_b32 v17, 0xffff0000, v46
    v_lshlrev_b32 v18, 16, v47
    v_and_b32 v19, 0xffff0000, v47
    v_lshlrev_b32 v20, 16, v48
    v_and_b32 v21, 0xffff0000, v48
    v_lshlrev_b32 v22, 16, v49
    v_and_b32 v23, 0xffff0000, v49
    v_pk_add_f32 v[52:53], v[52:53], v[4:5]
    v_pk_add_f32 v[54:55], v[54:55], v[6:7]
    v_pk_add_f32 v[56:57], v[56:57], v[8:9]
    v_pk_add_f32 v[58:59], v[58:59], v[10:11]
    v_pk_add_f32 v[60:61], v[60:61], v[12:13]
    v_pk_add_f32 v[62:63], v[62:63], v[14:15]
    v_pk_add_f32 v[64:65], v[64:65], v[16:17]
    v_pk_add_f32 v[66:67], v[66:67], v[18:19]
    v_pk_add_f32 v[68:69], v[68:69], v[20:21]
    v_pk_add_f32 v[70:71], v[70:71], v[22:23]
    s_waitcnt lgkmcnt(14)
    v_pk_add_f32 v[52:53], v[52:53], v[72:73]
    v_pk_add_f32 v[54:55], v[54:55], v[74:75]
    s_waitcnt lgkmcnt(13)
    v_pk_add_f32 v[56:57], v[56:57], v[76:77]
    v_pk_add_f32 v[58:59], v[58:59], v[78:79]
    s_waitcnt lgkmcnt(12)
    v_pk_add_f32 v[60:61], v[60:61], v[80:81]
    v_pk_add_f32 v[62:63], v[62:63], v[82:83]
    s_waitcnt lgkmcnt(11)
    v_pk_add_f32 v[64:65], v[64:65], v[84:85]
    v_pk_add_f32 v[66:67], v[66:67], v[86:87]
    s_waitcnt lgkmcnt(10)
    v_pk_add_f32 v[68:69], v[68:69], v[88:89]
    v_pk_add_f32 v[70:71], v[70:71], v[90:91]
    s_waitcnt lgkmcnt(9)
    v_pk_add_f32 v[52:53], v[52:53], v[92:93]
    v_pk_add_f32 v[54:55], v[54:55], v[94:95]
    s_waitcnt lgkmcnt(8)
    v_pk_add_f32 v[56:57], v[56:57], v[96:97]
    v_pk_add_f32 v[58:59], v[58:59], v[98:99]
    s_waitcnt lgkmcnt(7)
    v_pk_add_f32 v[60:61], v[60:61], v[100:101]
    v_pk_add_f32 v[62:63], v[62:63], v[102:103]
    s_waitcnt lgkmcnt(6)
    v_pk_add_f32 v[64:65], v[64:65], v[104:105]
    v_pk_add_f32 v[66:67], v[66:67], v[106:107]
    s_waitcnt lgkmcnt(5)
    v_pk_add_f32 v[68:69], v[68:69], v[108:109]
    v_pk_add_f32 v[70:71], v[70:71], v[110:111]
    s_waitcnt lgkmcnt(4)
    v_pk_add_f32 v[52:53], v[52:53], v[112:113]
    v_pk_add_f32 v[54:55], v[54:55], v[114:115]
    s_waitcnt lgkmcnt(3)
    v_pk_add_f32 v[56:57], v[56:57], v[116:117]
    v_pk_add_f32 v[58:59], v[58:59], v[118:119]
    s_waitcnt lgkmcnt(2)
    v_pk_add_f32 v[60:61], v[60:61], v[120:121]
    v_pk_add_f32 v[62:63], v[62:63], v[122:123]
    s_waitcnt lgkmcnt(1)
    v_pk_add_f32 v[64:65], v[64:65], v[124:125]
    v_pk_add_f32 v[66:67], v[66:67], v[126:127]
    s_waitcnt lgkmcnt(0)
    v_pk_add_f32 v[68:69], v[68:69], v[128:129]
    v_pk_add_f32 v[70:71], v[70:71], v[130:131]
    v_pk_add_f32 v[4:5], v[52:53], v[54:55]
    v_pk_mul_f32 v[6:7], v[52:53], v[52:53]
    v_pk_fma_f32 v[6:7], v[54:55], v[54:55], v[6:7]
    v_pk_add_f32 v[4:5], v[4:5], v[56:57]
    v_pk_fma_f32 v[6:7], v[56:57], v[56:57], v[6:7]
    v_pk_add_f32 v[4:5], v[4:5], v[58:59]
    v_pk_fma_f32 v[6:7], v[58:59], v[58:59], v[6:7]
    v_pk_add_f32 v[4:5], v[4:5], v[60:61]
    v_pk_fma_f32 v[6:7], v[60:61], v[60:61], v[6:7]
    v_pk_add_f32 v[4:5], v[4:5], v[62:63]
    v_pk_fma_f32 v[6:7], v[62:63], v[62:63], v[6:7]
    v_pk_add_f32 v[4:5], v[4:5], v[64:65]
    v_pk_fma_f32 v[6:7], v[64:65], v[64:65], v[6:7]
    v_pk_add_f32 v[4:5], v[4:5], v[66:67]
    v_pk_fma_f32 v[6:7], v[66:67], v[66:67], v[6:7]
    v_pk_add_f32 v[4:5], v[4:5], v[68:69]
    v_pk_fma_f32 v[6:7], v[68:69], v[68:69], v[6:7]
    v_pk_add_f32 v[4:5], v[4:5], v[70:71]
    v_pk_fma_f32 v[6:7], v[70:71], v[70:71], v[6:7]
    v_add_f32 v4, v4, v5
    v_add_f32 v6, v6, v7
    v_lshrrev_b32 v0, 4, v3
    v_lshrrev_b32 v8, 5, v0
    v_permlane32_swap_b32 v4, v6
    v_add_f32 v4, v4, v6
    v_lshlrev_b32 v8, 2, v8
    v_mov_b32 v5, v4
    v_lshl_add_u32 v8, v39, 3, v8
    s_lshl_b32 s34, s22, 12
    s_lshl_b32 s35, s20, 7
    v_permlane16_swap_b32 v5, v4
    s_add_u32 s34, s34, s35
    s_add_u32 s34, s34, 20709376
    s_lshl_b32 s35, s21, 9
    s_add_u32 s35, s35, s34
    v_add_f32 v4, v4, v5
    s_mov_b32 exec_lo, 0xffff
    s_mov_b32 exec_hi, 0xffff
    buffer_store_dword v4, v8, s[4:7], s35 offen sc1
    s_mov_b64 exec, -1
    v_cvt_pk_bf16_f32 v40, v52, v53
    v_cvt_pk_bf16_f32 v41, v54, v55
    v_cvt_pk_bf16_f32 v42, v56, v57
    v_cvt_pk_bf16_f32 v43, v58, v59
    v_cvt_pk_bf16_f32 v44, v60, v61
    v_cvt_pk_bf16_f32 v45, v62, v63
    v_cvt_pk_bf16_f32 v46, v64, v65
    v_cvt_pk_bf16_f32 v47, v66, v67
    v_cvt_pk_bf16_f32 v48, v68, v69
    v_cvt_pk_bf16_f32 v49, v70, v71
    v_permlane16_swap_b32 v40, v42
    v_permlane16_swap_b32 v41, v43
    buffer_store_dwordx4 v[40:43], v38, s[4:7], s31 offen offset:0 sc1
    v_permlane16_swap_b32 v44, v46
    v_permlane16_swap_b32 v45, v47
    buffer_store_dwordx4 v[44:47], v38, s[4:7], s31 offen offset:1024 sc1
    buffer_store_dwordx2 v[48:49], v51, s[4:7], s31 offen offset:2048 sc1
    s_add_u32 s37, s50, 12288
    buffer_load_dwordx4 a[60:63], v3, s[4:7], s37 offen offset:3072
    s_add_u32 s37, s50, 16384
    buffer_load_dwordx4 a[64:67], v3, s[4:7], s37 offen offset:0
    buffer_load_dwordx4 a[68:71], v3, s[4:7], s37 offen offset:1024
    buffer_load_dwordx4 a[72:75], v3, s[4:7], s37 offen offset:2048
    buffer_load_dwordx4 a[76:79], v3, s[4:7], s37 offen offset:3072
    v_lshlrev_b32 v39, 3, v39
    v_lshrrev_b32 v6, 4, v0
    v_lshl_add_u32 v39, v6, 10, v39
    v_lshrrev_b32 v106, 2, v0
    v_mul_u32_u24 v106, 160, v106
    v_and_b32 v107, 1, v0
    v_lshl_add_u32 v107, v107, 3, v106
    v_bfe_u32 v108, v0, 1, 1
    v_mul_u32_u24 v108, 80, v108
    v_add3_u32 v107, v107, v108, 64
    v_and_b32 v108, 3, v0
    v_lshl_add_u32 v106, v108, 3, v106
    v_bfe_u32 v108, v0, 1, 3
    v_mul_u32_u24 v108, 81920, v108
    v_and_b32 v109, 1, v0
    v_lshl_add_u32 v108, v109, 4, v108
    v_bfe_u32 v110, v0, 4, 1
    v_lshl_add_u32 v109, v110, 5, v108
    v_lshrrev_b32 v110, 5, v0
    v_lshl_add_u32 v109, v110, 3, v109
    v_lshrrev_b32 v110, 4, v0
    v_lshl_add_u32 v108, v110, 5, v108
    s_mul_i32 s30, s20, 655360
    s_add_u32 s30, s30, 22020096
    s_lshl_b32 s31, s23, 3
    s_add_u32 s31, s31, s21
    s_lshl_b32 s31, s31, 6
    s_add_u32 s32, s30, s31
    s_add_u32 s30, s32, s31
    s_add_u32 s32, s32, 65536
    v_and_b32 v7, 15, v0
    v_mul_u32_u24 v7, 160, v7
    v_lshl_add_u32 v7, v6, 3, v7
    s_mul_i32 s35, s20, 2560
    s_add_u32 s35, s35, 0
    v_add_u32 v7, s35, v7
    s_mov_b32 s57, 0
sp_kp_kernel_24:
    buffer_load_dwordx2 v[12:13], v39, s[4:7], s34 offen sc1
    buffer_load_dwordx2 v[14:15], v39, s[4:7], s34 offen offset:512 sc1
    s_add_u32 s57, s57, 1
    s_waitcnt vmcnt(0)
    s_cmp_gt_u32 s57, 524288
    s_cbranch_scc1 sok_kp_kernel_25
    v_max_u32 v16, v12, v13
    v_max3_u32 v16, v14, v15, v16
    v_cmp_eq_u32 vcc, -1, v16
    s_cbranch_vccnz sp_kp_kernel_24
sok_kp_kernel_25:
    v_pk_add_f32 v[12:13], v[12:13], v[14:15]
    v_mov_b32 v16, 0x3727c5ac
    v_mov_b32 v14, v12
    v_mov_b32 v15, v13
    s_nop 0
    v_permlane16_swap_b32 v14, v12
    v_permlane16_swap_b32 v15, v13
    v_pk_add_f32 v[12:13], v[12:13], v[14:15]
    v_mov_b32 v14, v12
    v_mov_b32 v15, v13
    s_nop 0
    v_permlane32_swap_b32 v14, v12
    v_permlane32_swap_b32 v15, v13
    v_pk_add_f32 v[12:13], v[12:13], v[14:15]
    v_mul_f32 v4, 0x3acccccd, v12
    v_fmamk_f32 v5, v13, 0x3acccccd, v16
    v_fma_f32 v5, -v4, v4, v5
    v_max_f32 v5, v16, v5
    v_rsq_f32 v5, v5
    s_nop 0
    v_mul_f32 v4, v4, v5
    v_pk_fma_f32 v[52:53], v[52:53], v[4:5], v[4:5] op_sel:[0,1,0] op_sel_hi:[1,1,0] neg_lo:[0,0,1] neg_hi:[0,0,1]
    v_pk_fma_f32 v[54:55], v[54:55], v[4:5], v[4:5] op_sel:[0,1,0] op_sel_hi:[1,1,0] neg_lo:[0,0,1] neg_hi:[0,0,1]
    v_cvt_pk_f16_f32 v40, v52, v53
    v_cvt_pk_f16_f32 v41, v54, v55
    ds_write_b64 v7, v[40:41] offset:0
    v_pk_fma_f32 v[56:57], v[56:57], v[4:5], v[4:5] op_sel:[0,1,0] op_sel_hi:[1,1,0] neg_lo:[0,0,1] neg_hi:[0,0,1]
    v_pk_fma_f32 v[58:59], v[58:59], v[4:5], v[4:5] op_sel:[0,1,0] op_sel_hi:[1,1,0] neg_lo:[0,0,1] neg_hi:[0,0,1]
    v_cvt_pk_f16_f32 v42, v56, v57
    v_cvt_pk_f16_f32 v43, v58, v59
    ds_write_b64 v7, v[42:43] offset:32
    v_pk_fma_f32 v[60:61], v[60:61], v[4:5], v[4:5] op_sel:[0,1,0] op_sel_hi:[1,1,0] neg_lo:[0,0,1] neg_hi:[0,0,1]
    v_pk_fma_f32 v[62:63], v[62:63], v[4:5], v[4:5] op_sel:[0,1,0] op_sel_hi:[1,1,0] neg_lo:[0,0,1] neg_hi:[0,0,1]
    v_cvt_pk_f16_f32 v44, v60, v61
    v_cvt_pk_f16_f32 v45, v62, v63
    ds_write_b64 v7, v[44:45] offset:64
    v_pk_fma_f32 v[64:65], v[64:65], v[4:5], v[4:5] op_sel:[0,1,0] op_sel_hi:[1,1,0] neg_lo:[0,0,1] neg_hi:[0,0,1]
    v_pk_fma_f32 v[66:67], v[66:67], v[4:5], v[4:5] op_sel:[0,1,0] op_sel_hi:[1,1,0] neg_lo:[0,0,1] neg_hi:[0,0,1]
    v_cvt_pk_f16_f32 v46, v64, v65
    v_cvt_pk_f16_f32 v47, v66, v67
    ds_write_b64 v7, v[46:47] offset:96
    v_pk_fma_f32 v[68:69], v[68:69], v[4:5], v[4:5] op_sel:[0,1,0] op_sel_hi:[1,1,0] neg_lo:[0,0,1] neg_hi:[0,0,1]
    v_pk_fma_f32 v[70:71], v[70:71], v[4:5], v[4:5] op_sel:[0,1,0] op_sel_hi:[1,1,0] neg_lo:[0,0,1] neg_hi:[0,0,1]
    v_cvt_pk_f16_f32 v48, v68, v69
    v_cvt_pk_f16_f32 v49, v70, v71
    ds_write_b64 v7, v[48:49] offset:128
    s_waitcnt lgkmcnt(0)
    s_barrier
    ds_read_b64_tr_b16 v[110:111], v106 offset:0
    ds_read_b64_tr_b16 v[112:113], v106 offset:2560
    ds_read_b64_tr_b16 v[114:115], v106 offset:5120
    ds_read_b64_tr_b16 v[116:117], v106 offset:7680
    ds_read_b64_tr_b16 v[118:119], v106 offset:80
    ds_read_b64_tr_b16 v[120:121], v106 offset:2640
    ds_read_b64_tr_b16 v[122:123], v106 offset:5200
    ds_read_b64_tr_b16 v[124:125], v106 offset:7760
    s_waitcnt lgkmcnt(6)
    v_mfma_f32_16x16x32_f16 v[126:129], v[110:113], v[24:27], 0
    s_waitcnt lgkmcnt(4)
    v_mfma_f32_16x16x32_f16 v[126:129], v[114:117], v[28:31], v[126:129]
    s_waitcnt lgkmcnt(2)
    v_mfma_f32_16x16x32_f16 v[130:133], v[118:121], v[24:27], 0
    s_waitcnt lgkmcnt(0)
    v_mfma_f32_16x16x32_f16 v[130:133], v[122:125], v[28:31], v[130:133]
    s_nop 3
    v_cvt_pk_f16_f32 v134, v126, v127
    v_cvt_pk_f16_f32 v135, v128, v129
    s_nop 1
    v_cvt_pk_f16_f32 v136, v130, v131
    v_cvt_pk_f16_f32 v137, v132, v133
    buffer_store_dwordx4 v[134:137], v108, s[4:7], s30 offen sc1
    ds_read_b64_tr_b16 v[110:111], v106 offset:32
    ds_read_b64_tr_b16 v[112:113], v106 offset:2592
    ds_read_b64_tr_b16 v[114:115], v106 offset:5152
    ds_read_b64_tr_b16 v[116:117], v106 offset:7712
    ds_read_b64_tr_b16 v[118:119], v106 offset:112
    ds_read_b64_tr_b16 v[120:121], v106 offset:2672
    ds_read_b64_tr_b16 v[122:123], v106 offset:5232
    ds_read_b64_tr_b16 v[124:125], v106 offset:7792
    s_waitcnt lgkmcnt(6)
    v_mfma_f32_16x16x32_f16 v[126:129], v[110:113], v[24:27], 0
    s_waitcnt lgkmcnt(4)
    v_mfma_f32_16x16x32_f16 v[126:129], v[114:117], v[28:31], v[126:129]
    s_waitcnt lgkmcnt(2)
    v_mfma_f32_16x16x32_f16 v[130:133], v[118:121], v[24:27], 0
    s_waitcnt lgkmcnt(0)
    v_mfma_f32_16x16x32_f16 v[130:133], v[122:125], v[28:31], v[130:133]
    s_nop 3
    v_cvt_pk_f16_f32 v134, v126, v127
    v_cvt_pk_f16_f32 v135, v128, v129
    s_nop 1
    v_cvt_pk_f16_f32 v136, v130, v131
    v_cvt_pk_f16_f32 v137, v132, v133
    s_add_u32 s33, s30, 32768
    buffer_store_dwordx4 v[134:137], v108, s[4:7], s33 offen sc1
    ds_read_b64_tr_b16 v[110:111], v107 offset:0
    ds_read_b64_tr_b16 v[112:113], v107 offset:2560
    ds_read_b64_tr_b16 v[114:115], v107 offset:5120
    ds_read_b64_tr_b16 v[116:117], v107 offset:7680
    s_waitcnt lgkmcnt(2)
    v_mfma_f32_16x16x32_f16 v[126:129], v[110:113], v[24:27], 0
    s_waitcnt lgkmcnt(0)
    v_mfma_f32_16x16x32_f16 v[126:129], v[114:117], v[28:31], v[126:129]
    s_nop 7
    v_cvt_pk_f16_f32 v138, v126, v127
    v_cvt_pk_f16_f32 v139, v128, v129
    buffer_store_dwordx2 v[138:139], v109, s[4:7], s32 offen sc1
    s_lshl_b32 s56, s20, 15
    s_lshl_b32 s57, s22, 7
    s_add_u32 s56, s56, s57
    s_lshl_b32 s57, s21, 2
    s_add_u32 s56, s56, s57
    s_add_u32 s56, s56, 26476544
    v_lshlrev_b32 v24, 12, v0
    v_mov_b32 v25, 1
    s_mov_b64 exec, 0xff
    buffer_store_dword v25, v24, s[4:7], s56 offen sc1
    s_mov_b64 exec, -1
    s_mov_b32 s53, 0
redo_kp_kernel_26:
    s_lshr_b32 s24, s21, 2
    s_sub_u32 s25, 32, s23
    s_and_b32 s25, s25, 31
    s_cmp_eq_u32 s24, 0
    s_cselect_b32 s25, s23, s25
    s_mov_b32 s51, s25
    s_mul_i32 s25, s25, 81920
    s_lshl_b32 s27, s20, 13
    s_add_u32 s39, s25, 22085632
    s_add_u32 s25, s25, s27
    s_add_u32 s25, s25, 22020096
    s_mul_i32 s29, s20, 8448
    v_lshlrev_b32 v3, 4, v0
    s_lshl_b32 s30, s20, 12
    s_add_u32 s28, s30, 8192
    s_add_u32 m0, s30, 118912
    s_lshl_b32 s27, s20, 9
    s_add_u32 s27, s27, 130176
    buffer_load_dwordx4 v3, s[16:19], s28 offen offset:0 lds
    buffer_load_dwordx4 v3, s[16:19], s28 offen offset:1024 lds
    buffer_load_dwordx4 v3, s[16:19], s28 offen offset:2048 lds
    buffer_load_dwordx4 v3, s[16:19], s28 offen offset:3072 lds
    s_mul_i32 s33, s22, 81920
    s_lshl_b32 s34, s21, 2
    s_add_u32 s34, s34, s20
    s_mul_i32 s34, s34, 2560
    s_add_u32 s33, s33, s34
    s_and_b32 s35, s21, 3
    s_lshl_b32 s35, s35, 9
    s_lshl_b32 s36, s24, 5
    s_add_u32 s35, s35, s36
    s_add_u32 s35, s35, s23
    s_lshl_b32 s32, s21, 2
    s_add_u32 s32, s32, s20
    s_lshr_b32 s31, s32, 3
    s_mul_i32 s31, s31, 2560
    s_mul_i32 s36, s22, 81920
    s_add_u32 s31, s31, s36
    s_add_u32 s31, s31, 7864320
    s_and_b32 s32, s32, 7
    s_lshl_b32 s32, s32, 1
    v_lshrrev_b32 v4, 4, v0
    v_and_b32 v5, 7, v0
    v_lshl_add_u32 v5, v5, 6, s35
    v_cvt_f32_u32 v5, v5
    v_mul_f32 v5, 0x3a000000, v5
    v_lshlrev_b32 v6, 1, v4
    v_cvt_f32_u32 v6, v6
    v_bfe_u32 v7, v0, 3, 1
    v_lshl_add_u32 v2, v7, 2, v4
    v_lshl_add_u32 v2, v2, 6, s27
    v_cvt_f32_u32 v7, v7
    v_mul_f32 v7, 0x3e800000, v7
    v_fmac_f32 v7, v5, v6
    s_cmp_eq_u32 s23, 0
    s_cselect_b32 s36, 1, 0
    s_and_b32 s40, s36, s24
    s_cmp_eq_u32 s24, 0
    s_mov_b32 s42, 0xbe000000
    s_cselect_b32 s42, 0x3e000000, s42
    s_cmp_eq_u32 s36, 1
    s_cselect_b32 s42, 0, s42
    s_cmp_eq_u32 s40, 1
    s_cselect_b32 s41, 0, 0x3e000000
    s_cselect_b32 s42, 0x3e000000, s42
    s_cselect_b32 s43, 0, 0xbe800000
    v_fmamk_f32 v92, v5, 0x00000000, v7
    v_add_f32 v93, s43, v92
    v_cos_f32 v92, v92
    v_cos_f32 v93, v93
    v_fmamk_f32 v94, v5, 0x3f800000, v7
    v_add_f32 v95, s43, v94
    v_cos_f32 v94, v94
    v_cos_f32 v95, v95
    v_fmamk_f32 v96, v5, 0x41000000, v7
    v_add_f32 v97, s43, v96
    v_cos_f32 v96, v96
    v_cos_f32 v97, v97
    v_fmamk_f32 v98, v5, 0x41100000, v7
    v_add_f32 v99, s43, v98
    v_cos_f32 v98, v98
    v_cos_f32 v99, v99
    v_fmamk_f32 v100, v5, 0x41800000, v7
    v_add_f32 v101, s43, v100
    v_cos_f32 v100, v100
    v_cos_f32 v101, v101
    v_fmamk_f32 v102, v5, 0x41880000, v7
    v_add_f32 v103, s43, v102
    v_cos_f32 v102, v102
    v_cos_f32 v103, v103
    v_fmamk_f32 v104, v5, 0x41c00000, v7
    v_add_f32 v105, s43, v104
    v_cos_f32 v104, v104
    v_cos_f32 v105, v105
    v_fmamk_f32 v106, v5, 0x41c80000, v7
    v_add_f32 v107, s43, v106
    v_cos_f32 v106, v106
    v_cos_f32 v107, v107
    v_mul_f32 v92, s41, v92
    v_mul_f32 v93, s42, v93
    v_cvt_pk_f16_f32 v16, v92, v93
    v_mul_f32 v94, s41, v94
    v_mul_f32 v95, s42, v95
    v_cvt_pk_f16_f32 v17, v94, v95
    v_mul_f32 v96, s41, v96
    v_mul_f32 v97, s42, v97
    v_cvt_pk_f16_f32 v18, v96, v97
    v_mul_f32 v98, s41, v98
    v_mul_f32 v99, s42, v99
    v_cvt_pk_f16_f32 v19, v98, v99
    v_mul_f32 v100, s41, v100
    v_mul_f32 v101, s42, v101
    v_cvt_pk_f16_f32 v20, v100, v101
    v_mul_f32 v102, s41, v102
    v_mul_f32 v103, s42, v103
    v_cvt_pk_f16_f32 v21, v102, v103
    v_mul_f32 v104, s41, v104
    v_mul_f32 v105, s42, v105
    v_cvt_pk_f16_f32 v22, v104, v105
    v_mul_f32 v106, s41, v106
    v_mul_f32 v107, s42, v107
    v_cvt_pk_f16_f32 v23, v106, v107
    s_lshl_b32 s34, s20, 12
    s_add_u32 s39, s39, s34
    s_mul_i32 s40, s20, 4224
    s_add_u32 s40, s40, 67584
    v_lshrrev_b32 v7, 5, v0
    v_lshlrev_b32 v7, 7, v7
    v_xor_b32 v7, v7, v3
    v_and_b32 v14, 15, v0
    v_lshlrev_b32 v10, 5, v14
    v_cmp_gt_u32 vcc, 8, v14
    v_lshrrev_b32 v15, 5, v0
    v_lshl_add_u32 v15, v15, 4, v10
    v_bfe_u32 v13, v0, 4, 1
    v_add_u32 v11, s32, v13
    v_lshlrev_b32 v11, 5, v11
    v_lshrrev_b32 v12, 4, v15
    s_mov_b32 s34, 10240
    v_add_u32 v49, 0, v12
    v_mul_u32_u24 v50, 205, v49
    v_lshrrev_b32 v50, 11, v50
    v_mul_u32_u24 v51, 10, v50
    v_sub_u32 v49, v49, v51
    v_mad_u32_u24 v48, v50, s34, v11
    v_lshrrev_b32 v50, 2, v49
    v_lshl_add_u32 v48, v50, 10, v48
    v_and_b32 v51, 3, v49
    v_lshl_add_u32 v48, v51, 4, v48
    v_lshrrev_b32 v50, 3, v49
    v_xor_b32 v50, 1, v50
    v_mad_u32_u24 v48, v50, v11, v48
    v_add_u32 v53, 32, v12
    v_mul_u32_u24 v54, 205, v53
    v_lshrrev_b32 v54, 11, v54
    v_mul_u32_u24 v55, 10, v54
    v_sub_u32 v53, v53, v55
    v_mad_u32_u24 v52, v54, s34, v11
    v_lshrrev_b32 v54, 2, v53
    v_lshl_add_u32 v52, v54, 10, v52
    v_and_b32 v55, 3, v53
    v_lshl_add_u32 v52, v55, 4, v52
    v_lshrrev_b32 v54, 3, v53
    v_xor_b32 v54, 1, v54
    v_mad_u32_u24 v52, v54, v11, v52
    v_add_u32 v57, 64, v12
    v_mul_u32_u24 v58, 205, v57
    v_lshrrev_b32 v58, 11, v58
    v_mul_u32_u24 v59, 10, v58
    v_sub_u32 v57, v57, v59
    v_mad_u32_u24 v56, v58, s34, v11
    v_lshrrev_b32 v58, 2, v57
    v_lshl_add_u32 v56, v58, 10, v56
    v_and_b32 v59, 3, v57
    v_lshl_add_u32 v56, v59, 4, v56
    v_lshrrev_b32 v58, 3, v57
    v_xor_b32 v58, 1, v58
    v_mad_u32_u24 v56, v58, v11, v56
    v_mov_b32 v11, v56
    v_mul_u32_u24 v13, 1280, v13
    v_add_u32 v13, v13, v15
    v_mov_b32 v15, 536870912
    v_cndmask_b32 v56, v15, v11, vcc
    v_cndmask_b32 v15, v15, v13, vcc
    v_and_b32 v1, 1, v0
    v_lshlrev_b32 v1, 3, v1
    v_bfe_u32 v5, v0, 2, 1
    v_lshl_add_u32 v1, v5, 4, v1
    s_lshl_b32 s30, s20, 5
    v_add_u32 v1, s30, v1
    v_bfe_u32 v8, v0, 1, 1
    v_mul_u32_u24 v5, 1056, v4
    v_lshl_add_u32 v5, v8, 6, v5
    v_lshl_add_u32 v9, v8, 7, v1
    v_add_u32 v5, v5, v1
    s_and_b32 s30, s30, 64
    v_subrev_u32 v5, s30, v5
    v_bfe_u32 v8, v0, 3, 1
    v_mul_u32_u24 v6, 384, v8
    v_mul_u32_u24 v8, 640, v8
    v_add_u32 v5, 67584, v5
    v_add3_u32 v6, v6, v5, 64
    v_add_u32 v6, 64, v6
    v_add_u32 v5, v5, v8
    v_lshrrev_b32 v1, 3, v0
    v_mul_u32_u24 v1, 1056, v1
    v_add_u32 v1, v1, v9
    v_and_b32 v8, 7, v0
    v_mul_u32_u24 v8, 2576, v8
    v_mul_u32_u24 v9, 320, v4
    v_add_u32 v8, v8, v9
    v_bfe_u32 v9, v0, 3, 1
    v_lshl_add_u32 v8, v9, 3, v8
    s_lshl_b32 s30, s20, 4
    s_add_u32 s30, s30, 98304
    v_add_u32 v8, s30, v8
    s_mul_i32 s30, s20, 5152
    s_add_u32 s30, s30, 98304
    v_mul_u32_u24 v9, 160, v14
    v_add_u32 v9, s30, v9
    v_bfe_u32 v10, v0, 4, 1
    v_lshl_add_u32 v10, v10, 4, v9
    v_lshl_add_u32 v9, v4, 4, v9
    v_add_u32 v14, 118912, v3
    s_add_u32 s37, s50, 20480
    buffer_load_dwordx4 a[80:83], v3, s[4:7], s37 offen offset:0
    buffer_load_dwordx4 a[84:87], v3, s[4:7], s37 offen offset:1024
    buffer_load_dwordx4 a[88:91], v3, s[4:7], s37 offen offset:2048
    s_add_u32 s37, s50, 8192
    buffer_load_dwordx4 a[32:35], v3, s[4:7], s37 offen offset:0
    s_lshl_b32 s58, s51, 12
    s_add_u32 s58, s58, 26476544
    s_lshl_b32 s56, s20, 15
    s_lshl_b32 s57, s22, 7
    s_add_u32 s56, s56, s57
    s_lshl_b32 s57, s21, 2
    s_add_u32 s56, s56, s57
    s_add_u32 s56, s56, 26476544
    v_lshlrev_b32 v24, 12, v0
    v_mov_b32 v25, 1
    v_lshrrev_b32 v26, 1, v0
    v_lshlrev_b32 v26, 7, v26
    v_and_b32 v27, 1, v0
    v_lshl_add_u32 v26, v27, 4, v26
    s_mov_b32 s57, 0
    buffer_load_dwordx4 a[36:39], v3, s[4:7], s37 offen offset:1024
    buffer_load_dwordx4 a[40:43], v3, s[4:7], s37 offen offset:2048
    buffer_load_dwordx4 a[44:47], v3, s[4:7], s37 offen offset:3072
    s_add_u32 s37, s50, 12288
    buffer_load_dwordx4 a[48:51], v3, s[4:7], s37 offen offset:0
    s_cmp_lg_u32 s20, 3
    s_cbranch_scc1 jn_kp_kernel_28
    s_mov_b32 s59, 5
bo_kp_kernel_31:
    s_nop 7
    s_sub_u32 s59, s59, 1
    s_cmp_lg_u32 s59, 0
    s_cbranch_scc1 bo_kp_kernel_31
gp_kp_kernel_29:
    buffer_load_dwordx4 v[28:31], v26, s[4:7], s58 offen sc1
    s_waitcnt vmcnt(0)
    v_min_u32 v27, v28, v29
    v_min3_u32 v27, v27, v30, v31
    v_cmp_eq_u32 vcc, 0, v27
    s_cbranch_vccz gd_kp_kernel_30
    s_mov_b32 s59, 5
bo_kp_kernel_32:
    s_nop 7
    s_sub_u32 s59, s59, 1
    s_cmp_lg_u32 s59, 0
    s_cbranch_scc1 bo_kp_kernel_32
    s_add_u32 s57, s57, 1
    s_cmp_lt_u32 s57, 524288
    s_cbranch_scc1 gp_kp_kernel_29
gd_kp_kernel_30:
jn_kp_kernel_28:
    s_barrier
    s_add_u32 m0, s29, 0
    s_nop 0
    buffer_load_dwordx4 v3, s[4:7], s25 offen offset:0 sc1 lds
    s_add_u32 m0, m0, 32
    s_nop 0
    buffer_load_dwordx4 v3, s[4:7], s25 offen offset:1024 sc1 lds
    s_add_u32 m0, m0, 32
    s_nop 0
    buffer_load_dwordx4 v3, s[4:7], s25 offen offset:2048 sc1 lds
    s_add_u32 m0, m0, 32
    s_nop 0
    buffer_load_dwordx4 v3, s[4:7], s25 offen offset:3072 sc1 lds
    s_add_u32 s25, s25, 4096
    s_add_u32 m0, m0, 4128
    s_nop 0
    buffer_load_dwordx4 v3, s[4:7], s25 offen offset:0 sc1 lds
    s_add_u32 m0, m0, 32
    s_nop 0
    buffer_load_dwordx4 v3, s[4:7], s25 offen offset:1024 sc1 lds
    s_add_u32 m0, m0, 32
    s_nop 0
    buffer_load_dwordx4 v3, s[4:7], s25 offen offset:2048 sc1 lds
    s_add_u32 m0, m0, 32
    s_nop 0
    buffer_load_dwordx4 v3, s[4:7], s25 offen offset:3072 sc1 lds
    s_add_u32 s25, s25, 28672
    s_add_u32 m0, s29, 33792
    s_nop 0
    buffer_load_dwordx4 v3, s[4:7], s25 offen offset:0 sc1 lds
    s_add_u32 m0, m0, 32
    s_nop 0
    buffer_load_dwordx4 v3, s[4:7], s25 offen offset:1024 sc1 lds
    s_add_u32 m0, m0, 32
    s_nop 0
    buffer_load_dwordx4 v3, s[4:7], s25 offen offset:2048 sc1 lds
    s_add_u32 m0, m0, 32
    s_nop 0
    buffer_load_dwordx4 v3, s[4:7], s25 offen offset:3072 sc1 lds
    s_add_u32 s25, s25, 4096
    s_add_u32 m0, m0, 4128
    s_nop 0
    buffer_load_dwordx4 v3, s[4:7], s25 offen offset:0 sc1 lds
    s_add_u32 m0, m0, 32
    s_nop 0
    buffer_load_dwordx4 v3, s[4:7], s25 offen offset:1024 sc1 lds
    s_add_u32 m0, m0, 32
    s_nop 0
    buffer_load_dwordx4 v3, s[4:7], s25 offen offset:2048 sc1 lds
    s_add_u32 m0, m0, 32
    s_nop 0
    buffer_load_dwordx4 v3, s[4:7], s25 offen offset:3072 sc1 lds
    s_add_u32 s25, s25, 28672
    s_waitcnt vmcnt(8)
    s_barrier
    ds_read_b64_tr_b16 v[60:61], v1 offset:0
    ds_read_b64_tr_b16 v[62:63], v1 offset:8448
    ds_read_b64_tr_b16 v[68:69], v1 offset:256
    ds_read_b64_tr_b16 v[70:71], v1 offset:8704
    ds_read_b64_tr_b16 v[76:77], v1 offset:512
    ds_read_b64_tr_b16 v[78:79], v1 offset:8960
    ds_read_b64_tr_b16 v[84:85], v1 offset:768
    ds_read_b64_tr_b16 v[86:87], v1 offset:9216
    ds_read_b64_tr_b16 v[64:65], v1 offset:16896
    ds_read_b64_tr_b16 v[66:67], v1 offset:25344
    ds_read_b64_tr_b16 v[72:73], v1 offset:17152
    ds_read_b64_tr_b16 v[74:75], v1 offset:25600
    ds_read_b64_tr_b16 v[80:81], v1 offset:17408
    ds_read_b64_tr_b16 v[82:83], v1 offset:25856
    ds_read_b64_tr_b16 v[88:89], v1 offset:17664
    ds_read_b64_tr_b16 v[90:91], v1 offset:26112
    ds_read_b128 v[24:27], v14 offset:0
    ds_read_b128 v[28:31], v14 offset:1024
    s_mov_b32 m0, s40
    s_nop 0
    buffer_load_dwordx4 v7, s[4:7], s39 offen offset:0 sc1 lds
    s_add_u32 m0, m0, 32
    s_nop 0
    buffer_load_dwordx4 v7, s[4:7], s39 offen offset:1024 sc1 lds
    s_add_u32 m0, m0, 32
    s_nop 0
    buffer_load_dwordx4 v7, s[4:7], s39 offen offset:2048 sc1 lds
    s_add_u32 m0, m0, 32
    s_nop 0
    buffer_load_dwordx4 v7, s[4:7], s39 offen offset:3072 sc1 lds
    buffer_load_dwordx4 v[48:51], v48, s[4:7], s31 offen sc1
    ds_read_b128 v[32:35], v2 offset:0
    ds_read_b128 v[36:39], v2 offset:16
    ds_read_b128 v[40:43], v2 offset:32
    ds_read_b128 v[44:47], v2 offset:48
    s_waitcnt lgkmcnt(15)
    v_mfma_f32_16x16x32_f16 v[92:95], v[60:63], v[16:19], 0
    v_mfma_f32_16x16x32_f16 v[96:99], v[68:71], v[16:19], 0
    v_mfma_f32_16x16x32_f16 v[100:103], v[76:79], v[16:19], 0
    s_waitcnt lgkmcnt(14)
    v_mfma_f32_16x16x32_f16 v[104:107], v[84:87], v[16:19], 0
    s_waitcnt lgkmcnt(12)
    v_mfma_f32_16x16x32_f16 v[92:95], v[64:67], v[20:23], v[92:95]
    s_waitcnt lgkmcnt(10)
    v_mfma_f32_16x16x32_f16 v[96:99], v[72:75], v[20:23], v[96:99]
    s_waitcnt lgkmcnt(8)
    v_mfma_f32_16x16x32_f16 v[100:103], v[80:83], v[20:23], v[100:103]
    s_waitcnt lgkmcnt(6)
    v_mfma_f32_16x16x32_f16 v[104:107], v[88:91], v[20:23], v[104:107]
    buffer_load_dwordx4 v[52:55], v52, s[4:7], s31 offen sc1
    s_nop 2
    v_cvt_pk_f16_f32 v108, v92, v96
    s_nop 2
    v_cvt_pk_f16_f32 v109, v100, v104
    buffer_load_dwordx4 v[56:59], v56, s[4:7], s31 offen sc1
    v_cvt_pk_f16_f32 v110, v93, v97
    v_cvt_pk_f16_f32 v111, v101, v105
    v_mov_b32 v116, v108
    v_mov_b32 v117, v109
    v_mov_b32_dpp v108, v110 row_ror:8 row_mask:0xf bank_mask:0xc
    v_mov_b32_dpp v109, v111 row_ror:8 row_mask:0xf bank_mask:0xc
    v_mov_b32_dpp v110, v116 row_ror:8 row_mask:0xf bank_mask:0x3
    v_mov_b32_dpp v111, v117 row_ror:8 row_mask:0xf bank_mask:0x3
    s_waitcnt lgkmcnt(4)
    s_nop 0
    v_mfma_f32_16x16x32_f16 v[118:121], v[24:27], v[108:111], 0
    v_mfma_f32_16x16x32_f16 v[122:125], v[28:31], v[108:111], 0
    v_cvt_pk_f16_f32 v112, v94, v98
    v_cvt_pk_f16_f32 v113, v102, v106
    v_cvt_pk_f16_f32 v114, v95, v99
    buffer_load_dwordx4 a[52:55], v3, s[4:7], s37 offen offset:1024
    v_cvt_pk_f16_f32 v115, v103, v107
    v_mov_b32 v116, v112
    v_mov_b32 v117, v113
    v_mov_b32_dpp v112, v114 row_ror:8 row_mask:0xf bank_mask:0xc
    v_mov_b32_dpp v113, v115 row_ror:8 row_mask:0xf bank_mask:0xc
    v_mov_b32_dpp v114, v116 row_ror:8 row_mask:0xf bank_mask:0x3
    v_mov_b32_dpp v115, v117 row_ror:8 row_mask:0xf bank_mask:0x3
    s_nop 1
    v_mfma_f32_16x16x32_f16 v[126:129], v[24:27], v[112:115], 0
    v_mfma_f32_16x16x32_f16 v[130:133], v[28:31], v[112:115], 0
    s_waitcnt lgkmcnt(0)
    s_waitcnt vmcnt(8)
    s_barrier
    ds_read_b64_tr_b16 v[60:61], v1 offset:33792
    ds_read_b64_tr_b16 v[62:63], v1 offset:42240
    ds_read_b64_tr_b16 v[68:69], v1 offset:34048
    ds_read_b64_tr_b16 v[70:71], v1 offset:42496
    s_add_u32 s37, s50, 32768
    buffer_load_dwordx4 a[128:131], v3, s[4:7], s37 offen offset:0
    ds_read_b64_tr_b16 v[76:77], v1 offset:34304
    ds_read_b64_tr_b16 v[78:79], v1 offset:42752
    ds_read_b64_tr_b16 v[84:85], v1 offset:34560
    ds_read_b64_tr_b16 v[86:87], v1 offset:43008
    ds_read_b64_tr_b16 v[64:65], v1 offset:50688
    ds_read_b64_tr_b16 v[66:67], v1 offset:59136
    ds_read_b64_tr_b16 v[72:73], v1 offset:50944
    ds_read_b64_tr_b16 v[74:75], v1 offset:59392
    ds_read_b64_tr_b16 v[80:81], v1 offset:51200
    ds_read_b64_tr_b16 v[82:83], v1 offset:59648
    ds_read_b64_tr_b16 v[88:89], v1 offset:51456
    ds_read_b64_tr_b16 v[90:91], v1 offset:59904
    buffer_load_dwordx4 a[132:135], v3, s[4:7], s37 offen offset:1024
    v_pk_mul_f32 v[92:93], v[118:119], v[32:33] op_sel_hi:[1,0]
    v_pk_mul_f32 v[100:101], v[126:127], v[40:41] op_sel_hi:[1,0]
    v_pk_fma_f32 v[92:93], v[118:119], v[32:33], v[92:93] op_sel:[1,1,0] op_sel_hi:[0,1,1] neg_hi:[1,0,0]
    v_pk_fma_f32 v[100:101], v[126:127], v[40:41], v[100:101] op_sel:[1,1,0] op_sel_hi:[0,1,1] neg_hi:[1,0,0]
    v_cvt_pk_f16_f32 v108, v92, v93
    v_cvt_pk_f16_f32 v109, v100, v101
    ds_write_b64 v8, v[108:109] offset:0
    v_pk_mul_f32 v[94:95], v[120:121], v[34:35] op_sel_hi:[1,0]
    v_pk_mul_f32 v[102:103], v[128:129], v[42:43] op_sel_hi:[1,0]
    v_pk_fma_f32 v[94:95], v[120:121], v[34:35], v[94:95] op_sel:[1,1,0] op_sel_hi:[0,1,1] neg_hi:[1,0,0]
    v_pk_fma_f32 v[102:103], v[128:129], v[42:43], v[102:103] op_sel:[1,1,0] op_sel_hi:[0,1,1] neg_hi:[1,0,0]
    v_cvt_pk_f16_f32 v110, v94, v95
    buffer_load_dwordx4 a[136:139], v3, s[4:7], s37 offen offset:2048
    v_cvt_pk_f16_f32 v111, v102, v103
    ds_write_b64 v8, v[110:111] offset:160
    v_pk_mul_f32 v[96:97], v[122:123], v[36:37] op_sel_hi:[1,0]
    v_pk_mul_f32 v[104:105], v[130:131], v[44:45] op_sel_hi:[1,0]
    v_pk_fma_f32 v[96:97], v[122:123], v[36:37], v[96:97] op_sel:[1,1,0] op_sel_hi:[0,1,1] neg_hi:[1,0,0]
    v_pk_fma_f32 v[104:105], v[130:131], v[44:45], v[104:105] op_sel:[1,1,0] op_sel_hi:[0,1,1] neg_hi:[1,0,0]
    v_cvt_pk_f16_f32 v112, v96, v97
    v_cvt_pk_f16_f32 v113, v104, v105
    ds_write_b64 v8, v[112:113] offset:1280
    v_pk_mul_f32 v[98:99], v[124:125], v[38:39] op_sel_hi:[1,0]
    v_pk_mul_f32 v[106:107], v[132:133], v[46:47] op_sel_hi:[1,0]
    v_pk_fma_f32 v[98:99], v[124:125], v[38:39], v[98:99] op_sel:[1,1,0] op_sel_hi:[0,1,1] neg_hi:[1,0,0]
    buffer_load_dwordx4 a[140:143], v3, s[4:7], s37 offen offset:3072
    v_pk_fma_f32 v[106:107], v[132:133], v[46:47], v[106:107] op_sel:[1,1,0] op_sel_hi:[0,1,1] neg_hi:[1,0,0]
    v_cvt_pk_f16_f32 v114, v98, v99
    v_cvt_pk_f16_f32 v115, v106, v107
    ds_write_b64 v8, v[114:115] offset:1440
    ds_read_b128 v[32:35], v2 offset:2048
    ds_read_b128 v[36:39], v2 offset:2064
    ds_read_b128 v[40:43], v2 offset:2080
    ds_read_b128 v[44:47], v2 offset:2096
    s_waitcnt lgkmcnt(15)
    v_mfma_f32_16x16x32_f16 v[92:95], v[60:63], v[16:19], 0
    v_mfma_f32_16x16x32_f16 v[96:99], v[68:71], v[16:19], 0
    v_mfma_f32_16x16x32_f16 v[100:103], v[76:79], v[16:19], 0
    v_mfma_f32_16x16x32_f16 v[104:107], v[84:87], v[16:19], 0
    s_waitcnt lgkmcnt(14)
    v_mfma_f32_16x16x32_f16 v[92:95], v[64:67], v[20:23], v[92:95]
    s_waitcnt lgkmcnt(12)
    v_mfma_f32_16x16x32_f16 v[96:99], v[72:75], v[20:23], v[96:99]
    s_waitcnt lgkmcnt(10)
    s_add_u32 s37, s50, 36864
    buffer_load_dwordx4 a[144:147], v3, s[4:7], s37 offen offset:0
    v_mfma_f32_16x16x32_f16 v[100:103], v[80:83], v[20:23], v[100:103]
    s_waitcnt lgkmcnt(8)
    v_mfma_f32_16x16x32_f16 v[104:107], v[88:91], v[20:23], v[104:107]
    buffer_load_dwordx4 a[148:151], v3, s[4:7], s37 offen offset:1024
    s_nop 0
    v_cvt_pk_f16_f32 v108, v92, v96
    s_nop 4
    v_cvt_pk_f16_f32 v109, v100, v104
    v_cvt_pk_f16_f32 v110, v93, v97
    v_cvt_pk_f16_f32 v111, v101, v105
    v_mov_b32 v116, v108
    v_mov_b32 v117, v109
    v_mov_b32_dpp v108, v110 row_ror:8 row_mask:0xf bank_mask:0xc
    v_mov_b32_dpp v109, v111 row_ror:8 row_mask:0xf bank_mask:0xc
    v_mov_b32_dpp v110, v116 row_ror:8 row_mask:0xf bank_mask:0x3
    v_mov_b32_dpp v111, v117 row_ror:8 row_mask:0xf bank_mask:0x3
    s_nop 1
    v_mfma_f32_16x16x32_f16 v[118:121], v[24:27], v[108:111], 0
    v_mfma_f32_16x16x32_f16 v[122:125], v[28:31], v[108:111], 0
    v_cvt_pk_f16_f32 v112, v94, v98
    buffer_load_dwordx4 a[152:155], v3, s[4:7], s37 offen offset:2048
    v_cvt_pk_f16_f32 v113, v102, v106
    v_cvt_pk_f16_f32 v114, v95, v99
    v_cvt_pk_f16_f32 v115, v103, v107
    v_mov_b32 v116, v112
    v_mov_b32 v117, v113
    v_mov_b32_dpp v112, v114 row_ror:8 row_mask:0xf bank_mask:0xc
    v_mov_b32_dpp v113, v115 row_ror:8 row_mask:0xf bank_mask:0xc
    v_mov_b32_dpp v114, v116 row_ror:8 row_mask:0xf bank_mask:0x3
    v_mov_b32_dpp v115, v117 row_ror:8 row_mask:0xf bank_mask:0x3
    s_nop 1
    v_mfma_f32_16x16x32_f16 v[126:129], v[24:27], v[112:115], 0
    v_mfma_f32_16x16x32_f16 v[130:133], v[28:31], v[112:115], 0
    s_waitcnt lgkmcnt(0)
    s_waitcnt vmcnt(8)
    s_barrier
    ds_read_b64_tr_b16 v[60:61], v5 offset:0
    ds_read_b64_tr_b16 v[62:63], v5 offset:4224
    buffer_load_dwordx4 a[156:159], v3, s[4:7], s37 offen offset:3072
    ds_read_b64_tr_b16 v[68:69], v6 offset:0
    ds_read_b64_tr_b16 v[70:71], v6 offset:4224
    ds_read_b64_tr_b16 v[76:77], v5 offset:256
    ds_read_b64_tr_b16 v[78:79], v5 offset:4480
    ds_read_b64_tr_b16 v[84:85], v6 offset:256
    ds_read_b64_tr_b16 v[86:87], v6 offset:4480
    ds_read_b64_tr_b16 v[64:65], v5 offset:8448
    ds_read_b64_tr_b16 v[66:67], v5 offset:12672
    ds_read_b64_tr_b16 v[72:73], v6 offset:8448
    ds_read_b64_tr_b16 v[74:75], v6 offset:12672
    ds_read_b64_tr_b16 v[80:81], v5 offset:8704
    ds_read_b64_tr_b16 v[82:83], v5 offset:12928
    s_add_u32 s37, s50, 40960
    buffer_load_dwordx4 a[160:163], v3, s[4:7], s37 offen offset:0
    ds_read_b64_tr_b16 v[88:89], v6 offset:8704
    ds_read_b64_tr_b16 v[90:91], v6 offset:12928
    v_pk_mul_f32 v[92:93], v[118:119], v[32:33] op_sel_hi:[1,0]
    v_pk_mul_f32 v[100:101], v[126:127], v[40:41] op_sel_hi:[1,0]
    v_pk_fma_f32 v[92:93], v[118:119], v[32:33], v[92:93] op_sel:[1,1,0] op_sel_hi:[0,1,1] neg_hi:[1,0,0]
    v_pk_fma_f32 v[100:101], v[126:127], v[40:41], v[100:101] op_sel:[1,1,0] op_sel_hi:[0,1,1] neg_hi:[1,0,0]
    v_cvt_pk_f16_f32 v108, v92, v93
    v_cvt_pk_f16_f32 v109, v100, v101
    ds_write_b64 v8, v[108:109] offset:64
    v_pk_mul_f32 v[94:95], v[120:121], v[34:35] op_sel_hi:[1,0]
    v_pk_mul_f32 v[102:103], v[128:129], v[42:43] op_sel_hi:[1,0]
    v_pk_fma_f32 v[94:95], v[120:121], v[34:35], v[94:95] op_sel:[1,1,0] op_sel_hi:[0,1,1] neg_hi:[1,0,0]
    buffer_load_dwordx4 a[164:167], v3, s[4:7], s37 offen offset:1024
    v_pk_fma_f32 v[102:103], v[128:129], v[42:43], v[102:103] op_sel:[1,1,0] op_sel_hi:[0,1,1] neg_hi:[1,0,0]
    v_cvt_pk_f16_f32 v110, v94, v95
    v_cvt_pk_f16_f32 v111, v102, v103
    ds_write_b64 v8, v[110:111] offset:224
    v_pk_mul_f32 v[96:97], v[122:123], v[36:37] op_sel_hi:[1,0]
    v_pk_mul_f32 v[104:105], v[130:131], v[44:45] op_sel_hi:[1,0]
    v_pk_fma_f32 v[96:97], v[122:123], v[36:37], v[96:97] op_sel:[1,1,0] op_sel_hi:[0,1,1] neg_hi:[1,0,0]
    v_pk_fma_f32 v[104:105], v[130:131], v[44:45], v[104:105] op_sel:[1,1,0] op_sel_hi:[0,1,1] neg_hi:[1,0,0]
    v_cvt_pk_f16_f32 v112, v96, v97
    v_cvt_pk_f16_f32 v113, v104, v105
    ds_write_b64 v8, v[112:113] offset:1344
    v_pk_mul_f32 v[98:99], v[124:125], v[38:39] op_sel_hi:[1,0]
    buffer_load_dwordx4 a[168:171], v3, s[4:7], s37 offen offset:2048
    v_pk_mul_f32 v[106:107], v[132:133], v[46:47] op_sel_hi:[1,0]
    v_pk_fma_f32 v[98:99], v[124:125], v[38:39], v[98:99] op_sel:[1,1,0] op_sel_hi:[0,1,1] neg_hi:[1,0,0]
    v_pk_fma_f32 v[106:107], v[132:133], v[46:47], v[106:107] op_sel:[1,1,0] op_sel_hi:[0,1,1] neg_hi:[1,0,0]
    v_cvt_pk_f16_f32 v114, v98, v99
    v_cvt_pk_f16_f32 v115, v106, v107
    ds_write_b64 v8, v[114:115] offset:1504
    s_cmp_ge_u32 s20, 2
    s_cbranch_scc1 q2_kp_kernel_34
    ds_read_b128 v[32:35], v2 offset:4096
    ds_read_b128 v[36:39], v2 offset:4112
    s_waitcnt lgkmcnt(15)
    v_mfma_f32_16x16x32_f16 v[92:95], v[60:63], v[16:19], 0
    v_mfma_f32_16x16x32_f16 v[96:99], v[68:71], v[16:19], 0
    v_mfma_f32_16x16x32_f16 v[100:103], v[76:79], v[16:19], 0
    s_waitcnt lgkmcnt(14)
    v_mfma_f32_16x16x32_f16 v[104:107], v[84:87], v[16:19], 0
    s_waitcnt lgkmcnt(12)
    v_mfma_f32_16x16x32_f16 v[92:95], v[64:67], v[20:23], v[92:95]
    s_waitcnt lgkmcnt(10)
    s_add_u32 s37, s50, 40960
    buffer_load_dwordx4 a[172:175], v3, s[4:7], s37 offen offset:3072
    v_mfma_f32_16x16x32_f16 v[96:99], v[72:75], v[20:23], v[96:99]
    s_waitcnt lgkmcnt(8)
    v_mfma_f32_16x16x32_f16 v[100:103], v[80:83], v[20:23], v[100:103]
    s_waitcnt lgkmcnt(6)
    v_mfma_f32_16x16x32_f16 v[104:107], v[88:91], v[20:23], v[104:107]
    s_add_u32 s37, s50, 45056
    buffer_load_dwordx4 a[176:179], v3, s[4:7], s37 offen offset:0
    s_nop 1
    v_cvt_pk_f16_f32 v108, v92, v96
    s_nop 2
    v_cvt_pk_f16_f32 v109, v100, v104
    v_cvt_pk_f16_f32 v110, v93, v97
    v_cvt_pk_f16_f32 v111, v101, v105
    v_mov_b32 v116, v108
    v_mov_b32 v117, v109
    v_mov_b32_dpp v108, v110 row_ror:8 row_mask:0xf bank_mask:0xc
    v_mov_b32_dpp v109, v111 row_ror:8 row_mask:0xf bank_mask:0xc
    v_mov_b32_dpp v110, v116 row_ror:8 row_mask:0xf bank_mask:0x3
    v_mov_b32_dpp v111, v117 row_ror:8 row_mask:0xf bank_mask:0x3
    buffer_load_dwordx4 a[180:183], v3, s[4:7], s37 offen offset:1024
    s_nop 0
    v_mfma_f32_16x16x32_f16 v[118:121], v[24:27], v[108:111], 0
    v_mfma_f32_16x16x32_f16 v[122:125], v[28:31], v[108:111], 0
    s_waitcnt lgkmcnt(0)
    s_nop 5
    v_pk_mul_f32 v[92:93], v[118:119], v[32:33] op_sel_hi:[1,0]
    v_pk_fma_f32 v[92:93], v[118:119], v[32:33], v[92:93] op_sel:[1,1,0] op_sel_hi:[0,1,1] neg_hi:[1,0,0]
    v_cvt_pk_f16_f32 v108, v92, v93
    ds_write_b32 v8, v108 offset:128
    v_pk_mul_f32 v[94:95], v[120:121], v[34:35] op_sel_hi:[1,0]
    v_pk_fma_f32 v[94:95], v[120:121], v[34:35], v[94:95] op_sel:[1,1,0] op_sel_hi:[0,1,1] neg_hi:[1,0,0]
    v_cvt_pk_f16_f32 v110, v94, v95
    ds_write_b32 v8, v110 offset:288
    v_pk_mul_f32 v[96:97], v[122:123], v[36:37] op_sel_hi:[1,0]
    v_pk_fma_f32 v[96:97], v[122:123], v[36:37], v[96:97] op_sel:[1,1,0] op_sel_hi:[0,1,1] neg_hi:[1,0,0]
    v_cvt_pk_f16_f32 v112, v96, v97
    buffer_load_dwordx4 a[184:187], v3, s[4:7], s37 offen offset:2048
    ds_write_b32 v8, v112 offset:1408
    v_pk_mul_f32 v[98:99], v[124:125], v[38:39] op_sel_hi:[1,0]
    v_pk_fma_f32 v[98:99], v[124:125], v[38:39], v[98:99] op_sel:[1,1,0] op_sel_hi:[0,1,1] neg_hi:[1,0,0]
    v_cvt_pk_f16_f32 v114, v98, v99
    ds_write_b32 v8, v114 offset:1568
    s_branch q2e_kp_kernel_35
q2_kp_kernel_34:
    v_subrev_u32 v2, 1024, v2
    ds_read_b128 v[40:43], v2 offset:4128
    ds_read_b128 v[44:47], v2 offset:4144
    s_waitcnt lgkmcnt(15)
    v_mfma_f32_16x16x32_f16 v[92:95], v[60:63], v[16:19], 0
    v_mfma_f32_16x16x32_f16 v[96:99], v[68:71], v[16:19], 0
    v_mfma_f32_16x16x32_f16 v[100:103], v[76:79], v[16:19], 0
    s_waitcnt lgkmcnt(14)
    v_mfma_f32_16x16x32_f16 v[104:107], v[84:87], v[16:19], 0
    s_waitcnt lgkmcnt(12)
    v_mfma_f32_16x16x32_f16 v[92:95], v[64:67], v[20:23], v[92:95]
    s_waitcnt lgkmcnt(10)
    s_add_u32 s37, s50, 40960
    buffer_load_dwordx4 a[172:175], v3, s[4:7], s37 offen offset:3072
    v_mfma_f32_16x16x32_f16 v[96:99], v[72:75], v[20:23], v[96:99]
    s_waitcnt lgkmcnt(8)
    v_mfma_f32_16x16x32_f16 v[100:103], v[80:83], v[20:23], v[100:103]
    s_waitcnt lgkmcnt(6)
    v_mfma_f32_16x16x32_f16 v[104:107], v[88:91], v[20:23], v[104:107]
    s_add_u32 s37, s50, 45056
    buffer_load_dwordx4 a[176:179], v3, s[4:7], s37 offen offset:0
    s_nop 1
    v_cvt_pk_f16_f32 v112, v94, v98
    s_nop 2
    v_cvt_pk_f16_f32 v113, v102, v106
    v_cvt_pk_f16_f32 v114, v95, v99
    v_cvt_pk_f16_f32 v115, v103, v107
    v_mov_b32 v116, v112
    v_mov_b32 v117, v113
    v_mov_b32_dpp v112, v114 row_ror:8 row_mask:0xf bank_mask:0xc
    v_mov_b32_dpp v113, v115 row_ror:8 row_mask:0xf bank_mask:0xc
    v_mov_b32_dpp v114, v116 row_ror:8 row_mask:0xf bank_mask:0x3
    v_mov_b32_dpp v115, v117 row_ror:8 row_mask:0xf bank_mask:0x3
    buffer_load_dwordx4 a[180:183], v3, s[4:7], s37 offen offset:1024
    s_nop 0
    v_mfma_f32_16x16x32_f16 v[126:129], v[24:27], v[112:115], 0
    v_mfma_f32_16x16x32_f16 v[130:133], v[28:31], v[112:115], 0
    s_waitcnt lgkmcnt(0)
    s_nop 5
    v_pk_mul_f32 v[100:101], v[126:127], v[40:41] op_sel_hi:[1,0]
    v_pk_fma_f32 v[100:101], v[126:127], v[40:41], v[100:101] op_sel:[1,1,0] op_sel_hi:[0,1,1] neg_hi:[1,0,0]
    v_cvt_pk_f16_f32 v109, v100, v101
    ds_write_b32 v8, v109 offset:100
    v_pk_mul_f32 v[102:103], v[128:129], v[42:43] op_sel_hi:[1,0]
    v_pk_fma_f32 v[102:103], v[128:129], v[42:43], v[102:103] op_sel:[1,1,0] op_sel_hi:[0,1,1] neg_hi:[1,0,0]
    v_cvt_pk_f16_f32 v111, v102, v103
    ds_write_b32 v8, v111 offset:260
    v_pk_mul_f32 v[104:105], v[130:131], v[44:45] op_sel_hi:[1,0]
    v_pk_fma_f32 v[104:105], v[130:131], v[44:45], v[104:105] op_sel:[1,1,0] op_sel_hi:[0,1,1] neg_hi:[1,0,0]
    v_cvt_pk_f16_f32 v113, v104, v105
    buffer_load_dwordx4 a[184:187], v3, s[4:7], s37 offen offset:2048
    ds_write_b32 v8, v113 offset:1380
    v_pk_mul_f32 v[106:107], v[132:133], v[46:47] op_sel_hi:[1,0]
    v_pk_fma_f32 v[106:107], v[132:133], v[46:47], v[106:107] op_sel:[1,1,0] op_sel_hi:[0,1,1] neg_hi:[1,0,0]
    v_cvt_pk_f16_f32 v115, v106, v107
    ds_write_b32 v8, v115 offset:1540
q2e_kp_kernel_35:
    s_waitcnt lgkmcnt(0)
    s_barrier
    ds_read_b128 v[60:63], v9 offset:0
    ds_read_b128 v[72:75], v9 offset:2576
    ds_read_b128 v[16:19], v14 offset:2048
    ds_read_b128 v[28:31], v14 offset:5120
    ds_read_b128 v[40:43], v14 offset:8192
    ds_read_b128 v[64:67], v9 offset:64
    ds_read_b128 v[76:79], v9 offset:2640
    ds_read_b128 v[20:23], v14 offset:3072
    ds_read_b128 v[32:35], v14 offset:6144
    ds_read_b128 v[44:47], v14 offset:9216
    ds_read_b128 v[68:71], v10 offset:128
    ds_read_b128 v[80:83], v10 offset:2704
    ds_read_b128 v[24:27], v14 offset:4096
    ds_read_b128 v[36:39], v14 offset:7168
    ds_read_b128 v[84:87], v14 offset:10240
    s_add_u32 s37, s50, 45056
    buffer_load_dwordx4 a[188:191], v3, s[4:7], s37 offen offset:3072
    s_add_u32 s37, s50, 49152
    buffer_load_dwordx4 a[192:195], v3, s[4:7], s37 offen offset:0
    v_permlane16_swap_b32 v48, v50
    buffer_load_dwordx4 a[196:199], v3, s[4:7], s37 offen offset:1024
    v_permlane16_swap_b32 v49, v51
    v_lshlrev_b32 v116, 16, v48
    v_and_b32 v117, 0xffff0000, v48
    buffer_load_dwordx4 a[200:203], v3, s[4:7], s37 offen offset:2048
    v_lshlrev_b32 v118, 16, v49
    v_and_b32 v119, 0xffff0000, v49
    v_lshlrev_b32 v128, 16, v50
    buffer_load_dwordx4 a[204:207], v3, s[4:7], s37 offen offset:3072
    v_and_b32 v129, 0xffff0000, v50
    v_lshlrev_b32 v130, 16, v51
    v_and_b32 v131, 0xffff0000, v51
    v_permlane16_swap_b32 v52, v54
    v_permlane16_swap_b32 v53, v55
    v_lshlrev_b32 v120, 16, v52
    v_and_b32 v121, 0xffff0000, v52
    v_lshlrev_b32 v122, 16, v53
    v_and_b32 v123, 0xffff0000, v53
    v_lshlrev_b32 v132, 16, v54
    v_and_b32 v133, 0xffff0000, v54
    v_lshlrev_b32 v134, 16, v55
    v_and_b32 v135, 0xffff0000, v55
    v_permlane16_swap_b32 v56, v58
    v_permlane16_swap_b32 v57, v59
    v_lshlrev_b32 v124, 16, v56
    v_and_b32 v125, 0xffff0000, v56
    v_lshlrev_b32 v126, 16, v57
    v_and_b32 v127, 0xffff0000, v57
    v_lshlrev_b32 v136, 16, v58
    v_and_b32 v137, 0xffff0000, v58
    v_lshlrev_b32 v138, 16, v59
    v_and_b32 v139, 0xffff0000, v59
    s_waitcnt lgkmcnt(12)
    v_mfma_f32_16x16x32_f16 v[92:95], v[60:63], v[16:19], 0
    v_mfma_f32_16x16x32_f16 v[104:107], v[72:75], v[16:19], 0
    s_waitcnt lgkmcnt(11)
    v_mfma_f32_16x16x32_f16 v[96:99], v[60:63], v[28:31], 0
    v_mfma_f32_16x16x32_f16 v[108:111], v[72:75], v[28:31], 0
    s_waitcnt lgkmcnt(10)
    v_mfma_f32_16x16x32_f16 v[100:103], v[60:63], v[40:43], 0
    v_mfma_f32_16x16x32_f16 v[112:115], v[72:75], v[40:43], 0
    s_waitcnt lgkmcnt(7)
    v_mfma_f32_16x16x32_f16 v[92:95], v[64:67], v[20:23], v[92:95]
    v_mfma_f32_16x16x32_f16 v[104:107], v[76:79], v[20:23], v[104:107]
    s_waitcnt lgkmcnt(6)
    v_mfma_f32_16x16x32_f16 v[96:99], v[64:67], v[32:35], v[96:99]
    v_mfma_f32_16x16x32_f16 v[108:111], v[76:79], v[32:35], v[108:111]
    s_waitcnt lgkmcnt(5)
    v_mfma_f32_16x16x32_f16 v[100:103], v[64:67], v[44:47], v[100:103]
    v_mfma_f32_16x16x32_f16 v[112:115], v[76:79], v[44:47], v[112:115]
    s_waitcnt lgkmcnt(2)
    v_mfma_f32_16x16x32_f16 v[92:95], v[68:71], v[24:27], v[92:95]
    v_mfma_f32_16x16x32_f16 v[104:107], v[80:83], v[24:27], v[104:107]
    s_waitcnt lgkmcnt(1)
    v_mfma_f32_16x16x32_f16 v[96:99], v[68:71], v[36:39], v[96:99]
    v_mfma_f32_16x16x32_f16 v[108:111], v[80:83], v[36:39], v[108:111]
    s_waitcnt lgkmcnt(0)
    v_mfma_f32_16x16x32_f16 v[100:103], v[68:71], v[84:87], v[100:103]
    v_mfma_f32_16x16x32_f16 v[112:115], v[80:83], v[84:87], v[112:115]
    s_mov_b32 s44, 0x41000000
    v_pk_fma_f32 v[92:93], v[92:93], s[44:45], v[116:117] op_sel_hi:[1,0,1]
    v_pk_fma_f32 v[104:105], v[104:105], s[44:45], v[128:129] op_sel_hi:[1,0,1]
    v_pk_fma_f32 v[94:95], v[94:95], s[44:45], v[118:119] op_sel_hi:[1,0,1]
    v_pk_fma_f32 v[106:107], v[106:107], s[44:45], v[130:131] op_sel_hi:[1,0,1]
    v_pk_fma_f32 v[96:97], v[96:97], s[44:45], v[120:121] op_sel_hi:[1,0,1]
    v_pk_fma_f32 v[108:109], v[108:109], s[44:45], v[132:133] op_sel_hi:[1,0,1]
    v_pk_fma_f32 v[98:99], v[98:99], s[44:45], v[122:123] op_sel_hi:[1,0,1]
    v_pk_fma_f32 v[110:111], v[110:111], s[44:45], v[134:135] op_sel_hi:[1,0,1]
    v_pk_fma_f32 v[100:101], v[100:101], s[44:45], v[124:125] op_sel_hi:[1,0,1]
    v_pk_fma_f32 v[112:113], v[112:113], s[44:45], v[136:137] op_sel_hi:[1,0,1]
    v_pk_fma_f32 v[102:103], v[102:103], s[44:45], v[126:127] op_sel_hi:[1,0,1]
    v_pk_fma_f32 v[114:115], v[114:115], s[44:45], v[138:139] op_sel_hi:[1,0,1]
    v_pk_mul_f32 v[52:53], v[92:93], v[92:93]
    v_pk_mul_f32 v[54:55], v[104:105], v[104:105]
    v_pk_add_f32 v[48:49], v[92:93], v[94:95]
    v_pk_fma_f32 v[52:53], v[94:95], v[94:95], v[52:53]
    v_pk_add_f32 v[50:51], v[104:105], v[106:107]
    v_pk_fma_f32 v[54:55], v[106:107], v[106:107], v[54:55]
    v_pk_add_f32 v[48:49], v[48:49], v[96:97]
    v_pk_fma_f32 v[52:53], v[96:97], v[96:97], v[52:53]
    v_pk_add_f32 v[50:51], v[50:51], v[108:109]
    v_pk_fma_f32 v[54:55], v[108:109], v[108:109], v[54:55]
    v_pk_add_f32 v[48:49], v[48:49], v[98:99]
    v_pk_fma_f32 v[52:53], v[98:99], v[98:99], v[52:53]
    v_pk_add_f32 v[50:51], v[50:51], v[110:111]
    v_pk_fma_f32 v[54:55], v[110:111], v[110:111], v[54:55]
    v_pk_add_f32 v[48:49], v[48:49], v[100:101]
    v_pk_fma_f32 v[52:53], v[100:101], v[100:101], v[52:53]
    v_pk_add_f32 v[50:51], v[50:51], v[112:113]
    v_pk_fma_f32 v[54:55], v[112:113], v[112:113], v[54:55]
    v_pk_add_f32 v[48:49], v[48:49], v[102:103]
    v_pk_fma_f32 v[52:53], v[102:103], v[102:103], v[52:53]
    v_pk_add_f32 v[50:51], v[50:51], v[114:115]
    v_pk_fma_f32 v[54:55], v[114:115], v[114:115], v[54:55]
    v_add_f32 v48, v48, v49
    v_add_f32 v50, v50, v51
    v_add_f32 v52, v52, v53
    v_add_f32 v54, v54, v55
    v_cvt_pk_bf16_f32 v60, v92, v93
    v_cvt_pk_bf16_f32 v61, v94, v95
    v_permlane32_swap_b32 v48, v50
    v_permlane32_swap_b32 v52, v54
    v_add_f32 v48, v48, v50
    v_add_f32 v52, v52, v54
    v_cvt_pk_bf16_f32 v62, v104, v105
    v_cvt_pk_bf16_f32 v63, v106, v107
    v_permlane16_swap_b32 v48, v52
    v_add_f32 v48, v48, v52
    v_cvt_pk_bf16_f32 v64, v96, v97
    v_cvt_pk_bf16_f32 v65, v98, v99
    v_add_f32_dpp v48, v48, v48 quad_perm:[1,0,3,2] row_mask:0xf bank_mask:0xf
    v_cvt_pk_bf16_f32 v66, v108, v109
    v_cvt_pk_bf16_f32 v67, v110, v111
    v_add_f32_dpp v48, v48, v48 quad_perm:[2,3,0,1] row_mask:0xf bank_mask:0xf
    v_cvt_pk_bf16_f32 v68, v100, v101
    v_cvt_pk_bf16_f32 v69, v102, v103
    v_add_f32_dpp v48, v48, v48 row_half_mirror row_mask:0xf bank_mask:0xf
    v_cvt_pk_bf16_f32 v70, v112, v113
    v_cvt_pk_bf16_f32 v71, v114, v115
    v_add_f32_dpp v48, v48, v48 row_mirror row_mask:0xf bank_mask:0xf
    v_mul_f32 v48, 0x3acccccd, v48
    v_mov_b32 v53, 0x3727c5ac
    v_readlane_b32 s46, v48, 0
    v_readlane_b32 s47, v48, 16
    v_readlane_b32 s48, v48, 32
    v_readlane_b32 s49, v48, 48
    v_cmp_u_f32 vcc, v48, v48
    s_cbranch_vccnz rd_kp_kernel_36
rb_kp_kernel_37:
    v_mov_b32 v48, s46
    v_add_f32 v49, s47, v53
    v_mov_b32 v50, s48
    v_add_f32 v51, s49, v53
    v_fma_f32 v49, -v48, v48, v49
    v_fma_f32 v51, -v50, v50, v51
    v_max_f32 v49, v53, v49
    v_max_f32 v51, v53, v51
    v_rsq_f32 v49, v49
    v_rsq_f32 v51, v51
    s_add_u32 s30, s33, 2621440
    s_add_u32 s56, s33, 27262976
    v_mul_f32 v48, v48, v49
    v_mul_f32 v50, v50, v51
    v_pk_fma_f32 v[92:93], v[92:93], v[48:49], v[48:49] op_sel:[0,1,0] op_sel_hi:[1,1,0] neg_lo:[0,0,1] neg_hi:[0,0,1]
    v_pk_fma_f32 v[94:95], v[94:95], v[48:49], v[48:49] op_sel:[0,1,0] op_sel_hi:[1,1,0] neg_lo:[0,0,1] neg_hi:[0,0,1]
    v_pk_fma_f32 v[104:105], v[104:105], v[50:51], v[50:51] op_sel:[0,1,0] op_sel_hi:[1,1,0] neg_lo:[0,0,1] neg_hi:[0,0,1]
    v_pk_fma_f32 v[106:107], v[106:107], v[50:51], v[50:51] op_sel:[0,1,0] op_sel_hi:[1,1,0] neg_lo:[0,0,1] neg_hi:[0,0,1]
    v_cvt_pk_bf16_f32 v72, v92, v93
    v_cvt_pk_bf16_f32 v73, v94, v95
    v_cvt_pk_bf16_f32 v74, v104, v105
    v_cvt_pk_bf16_f32 v75, v106, v107
    s_nop 0
    v_permlane16_swap_b32 v72, v74
    v_permlane16_swap_b32 v73, v75
    buffer_store_dwordx4 v[72:75], v13, s[4:7], s30 offen offset:0 sc1
    v_pk_fma_f32 v[96:97], v[96:97], v[48:49], v[48:49] op_sel:[0,1,0] op_sel_hi:[1,1,0] neg_lo:[0,0,1] neg_hi:[0,0,1]
    v_pk_fma_f32 v[98:99], v[98:99], v[48:49], v[48:49] op_sel:[0,1,0] op_sel_hi:[1,1,0] neg_lo:[0,0,1] neg_hi:[0,0,1]
    v_pk_fma_f32 v[108:109], v[108:109], v[50:51], v[50:51] op_sel:[0,1,0] op_sel_hi:[1,1,0] neg_lo:[0,0,1] neg_hi:[0,0,1]
    v_pk_fma_f32 v[110:111], v[110:111], v[50:51], v[50:51] op_sel:[0,1,0] op_sel_hi:[1,1,0] neg_lo:[0,0,1] neg_hi:[0,0,1]
    v_cvt_pk_bf16_f32 v76, v96, v97
    v_cvt_pk_bf16_f32 v77, v98, v99
    v_cvt_pk_bf16_f32 v78, v108, v109
    v_cvt_pk_bf16_f32 v79, v110, v111
    s_nop 0
    v_permlane16_swap_b32 v76, v78
    v_permlane16_swap_b32 v77, v79
    buffer_store_dwordx4 v[76:79], v13, s[4:7], s30 offen offset:512 sc1
    v_pk_fma_f32 v[100:101], v[100:101], v[48:49], v[48:49] op_sel:[0,1,0] op_sel_hi:[1,1,0] neg_lo:[0,0,1] neg_hi:[0,0,1]
    v_pk_fma_f32 v[102:103], v[102:103], v[48:49], v[48:49] op_sel:[0,1,0] op_sel_hi:[1,1,0] neg_lo:[0,0,1] neg_hi:[0,0,1]
    v_pk_fma_f32 v[112:113], v[112:113], v[50:51], v[50:51] op_sel:[0,1,0] op_sel_hi:[1,1,0] neg_lo:[0,0,1] neg_hi:[0,0,1]
    v_pk_fma_f32 v[114:115], v[114:115], v[50:51], v[50:51] op_sel:[0,1,0] op_sel_hi:[1,1,0] neg_lo:[0,0,1] neg_hi:[0,0,1]
    v_cvt_pk_bf16_f32 v80, v100, v101
    v_cvt_pk_bf16_f32 v81, v102, v103
    v_cvt_pk_bf16_f32 v82, v112, v113
    v_cvt_pk_bf16_f32 v83, v114, v115
    s_nop 0
    v_permlane16_swap_b32 v80, v82
    v_permlane16_swap_b32 v81, v83
    buffer_store_dwordx4 v[80:83], v15, s[4:7], s30 offen offset:1024 sc1
    s_add_u32 s38, s52, 40960
    buffer_load_dwordx4 v[84:87], v3, s[4:7], s38 offen offset:1024
    buffer_load_dwordx4 v[88:91], v3, s[4:7], s38 offen offset:2048
    buffer_load_dwordx4 v[92:95], v3, s[4:7], s38 offen offset:3072
    s_add_u32 s38, s52, 45056
    buffer_load_dwordx4 v[96:99], v3, s[4:7], s38 offen offset:0
    buffer_load_dwordx4 v[100:103], v3, s[4:7], s38 offen offset:1024
    buffer_load_dwordx4 v[104:107], v3, s[4:7], s38 offen offset:2048
    buffer_load_dwordx4 v[108:111], v3, s[4:7], s38 offen offset:3072
    s_add_u32 s38, s52, 49152
    buffer_load_dwordx4 v[112:115], v3, s[4:7], s38 offen offset:0
    v_permlane16_swap_b32 v60, v62
    v_permlane16_swap_b32 v61, v63
    v_permlane16_swap_b32 v64, v66
    v_permlane16_swap_b32 v65, v67
    v_permlane16_swap_b32 v68, v70
    v_permlane16_swap_b32 v69, v71
    v_lshrrev_b32 v6, 3, v0
    v_and_b32 v7, 7, v0
    v_xor_b32 v7, v7, v6
    v_mul_u32_u24 v137, 1280, v6
    v_lshl_add_u32 v137, v7, 4, v137
    v_lshrrev_b32 v6, 4, v0
    v_and_b32 v7, 7, v0
    v_xor_b32 v6, v6, v7
    v_lshlrev_b32 v6, 4, v6
    v_lshl_add_u32 v6, v7, 7, v6
    v_bfe_u32 v7, v0, 3, 1
    v_lshl_add_u32 v1, v7, 10, v6
    v_xor_b32 v2, 64, v1
    v_and_b32 v0, 7, v0
    v_lshlrev_b32 v0, 2, v0
    v_mov_b32 v22, 1
    v_mov_b32 v138, v13
    v_mov_b32 v139, v15
    s_add_u32 s30, s33, 5242880
    s_lshr_b32 s26, s20, 1
    s_and_b32 s27, s20, 1
    s_mul_i32 s34, s22, 81920
    s_mul_i32 s29, s26, 10240
    s_add_u32 s28, s34, s29
    s_add_u32 s28, s28, 2621440
    s_mul_i32 s29, s27, 640
    s_add_u32 s39, s28, s29
    s_add_u32 s47, s39, 128
    s_add_u32 s90, s39, 256
    s_add_u32 s91, s39, 384
    s_add_u32 s58, s39, 512
    s_mul_i32 s29, s27, 10240
    s_lshl_b32 s31, s26, 10
    s_add_u32 s29, s29, s31
    s_mul_i32 s48, s20, 20480
    s_add_u32 s48, s48, s34
    s_mul_i32 s36, s21, 160
    s_add_u32 s48, s48, s36
    s_add_u32 s48, s48, 5242880
    s_lshl_b32 s32, s26, 5
    s_lshl_b32 s33, s27, 10
    s_add_u32 s32, s32, s33
    s_add_u32 s32, s32, s23
    s_mul_i32 s32, s32, 1280
    s_add_u32 s31, s32, s36
    s_mov_b32 s32, 81920
    s_lshl_b32 s33, s20, 11
    s_lshl_b32 s40, s22, 3
    s_add_u32 s41, s40, s21
    s_mul_i32 s41, s41, 24576
    s_add_u32 s41, s41, 10485760
    s_lshl_b32 s43, s20, 10
    s_add_u32 s41, s41, s43
    s_add_u32 s42, s41, 16384
    s_lshl_b32 s26, s20, 1
    s_add_u32 s26, s26, s40
    s_mul_i32 s26, s26, 24576
    s_add_u32 s26, s26, 10485760
    s_add_u32 s27, s26, 24576
    s_lshl_b32 s44, s22, 12
    s_add_u32 s44, s44, 25821184
    s_lshl_b32 s49, s21, 2
    s_add_u32 s49, s49, s44
    s_lshr_b32 s43, s21, 1
    s_lshl_b32 s43, s43, 5
    s_and_b32 s45, s21, 1
    s_lshl_b32 s45, s45, 2
    s_add_u32 s43, s43, s45
    s_add_u32 s43, s43, s20
    s_lshl_b32 s43, s43, 2
    s_add_u32 s43, s43, s44
    s_add_u32 s43, s43, 131072
    s_lshl_b32 s45, s20, 7
    s_add_u32 s45, s45, s44
    s_add_u32 s45, s45, 131072
    s_mov_b32 m0, s29
    s_waitcnt vmcnt(8)
    s_barrier
    s_cmp_lg_u32 s20, 0
    s_cbranch_scc1 nf_kp_kernel_38
    s_mov_b64 exec, 1
    buffer_store_dword v22, off, s[4:7], s49 sc1
    s_mov_b64 exec, -1
nf_kp_kernel_38:
    buffer_load_dwordx4 v[116:119], v3, s[4:7], s38 offen offset:1024
    buffer_load_dwordx4 v[120:123], v3, s[4:7], s38 offen offset:2048
    buffer_load_dwordx4 v[124:127], v3, s[4:7], s38 offen offset:3072
    s_add_u32 s38, s52, 53248
    buffer_load_dwordx4 v[128:131], v3, s[4:7], s38 offen offset:0
    buffer_load_dwordx4 v[132:135], v3, s[4:7], s38 offen offset:1024
    s_add_u32 s38, s52, 32768
    buffer_load_dwordx4 v[52:55], v3, s[4:7], s38 offen offset:1024
    buffer_load_dwordx4 v[56:59], v3, s[4:7], s38 offen offset:2048
    s_add_u32 s38, s52, 36864
    buffer_load_dwordx4 v[72:75], v3, s[4:7], s38 offen offset:2048
    buffer_load_dwordx4 v[76:79], v3, s[4:7], s38 offen offset:3072
    s_add_u32 s38, s52, 40960
    buffer_load_dwordx4 v[80:83], v3, s[4:7], s38 offen offset:0
    s_cmp_lg_u32 s20, 0
    s_cbranch_scc1 ok1_kp_kernel_39
    s_mov_b32 s57, 0
sp_kp_kernel_40:
    s_buffer_load_dwordx8 s[92:99], s[4:7], s44 glc
    s_waitcnt lgkmcnt(0)
    s_min_u32 s92, s92, s93
    s_min_u32 s94, s94, s95
    s_min_u32 s96, s96, s97
    s_min_u32 s98, s98, s99
    s_min_u32 s92, s92, s94
    s_min_u32 s96, s96, s98
    s_min_u32 s92, s92, s96
    s_cmp_eq_u32 s92, 0
    s_cbranch_scc1 ag_kp_kernel_41
    s_branch ok1_kp_kernel_39
ag_kp_kernel_41:
    s_add_u32 s57, s57, 1
    s_cmp_lt_u32 s57, 48
    s_cbranch_scc1 sp_kp_kernel_40
    s_mov_b32 s57, 0
poll_kp_kernel_42:
    buffer_load_dword v22, v0, s[4:7], s44 offen sc1
    s_add_u32 s57, s57, 1
    s_waitcnt vmcnt(0)
    s_cmp_gt_u32 s57, 524288
    s_cbranch_scc1 ok1_kp_kernel_39
    v_cmp_gt_u32 vcc, 1, v22
    s_cbranch_vccnz poll_kp_kernel_42
ok1_kp_kernel_39:
    s_barrier
    buffer_load_dwordx4 v137, s[4:7], s39 offen sc1 lds
    s_add_u32 m0, m0, 2048
    s_nop 0
    buffer_load_dwordx4 v137, s[4:7], s47 offen sc1 lds
    s_add_u32 m0, m0, 2048
    s_nop 0
    buffer_load_dwordx4 v137, s[4:7], s90 offen sc1 lds
    s_add_u32 m0, m0, 2048
    s_nop 0
    buffer_load_dwordx4 v137, s[4:7], s91 offen sc1 lds
    s_add_u32 m0, m0, 2048
    s_nop 0
    buffer_load_dwordx4 v137, s[4:7], s58 offen sc1 lds
    v_add_u32 v137, 20480, v137
    s_add_u32 m0, m0, 12288
    s_nop 0
    buffer_load_dwordx4 v137, s[4:7], s39 offen sc1 lds
    s_add_u32 m0, m0, 2048
    s_nop 0
    buffer_load_dwordx4 v137, s[4:7], s47 offen sc1 lds
    s_add_u32 m0, m0, 2048
    s_nop 0
    buffer_load_dwordx4 v137, s[4:7], s90 offen sc1 lds
    s_add_u32 m0, m0, 2048
    s_waitcnt vmcnt(3)
    s_barrier
    ds_read_b128 v[4:7], v1 offset:0
    ds_read_b128 v[8:11], v2 offset:0
    ds_read_b128 v[12:15], v1 offset:2048
    ds_read_b128 v[16:19], v2 offset:2048
    s_waitcnt lgkmcnt(3)
    v_mfma_f32_16x16x32_bf16 v[20:23], a[0:3], v[4:7], 0
    buffer_load_dwordx4 v137, s[4:7], s91 offen sc1 lds
    s_add_u32 m0, m0, 2048
    v_mfma_f32_16x16x32_bf16 v[24:27], a[4:7], v[4:7], 0
    v_mfma_f32_16x16x32_bf16 v[28:31], a[8:11], v[4:7], 0
    ds_read_b128 v[4:7], v1 offset:4096
    s_waitcnt lgkmcnt(3)
    v_mfma_f32_16x16x32_bf16 v[20:23], a[12:15], v[8:11], v[20:23]
    v_mfma_f32_16x16x32_bf16 v[24:27], a[16:19], v[8:11], v[24:27]
    buffer_load_dwordx4 v137, s[4:7], s58 offen sc1 lds
    v_add_u32 v137, 20480, v137
    s_add_u32 m0, m0, 12288
    v_mfma_f32_16x16x32_bf16 v[28:31], a[20:23], v[8:11], v[28:31]
    ds_read_b128 v[8:11], v2 offset:4096
    s_waitcnt lgkmcnt(3)
    v_mfma_f32_16x16x32_bf16 v[20:23], a[24:27], v[12:15], v[20:23]
    v_mfma_f32_16x16x32_bf16 v[24:27], a[28:31], v[12:15], v[24:27]
    v_mfma_f32_16x16x32_bf16 v[28:31], a[32:35], v[12:15], v[28:31]
    buffer_load_dwordx4 v137, s[4:7], s39 offen sc1 lds
    s_add_u32 m0, m0, 2048
    ds_read_b128 v[12:15], v1 offset:6144
    s_waitcnt lgkmcnt(3)
    v_mfma_f32_16x16x32_bf16 v[20:23], a[36:39], v[16:19], v[20:23]
    v_mfma_f32_16x16x32_bf16 v[24:27], a[40:43], v[16:19], v[24:27]
    v_mfma_f32_16x16x32_bf16 v[28:31], a[44:47], v[16:19], v[28:31]
    ds_read_b128 v[16:19], v2 offset:6144
    s_waitcnt lgkmcnt(3)
    v_mfma_f32_16x16x32_bf16 v[20:23], a[48:51], v[4:7], v[20:23]
    buffer_load_dwordx4 v137, s[4:7], s47 offen sc1 lds
    s_add_u32 m0, m0, 2048
    v_mfma_f32_16x16x32_bf16 v[24:27], a[52:55], v[4:7], v[24:27]
    v_mfma_f32_16x16x32_bf16 v[28:31], a[56:59], v[4:7], v[28:31]
    ds_read_b128 v[4:7], v1 offset:8192
    s_waitcnt lgkmcnt(3)
    v_mfma_f32_16x16x32_bf16 v[20:23], a[60:63], v[8:11], v[20:23]
    v_mfma_f32_16x16x32_bf16 v[24:27], a[64:67], v[8:11], v[24:27]
    buffer_load_dwordx4 v137, s[4:7], s90 offen sc1 lds
    s_add_u32 m0, m0, 2048
    v_mfma_f32_16x16x32_bf16 v[28:31], a[68:71], v[8:11], v[28:31]
    ds_read_b128 v[8:11], v2 offset:8192
    s_waitcnt lgkmcnt(3)
    v_mfma_f32_16x16x32_bf16 v[20:23], a[72:75], v[12:15], v[20:23]
    v_mfma_f32_16x16x32_bf16 v[24:27], a[76:79], v[12:15], v[24:27]
    v_mfma_f32_16x16x32_bf16 v[28:31], a[80:83], v[12:15], v[28:31]
    buffer_load_dwordx4 v137, s[4:7], s91 offen sc1 lds
    s_add_u32 m0, m0, 2048
    ds_read_b128 v[12:15], v1 offset:10240
    s_waitcnt lgkmcnt(3)
    v_mfma_f32_16x16x32_bf16 v[20:23], a[84:87], v[16:19], v[20:23]
    v_mfma_f32_16x16x32_bf16 v[24:27], a[88:91], v[16:19], v[24:27]
    v_mfma_f32_16x16x32_bf16 v[28:31], a[92:95], v[16:19], v[28:31]
    ds_read_b128 v[16:19], v2 offset:10240
    s_waitcnt lgkmcnt(3)
    v_mfma_f32_16x16x32_bf16 v[20:23], a[96:99], v[4:7], v[20:23]
    buffer_load_dwordx4 v137, s[4:7], s58 offen sc1 lds
    v_add_u32 v137, 20480, v137
    s_add_u32 m0, m0, 12288
    v_mfma_f32_16x16x32_bf16 v[24:27], a[100:103], v[4:7], v[24:27]
    v_mfma_f32_16x16x32_bf16 v[28:31], a[104:107], v[4:7], v[28:31]
    ds_read_b128 v[4:7], v1 offset:12288
    s_waitcnt lgkmcnt(3)
    v_mfma_f32_16x16x32_bf16 v[20:23], a[108:111], v[8:11], v[20:23]
    v_mfma_f32_16x16x32_bf16 v[24:27], a[112:115], v[8:11], v[24:27]
    buffer_load_dwordx4 v137, s[4:7], s39 offen sc1 lds
    s_add_u32 m0, m0, 2048
    v_mfma_f32_16x16x32_bf16 v[28:31], a[116:119], v[8:11], v[28:31]
    ds_read_b128 v[8:11], v2 offset:12288
    s_waitcnt lgkmcnt(3)
    v_mfma_f32_16x16x32_bf16 v[20:23], a[120:123], v[12:15], v[20:23]
    v_mfma_f32_16x16x32_bf16 v[24:27], a[124:127], v[12:15], v[24:27]
    v_mfma_f32_16x16x32_bf16 v[28:31], a[128:131], v[12:15], v[28:31]
    buffer_load_dwordx4 v137, s[4:7], s47 offen sc1 lds
    s_add_u32 m0, m0, 2048
    ds_read_b128 v[12:15], v1 offset:14336
    s_waitcnt lgkmcnt(3)
    v_mfma_f32_16x16x32_bf16 v[20:23], a[132:135], v[16:19], v[20:23]
    v_mfma_f32_16x16x32_bf16 v[24:27], a[136:139], v[16:19], v[24:27]
    v_mfma_f32_16x16x32_bf16 v[28:31], a[140:143], v[16:19], v[28:31]
    ds_read_b128 v[16:19], v2 offset:14336
    s_waitcnt lgkmcnt(3)
    v_mfma_f32_16x16x32_bf16 v[20:23], a[144:147], v[4:7], v[20:23]
    buffer_load_dwordx4 v137, s[4:7], s90 offen sc1 lds
    s_add_u32 m0, m0, 2048
    v_mfma_f32_16x16x32_bf16 v[24:27], a[148:151], v[4:7], v[24:27]
    v_mfma_f32_16x16x32_bf16 v[28:31], a[152:155], v[4:7], v[28:31]
    ds_read_b128 v[4:7], v1 offset:16384
    s_waitcnt lgkmcnt(3)
    v_mfma_f32_16x16x32_bf16 v[20:23], a[156:159], v[8:11], v[20:23]
    v_mfma_f32_16x16x32_bf16 v[24:27], a[160:163], v[8:11], v[24:27]
    buffer_load_dwordx4 v137, s[4:7], s91 offen sc1 lds
    s_add_u32 m0, m0, 2048
    v_mfma_f32_16x16x32_bf16 v[28:31], a[164:167], v[8:11], v[28:31]
    ds_read_b128 v[8:11], v2 offset:16384
    s_waitcnt lgkmcnt(3)
    v_mfma_f32_16x16x32_bf16 v[20:23], a[168:171], v[12:15], v[20:23]
    v_mfma_f32_16x16x32_bf16 v[24:27], a[172:175], v[12:15], v[24:27]
    v_mfma_f32_16x16x32_bf16 v[28:31], a[176:179], v[12:15], v[28:31]
    buffer_load_dwordx4 v137, s[4:7], s58 offen sc1 lds
    ds_read_b128 v[12:15], v1 offset:18432
    s_waitcnt lgkmcnt(3)
    v_mfma_f32_16x16x32_bf16 v[20:23], a[180:183], v[16:19], v[20:23]
    v_mfma_f32_16x16x32_bf16 v[24:27], a[184:187], v[16:19], v[24:27]
    v_mfma_f32_16x16x32_bf16 v[28:31], a[188:191], v[16:19], v[28:31]
    s_waitcnt vmcnt(10)
    s_barrier
    ds_read_b128 v[16:19], v2 offset:18432
    s_waitcnt lgkmcnt(3)
    v_mfma_f32_16x16x32_bf16 v[20:23], a[192:195], v[4:7], v[20:23]
    buffer_store_dwordx4 v[60:63], v138, s[4:7], s30 offen offset:0 sc1
    v_mfma_f32_16x16x32_bf16 v[24:27], a[196:199], v[4:7], v[24:27]
    v_mfma_f32_16x16x32_bf16 v[28:31], a[200:203], v[4:7], v[28:31]
    ds_read_b128 v[4:7], v1 offset:20480
    s_waitcnt lgkmcnt(3)
    v_mfma_f32_16x16x32_bf16 v[20:23], a[204:207], v[8:11], v[20:23]
    v_mfma_f32_16x16x32_bf16 v[24:27], a[208:211], v[8:11], v[24:27]
    buffer_store_dwordx4 v[64:67], v138, s[4:7], s30 offen offset:512 sc1
    v_mfma_f32_16x16x32_bf16 v[28:31], a[212:215], v[8:11], v[28:31]
    ds_read_b128 v[8:11], v2 offset:20480
    s_waitcnt lgkmcnt(3)
    v_mfma_f32_16x16x32_bf16 v[20:23], a[216:219], v[12:15], v[20:23]
    v_mfma_f32_16x16x32_bf16 v[24:27], a[220:223], v[12:15], v[24:27]
    v_mfma_f32_16x16x32_bf16 v[28:31], a[224:227], v[12:15], v[28:31]
    buffer_store_dwordx4 v[68:71], v139, s[4:7], s30 offen offset:1024 sc1
    ds_read_b128 v[12:15], v1 offset:22528
    s_waitcnt lgkmcnt(3)
    v_mfma_f32_16x16x32_bf16 v[20:23], a[228:231], v[16:19], v[20:23]
    v_mfma_f32_16x16x32_bf16 v[24:27], a[232:235], v[16:19], v[24:27]
    v_mfma_f32_16x16x32_bf16 v[28:31], a[236:239], v[16:19], v[28:31]
    ds_read_b128 v[16:19], v2 offset:22528
    s_waitcnt lgkmcnt(3)
    v_mfma_f32_16x16x32_bf16 v[32:35], a[0:3], v[4:7], 0
    v_mov_b32 v138, 1
    s_add_u32 s38, s52, 32768
    buffer_load_dwordx4 v[60:63], v3, s[4:7], s38 offen offset:3072
    v_mfma_f32_16x16x32_bf16 v[36:39], a[4:7], v[4:7], 0
    v_mfma_f32_16x16x32_bf16 v[40:43], a[8:11], v[4:7], 0
    v_cvt_pk_bf16_f32 v44, v20, v21
    v_cvt_pk_bf16_f32 v45, v22, v23
    ds_read_b128 v[4:7], v1 offset:24576
    s_waitcnt lgkmcnt(3)
    v_mfma_f32_16x16x32_bf16 v[32:35], a[12:15], v[8:11], v[32:35]
    v_cvt_pk_bf16_f32 v46, v24, v25
    v_cvt_pk_bf16_f32 v47, v26, v27
    v_mfma_f32_16x16x32_bf16 v[36:39], a[16:19], v[8:11], v[36:39]
    v_pk_max_i16 v44, v44, 0
    v_pk_max_i16 v45, v45, 0
    v_mfma_f32_16x16x32_bf16 v[40:43], a[20:23], v[8:11], v[40:43]
    v_pk_max_i16 v46, v46, 0
    v_pk_max_i16 v47, v47, 0
    ds_read_b128 v[8:11], v2 offset:24576
    s_waitcnt lgkmcnt(3)
    v_mfma_f32_16x16x32_bf16 v[32:35], a[24:27], v[12:15], v[32:35]
    v_cvt_pk_bf16_f32 v48, v28, v29
    v_cvt_pk_bf16_f32 v49, v30, v31
    v_mfma_f32_16x16x32_bf16 v[36:39], a[28:31], v[12:15], v[36:39]
    buffer_store_dwordx4 v[44:47], v3, s[4:7], s41 offen sc1
    v_pk_max_i16 v48, v48, 0
    v_mfma_f32_16x16x32_bf16 v[40:43], a[32:35], v[12:15], v[40:43]
    v_pk_max_i16 v49, v49, 0
    ds_read_b128 v[12:15], v1 offset:26624
    s_waitcnt lgkmcnt(3)
    v_mfma_f32_16x16x32_bf16 v[32:35], a[36:39], v[16:19], v[32:35]
    s_add_u32 s41, s41, 4096
    v_mfma_f32_16x16x32_bf16 v[36:39], a[40:43], v[16:19], v[36:39]
    v_mfma_f32_16x16x32_bf16 v[40:43], a[44:47], v[16:19], v[40:43]
    ds_read_b128 v[16:19], v2 offset:26624
    s_waitcnt lgkmcnt(3)
    v_mfma_f32_16x16x32_bf16 v[32:35], a[48:51], v[4:7], v[32:35]
    v_mfma_f32_16x16x32_bf16 v[36:39], a[52:55], v[4:7], v[36:39]
    v_mfma_f32_16x16x32_bf16 v[40:43], a[56:59], v[4:7], v[40:43]
    ds_read_b128 v[4:7], v1 offset:28672
    s_waitcnt lgkmcnt(3)
    v_mfma_f32_16x16x32_bf16 v[32:35], a[60:63], v[8:11], v[32:35]
    v_mfma_f32_16x16x32_bf16 v[36:39], a[64:67], v[8:11], v[36:39]
    v_mfma_f32_16x16x32_bf16 v[40:43], a[68:71], v[8:11], v[40:43]
    ds_read_b128 v[8:11], v2 offset:28672
    s_waitcnt lgkmcnt(3)
    v_mfma_f32_16x16x32_bf16 v[32:35], a[72:75], v[12:15], v[32:35]
    v_mfma_f32_16x16x32_bf16 v[36:39], a[76:79], v[12:15], v[36:39]
    v_mfma_f32_16x16x32_bf16 v[40:43], a[80:83], v[12:15], v[40:43]
    ds_read_b128 v[12:15], v1 offset:30720
    s_waitcnt lgkmcnt(3)
    v_mfma_f32_16x16x32_bf16 v[32:35], a[84:87], v[16:19], v[32:35]
    v_mfma_f32_16x16x32_bf16 v[36:39], a[88:91], v[16:19], v[36:39]
    v_mfma_f32_16x16x32_bf16 v[40:43], a[92:95], v[16:19], v[40:43]
    ds_read_b128 v[16:19], v2 offset:30720
    s_waitcnt lgkmcnt(3)
    v_mfma_f32_16x16x32_bf16 v[32:35], a[96:99], v[4:7], v[32:35]
    v_mfma_f32_16x16x32_bf16 v[36:39], a[100:103], v[4:7], v[36:39]
    v_mfma_f32_16x16x32_bf16 v[40:43], a[104:107], v[4:7], v[40:43]
    ds_read_b128 v[4:7], v1 offset:32768
    s_waitcnt lgkmcnt(3)
    v_mfma_f32_16x16x32_bf16 v[32:35], a[108:111], v[8:11], v[32:35]
    v_mfma_f32_16x16x32_bf16 v[36:39], a[112:115], v[8:11], v[36:39]
    v_mfma_f32_16x16x32_bf16 v[40:43], a[116:119], v[8:11], v[40:43]
    ds_read_b128 v[8:11], v2 offset:32768
    s_waitcnt lgkmcnt(3)
    v_mfma_f32_16x16x32_bf16 v[32:35], a[120:123], v[12:15], v[32:35]
    v_mfma_f32_16x16x32_bf16 v[36:39], a[124:127], v[12:15], v[36:39]
    v_mfma_f32_16x16x32_bf16 v[40:43], a[128:131], v[12:15], v[40:43]
    s_add_u32 s38, s52, 36864
    buffer_load_dwordx4 v[64:67], v3, s[4:7], s38 offen offset:0
    ds_read_b128 v[12:15], v1 offset:34816
    s_waitcnt lgkmcnt(3)
    v_mfma_f32_16x16x32_bf16 v[32:35], a[132:135], v[16:19], v[32:35]
    v_mfma_f32_16x16x32_bf16 v[36:39], a[136:139], v[16:19], v[36:39]
    v_mfma_f32_16x16x32_bf16 v[40:43], a[140:143], v[16:19], v[40:43]
    ds_read_b128 v[16:19], v2 offset:34816
    s_waitcnt lgkmcnt(3)
    v_mfma_f32_16x16x32_bf16 v[32:35], a[144:147], v[4:7], v[32:35]
    v_mfma_f32_16x16x32_bf16 v[36:39], a[148:151], v[4:7], v[36:39]
    v_mfma_f32_16x16x32_bf16 v[40:43], a[152:155], v[4:7], v[40:43]
    ds_read_b128 v[4:7], v1 offset:36864
    s_waitcnt lgkmcnt(3)
    v_mfma_f32_16x16x32_bf16 v[32:35], a[156:159], v[8:11], v[32:35]
    v_mfma_f32_16x16x32_bf16 v[36:39], a[160:163], v[8:11], v[36:39]
    v_mfma_f32_16x16x32_bf16 v[40:43], a[164:167], v[8:11], v[40:43]
    ds_read_b128 v[8:11], v2 offset:36864
    s_waitcnt lgkmcnt(3)
    v_mfma_f32_16x16x32_bf16 v[32:35], a[168:171], v[12:15], v[32:35]
    v_mfma_f32_16x16x32_bf16 v[36:39], a[172:175], v[12:15], v[36:39]
    v_mfma_f32_16x16x32_bf16 v[40:43], a[176:179], v[12:15], v[40:43]
    ds_read_b128 v[12:15], v1 offset:38912
    s_waitcnt lgkmcnt(3)
    v_mfma_f32_16x16x32_bf16 v[32:35], a[180:183], v[16:19], v[32:35]
    v_mfma_f32_16x16x32_bf16 v[36:39], a[184:187], v[16:19], v[36:39]
    v_mfma_f32_16x16x32_bf16 v[40:43], a[188:191], v[16:19], v[40:43]
    s_waitcnt vmcnt(11)
    s_barrier
    ds_read_b128 v[16:19], v2 offset:38912
    s_waitcnt lgkmcnt(3)
    v_mfma_f32_16x16x32_bf16 v[32:35], a[192:195], v[4:7], v[32:35]
    v_mfma_f32_16x16x32_bf16 v[36:39], a[196:199], v[4:7], v[36:39]
    v_mfma_f32_16x16x32_bf16 v[40:43], a[200:203], v[4:7], v[40:43]
    ds_read_b128 v[4:7], v1 offset:40960
    s_waitcnt lgkmcnt(3)
    v_mfma_f32_16x16x32_bf16 v[32:35], a[204:207], v[8:11], v[32:35]
    v_mfma_f32_16x16x32_bf16 v[36:39], a[208:211], v[8:11], v[36:39]
    v_mfma_f32_16x16x32_bf16 v[40:43], a[212:215], v[8:11], v[40:43]
    s_waitcnt vmcnt(1)
    s_mov_b64 exec, 1
    buffer_store_dword v138, off, s[4:7], s43 sc1
    s_mov_b64 exec, -1
    ds_read_b128 v[8:11], v2 offset:40960
    s_waitcnt lgkmcnt(3)
    v_mfma_f32_16x16x32_bf16 v[32:35], a[216:219], v[12:15], v[32:35]
    s_add_u32 s43, s43, 131072
    v_mfma_f32_16x16x32_bf16 v[36:39], a[220:223], v[12:15], v[36:39]
    v_mfma_f32_16x16x32_bf16 v[40:43], a[224:227], v[12:15], v[40:43]
    ds_read_b128 v[12:15], v1 offset:43008
    s_waitcnt lgkmcnt(3)
    v_mfma_f32_16x16x32_bf16 v[32:35], a[228:231], v[16:19], v[32:35]
    v_mfma_f32_16x16x32_bf16 v[36:39], a[232:235], v[16:19], v[36:39]
    v_mfma_f32_16x16x32_bf16 v[40:43], a[236:239], v[16:19], v[40:43]
    ds_read_b128 v[16:19], v2 offset:43008
    s_waitcnt lgkmcnt(3)
    v_mfma_f32_16x16x32_bf16 v[20:23], a[0:3], v[4:7], 0
    v_mfma_f32_16x16x32_bf16 v[24:27], a[4:7], v[4:7], 0
    v_mfma_f32_16x16x32_bf16 v[28:31], a[8:11], v[4:7], 0
    s_nop 0
    v_cvt_pk_bf16_f32 v44, v32, v33
    v_cvt_pk_bf16_f32 v45, v34, v35
    ds_read_b128 v[4:7], v1 offset:45056
    s_waitcnt lgkmcnt(3)
    v_mfma_f32_16x16x32_bf16 v[20:23], a[12:15], v[8:11], v[20:23]
    v_cvt_pk_bf16_f32 v46, v36, v37
    v_cvt_pk_bf16_f32 v47, v38, v39
    v_mfma_f32_16x16x32_bf16 v[24:27], a[16:19], v[8:11], v[24:27]
    v_pk_max_i16 v44, v44, 0
    v_pk_max_i16 v45, v45, 0
    buffer_load_dwordx4 v[68:71], v3, s[4:7], s38 offen offset:1024
    v_mfma_f32_16x16x32_bf16 v[28:31], a[20:23], v[8:11], v[28:31]
    v_pk_max_i16 v46, v46, 0
    v_pk_max_i16 v47, v47, 0
    ds_read_b128 v[8:11], v2 offset:45056
    s_waitcnt lgkmcnt(3)
    v_mfma_f32_16x16x32_bf16 v[20:23], a[24:27], v[12:15], v[20:23]
    v_cvt_pk_bf16_f32 v50, v40, v41
    v_cvt_pk_bf16_f32 v51, v42, v43
    v_mfma_f32_16x16x32_bf16 v[24:27], a[28:31], v[12:15], v[24:27]
    buffer_store_dwordx4 v[44:47], v3, s[4:7], s41 offen sc1
    v_pk_max_i16 v50, v50, 0
    v_mfma_f32_16x16x32_bf16 v[28:31], a[32:35], v[12:15], v[28:31]
    v_pk_max_i16 v51, v51, 0
    buffer_store_dwordx4 v[48:51], v3, s[4:7], s42 offen sc1
    ds_read_b128 v[12:15], v1 offset:47104
    s_waitcnt lgkmcnt(3)
    v_mfma_f32_16x16x32_bf16 v[20:23], a[36:39], v[16:19], v[20:23]
    s_add_u32 s41, s41, 4096
    s_add_u32 s42, s42, 4096
    v_mfma_f32_16x16x32_bf16 v[24:27], a[40:43], v[16:19], v[24:27]
    v_mfma_f32_16x16x32_bf16 v[28:31], a[44:47], v[16:19], v[28:31]
    ds_read_b128 v[16:19], v2 offset:47104
    s_waitcnt lgkmcnt(3)
    v_mfma_f32_16x16x32_bf16 v[20:23], a[48:51], v[4:7], v[20:23]
    v_mfma_f32_16x16x32_bf16 v[24:27], a[52:55], v[4:7], v[24:27]
    v_mfma_f32_16x16x32_bf16 v[28:31], a[56:59], v[4:7], v[28:31]
    ds_read_b128 v[4:7], v1 offset:49152
    s_waitcnt lgkmcnt(3)
    v_mfma_f32_16x16x32_bf16 v[20:23], a[60:63], v[8:11], v[20:23]
    v_mfma_f32_16x16x32_bf16 v[24:27], a[64:67], v[8:11], v[24:27]
    v_mfma_f32_16x16x32_bf16 v[28:31], a[68:71], v[8:11], v[28:31]
    ds_read_b128 v[8:11], v2 offset:49152
    s_waitcnt lgkmcnt(3)
    v_mfma_f32_16x16x32_bf16 v[20:23], a[72:75], v[12:15], v[20:23]
    v_mfma_f32_16x16x32_bf16 v[24:27], a[76:79], v[12:15], v[24:27]
    v_mfma_f32_16x16x32_bf16 v[28:31], a[80:83], v[12:15], v[28:31]
    ds_read_b128 v[12:15], v1 offset:51200
    s_waitcnt lgkmcnt(3)
    v_mfma_f32_16x16x32_bf16 v[20:23], a[84:87], v[16:19], v[20:23]
    v_mfma_f32_16x16x32_bf16 v[24:27], a[88:91], v[16:19], v[24:27]
    v_mfma_f32_16x16x32_bf16 v[28:31], a[92:95], v[16:19], v[28:31]
    ds_read_b128 v[16:19], v2 offset:51200
    s_waitcnt lgkmcnt(3)
    v_mfma_f32_16x16x32_bf16 v[20:23], a[96:99], v[4:7], v[20:23]
    v_mfma_f32_16x16x32_bf16 v[24:27], a[100:103], v[4:7], v[24:27]
    v_mfma_f32_16x16x32_bf16 v[28:31], a[104:107], v[4:7], v[28:31]
    s_buffer_load_dwordx8 s[92:99], s[4:7], s45 glc
    ds_read_b128 v[4:7], v1 offset:53248
    s_waitcnt lgkmcnt(3)
    v_mfma_f32_16x16x32_bf16 v[20:23], a[108:111], v[8:11], v[20:23]
    v_mfma_f32_16x16x32_bf16 v[24:27], a[112:115], v[8:11], v[24:27]
    v_mfma_f32_16x16x32_bf16 v[28:31], a[116:119], v[8:11], v[28:31]
    ds_read_b128 v[8:11], v2 offset:53248
    s_waitcnt lgkmcnt(3)
    v_mfma_f32_16x16x32_bf16 v[20:23], a[120:123], v[12:15], v[20:23]
    v_mfma_f32_16x16x32_bf16 v[24:27], a[124:127], v[12:15], v[24:27]
    v_mfma_f32_16x16x32_bf16 v[28:31], a[128:131], v[12:15], v[28:31]
    ds_read_b128 v[12:15], v1 offset:55296
    s_waitcnt lgkmcnt(3)
    v_mfma_f32_16x16x32_bf16 v[20:23], a[132:135], v[16:19], v[20:23]
    v_mfma_f32_16x16x32_bf16 v[24:27], a[136:139], v[16:19], v[24:27]
    v_mfma_f32_16x16x32_bf16 v[28:31], a[140:143], v[16:19], v[28:31]
    ds_read_b128 v[16:19], v2 offset:55296
    s_waitcnt lgkmcnt(3)
    v_mfma_f32_16x16x32_bf16 v[20:23], a[144:147], v[4:7], v[20:23]
    v_mfma_f32_16x16x32_bf16 v[24:27], a[148:151], v[4:7], v[24:27]
    v_mfma_f32_16x16x32_bf16 v[28:31], a[152:155], v[4:7], v[28:31]
    ds_read_b128 v[4:7], v1 offset:57344
    s_waitcnt lgkmcnt(3)
    v_mfma_f32_16x16x32_bf16 v[20:23], a[156:159], v[8:11], v[20:23]
    v_mfma_f32_16x16x32_bf16 v[24:27], a[160:163], v[8:11], v[24:27]
    v_mfma_f32_16x16x32_bf16 v[28:31], a[164:167], v[8:11], v[28:31]
    ds_read_b128 v[8:11], v2 offset:57344
    s_waitcnt lgkmcnt(3)
    v_mfma_f32_16x16x32_bf16 v[20:23], a[168:171], v[12:15], v[20:23]
    v_mfma_f32_16x16x32_bf16 v[24:27], a[172:175], v[12:15], v[24:27]
    v_mfma_f32_16x16x32_bf16 v[28:31], a[176:179], v[12:15], v[28:31]
    ds_read_b128 v[12:15], v1 offset:59392
    s_waitcnt lgkmcnt(3)
    v_mfma_f32_16x16x32_bf16 v[20:23], a[180:183], v[16:19], v[20:23]
    v_mfma_f32_16x16x32_bf16 v[24:27], a[184:187], v[16:19], v[24:27]
    v_mfma_f32_16x16x32_bf16 v[28:31], a[188:191], v[16:19], v[28:31]
    s_barrier
    ds_read_b128 v[16:19], v2 offset:59392
    s_waitcnt lgkmcnt(3)
    v_mfma_f32_16x16x32_bf16 v[20:23], a[192:195], v[4:7], v[20:23]
    v_mfma_f32_16x16x32_bf16 v[24:27], a[196:199], v[4:7], v[24:27]
    v_mfma_f32_16x16x32_bf16 v[28:31], a[200:203], v[4:7], v[28:31]
    v_add_u32 v1, 61440, v1
    v_add_u32 v2, 61440, v2
    ds_read_b128 v[4:7], v1 offset:0
    s_waitcnt lgkmcnt(3)
    v_mfma_f32_16x16x32_bf16 v[20:23], a[204:207], v[8:11], v[20:23]
    v_mfma_f32_16x16x32_bf16 v[24:27], a[208:211], v[8:11], v[24:27]
    v_mfma_f32_16x16x32_bf16 v[28:31], a[212:215], v[8:11], v[28:31]
    s_waitcnt vmcnt(0)
    s_mov_b64 exec, 1
    buffer_store_dword v138, off, s[4:7], s43 sc1
    s_mov_b64 exec, -1
    ds_read_b128 v[8:11], v2 offset:0
    s_waitcnt lgkmcnt(3)
    v_mfma_f32_16x16x32_bf16 v[20:23], a[216:219], v[12:15], v[20:23]
    s_add_u32 s43, s43, 131072
    v_mfma_f32_16x16x32_bf16 v[24:27], a[220:223], v[12:15], v[24:27]
    v_mfma_f32_16x16x32_bf16 v[28:31], a[224:227], v[12:15], v[28:31]
    ds_read_b128 v[12:15], v1 offset:2048
    s_waitcnt lgkmcnt(3)
    v_mfma_f32_16x16x32_bf16 v[20:23], a[228:231], v[16:19], v[20:23]
    v_mfma_f32_16x16x32_bf16 v[24:27], a[232:235], v[16:19], v[24:27]
    v_mfma_f32_16x16x32_bf16 v[28:31], a[236:239], v[16:19], v[28:31]
    ds_read_b128 v[16:19], v2 offset:2048
    s_waitcnt lgkmcnt(3)
    v_mfma_f32_16x16x32_bf16 v[32:35], a[0:3], v[4:7], 0
    v_mfma_f32_16x16x32_bf16 v[36:39], a[4:7], v[4:7], 0
    v_mfma_f32_16x16x32_bf16 v[40:43], a[8:11], v[4:7], 0
    s_waitcnt lgkmcnt(0)
    s_min_u32 s92, s92, s93
    s_min_u32 s94, s94, s95
    s_min_u32 s96, s96, s97
    s_min_u32 s98, s98, s99
    s_min_u32 s92, s92, s94
    s_min_u32 s96, s96, s98
    s_min_u32 s92, s92, s96
    s_cmp_eq_u32 s92, 0
    s_cbranch_scc1 slow_kp_kernel_43
back_kp_kernel_44:
    s_add_u32 s45, s45, 131072
    buffer_load_dwordx4 a[0:3], v3, s[4:7], s26 offen offset:0 sc1
    ds_read_b128 v[4:7], v1 offset:4096
    s_waitcnt lgkmcnt(3)
    v_mfma_f32_16x16x32_bf16 v[32:35], a[12:15], v[8:11], v[32:35]
    v_cvt_pk_bf16_f32 v44, v20, v21
    v_cvt_pk_bf16_f32 v45, v22, v23
    v_mfma_f32_16x16x32_bf16 v[36:39], a[16:19], v[8:11], v[36:39]
    v_cvt_pk_bf16_f32 v46, v24, v25
    v_cvt_pk_bf16_f32 v47, v26, v27
    v_mfma_f32_16x16x32_bf16 v[40:43], a[20:23], v[8:11], v[40:43]
    buffer_load_dwordx4 a[4:7], v3, s[4:7], s26 offen offset:1024 sc1
    v_pk_max_i16 v44, v44, 0
    ds_read_b128 v[8:11], v2 offset:4096
    s_waitcnt lgkmcnt(3)
    v_mfma_f32_16x16x32_bf16 v[32:35], a[24:27], v[12:15], v[32:35]
    v_pk_max_i16 v45, v45, 0
    v_pk_max_i16 v46, v46, 0
    v_mfma_f32_16x16x32_bf16 v[36:39], a[28:31], v[12:15], v[36:39]
    v_pk_max_i16 v47, v47, 0
    v_cvt_pk_bf16_f32 v48, v28, v29
    v_mfma_f32_16x16x32_bf16 v[40:43], a[32:35], v[12:15], v[40:43]
    buffer_load_dwordx4 a[8:11], v3, s[4:7], s26 offen offset:2048 sc1
    v_cvt_pk_bf16_f32 v49, v30, v31
    ds_read_b128 v[12:15], v1 offset:6144
    s_waitcnt lgkmcnt(3)
    v_mfma_f32_16x16x32_bf16 v[32:35], a[36:39], v[16:19], v[32:35]
    buffer_store_dwordx4 v[44:47], v3, s[4:7], s41 offen sc1
    v_pk_max_i16 v48, v48, 0
    v_mfma_f32_16x16x32_bf16 v[36:39], a[40:43], v[16:19], v[36:39]
    v_pk_max_i16 v49, v49, 0
    v_mfma_f32_16x16x32_bf16 v[40:43], a[44:47], v[16:19], v[40:43]
    buffer_load_dwordx4 a[12:15], v3, s[4:7], s26 offen offset:3072 sc1
    s_add_u32 s41, s41, 4096
    ds_read_b128 v[16:19], v2 offset:6144
    s_waitcnt lgkmcnt(3)
    v_mfma_f32_16x16x32_bf16 v[32:35], a[48:51], v[4:7], v[32:35]
    v_mfma_f32_16x16x32_bf16 v[36:39], a[52:55], v[4:7], v[36:39]
    v_mfma_f32_16x16x32_bf16 v[40:43], a[56:59], v[4:7], v[40:43]
    buffer_load_dwordx4 a[16:19], v3, s[4:7], s27 offen offset:0 sc1
    ds_read_b128 v[4:7], v1 offset:8192
    s_waitcnt lgkmcnt(3)
    v_mfma_f32_16x16x32_bf16 v[32:35], a[60:63], v[8:11], v[32:35]
    v_mfma_f32_16x16x32_bf16 v[36:39], a[64:67], v[8:11], v[36:39]
    v_mfma_f32_16x16x32_bf16 v[40:43], a[68:71], v[8:11], v[40:43]
    buffer_load_dwordx4 a[20:23], v3, s[4:7], s27 offen offset:1024 sc1
    ds_read_b128 v[8:11], v2 offset:8192
    s_waitcnt lgkmcnt(3)
    v_mfma_f32_16x16x32_bf16 v[32:35], a[72:75], v[12:15], v[32:35]
    v_mfma_f32_16x16x32_bf16 v[36:39], a[76:79], v[12:15], v[36:39]
    v_mfma_f32_16x16x32_bf16 v[40:43], a[80:83], v[12:15], v[40:43]
    buffer_load_dwordx4 a[24:27], v3, s[4:7], s27 offen offset:2048 sc1
    ds_read_b128 v[12:15], v1 offset:10240
    s_waitcnt lgkmcnt(3)
    v_mfma_f32_16x16x32_bf16 v[32:35], a[84:87], v[16:19], v[32:35]
    v_mfma_f32_16x16x32_bf16 v[36:39], a[88:91], v[16:19], v[36:39]
    v_mfma_f32_16x16x32_bf16 v[40:43], a[92:95], v[16:19], v[40:43]
    buffer_load_dwordx4 a[28:31], v3, s[4:7], s27 offen offset:3072 sc1
    s_buffer_load_dwordx8 s[92:99], s[4:7], s45 glc
    ds_read_b128 v[16:19], v2 offset:10240
    s_waitcnt lgkmcnt(3)
    v_mfma_f32_16x16x32_bf16 v[32:35], a[96:99], v[4:7], v[32:35]
    v_mfma_f32_16x16x32_bf16 v[36:39], a[100:103], v[4:7], v[36:39]
    s_add_u32 s26, s26, 4096
    s_add_u32 s27, s27, 4096
    v_mfma_f32_16x16x32_bf16 v[40:43], a[104:107], v[4:7], v[40:43]
    ds_read_b128 v[4:7], v1 offset:12288
    s_waitcnt lgkmcnt(3)
    v_mfma_f32_16x16x32_bf16 v[32:35], a[108:111], v[8:11], v[32:35]
    v_mfma_f32_16x16x32_bf16 v[36:39], a[112:115], v[8:11], v[36:39]
    v_mfma_f32_16x16x32_bf16 v[40:43], a[116:119], v[8:11], v[40:43]
    s_add_u32 s38, s52, 53248
    buffer_load_dwordx4 a[32:35], v3, s[4:7], s38 offen offset:2048
    ds_read_b128 v[8:11], v2 offset:12288
    s_waitcnt lgkmcnt(3)
    v_mfma_f32_16x16x32_bf16 v[32:35], a[120:123], v[12:15], v[32:35]
    v_mfma_f32_16x16x32_bf16 v[36:39], a[124:127], v[12:15], v[36:39]
    v_mfma_f32_16x16x32_bf16 v[40:43], a[128:131], v[12:15], v[40:43]
    buffer_load_dwordx4 a[36:39], v3, s[4:7], s38 offen offset:3072
    ds_read_b128 v[12:15], v1 offset:14336
    s_waitcnt lgkmcnt(3)
    v_mfma_f32_16x16x32_bf16 v[32:35], a[132:135], v[16:19], v[32:35]
    v_mfma_f32_16x16x32_bf16 v[36:39], a[136:139], v[16:19], v[36:39]
    v_mfma_f32_16x16x32_bf16 v[40:43], a[140:143], v[16:19], v[40:43]
    s_add_u32 s38, s52, 57344
    buffer_load_dwordx4 a[40:43], v3, s[4:7], s38 offen offset:0
    ds_read_b128 v[16:19], v2 offset:14336
    s_waitcnt lgkmcnt(3)
    v_mfma_f32_16x16x32_bf16 v[32:35], a[144:147], v[4:7], v[32:35]
    v_mfma_f32_16x16x32_bf16 v[36:39], a[148:151], v[4:7], v[36:39]
    v_mfma_f32_16x16x32_bf16 v[40:43], a[152:155], v[4:7], v[40:43]
    buffer_load_dwordx4 a[44:47], v3, s[4:7], s38 offen offset:1024
    ds_read_b128 v[4:7], v1 offset:16384
    s_waitcnt lgkmcnt(3)
    v_mfma_f32_16x16x32_bf16 v[32:35], a[156:159], v[8:11], v[32:35]
    v_mfma_f32_16x16x32_bf16 v[36:39], a[160:163], v[8:11], v[36:39]
    v_mfma_f32_16x16x32_bf16 v[40:43], a[164:167], v[8:11], v[40:43]
    buffer_load_dwordx4 a[48:51], v3, s[4:7], s38 offen offset:2048
    ds_read_b128 v[8:11], v2 offset:16384
    s_waitcnt lgkmcnt(3)
    v_mfma_f32_16x16x32_bf16 v[32:35], a[168:171], v[12:15], v[32:35]
    v_mfma_f32_16x16x32_bf16 v[36:39], a[172:175], v[12:15], v[36:39]
    v_mfma_f32_16x16x32_bf16 v[40:43], a[176:179], v[12:15], v[40:43]
    buffer_load_dwordx4 a[52:55], v3, s[4:7], s38 offen offset:3072
    ds_read_b128 v[12:15], v1 offset:18432
    s_waitcnt lgkmcnt(3)
    v_mfma_f32_16x16x32_bf16 v[32:35], a[180:183], v[16:19], v[32:35]
    v_mfma_f32_16x16x32_bf16 v[36:39], a[184:187], v[16:19], v[36:39]
    v_mfma_f32_16x16x32_bf16 v[40:43], a[188:191], v[16:19], v[40:43]
    ds_read_b128 v[16:19], v2 offset:18432
    s_waitcnt lgkmcnt(3)
    v_mfma_f32_16x16x32_bf16 v[32:35], a[192:195], v[4:7], v[32:35]
    v_mfma_f32_16x16x32_bf16 v[36:39], a[196:199], v[4:7], v[36:39]
    v_mfma_f32_16x16x32_bf16 v[40:43], a[200:203], v[4:7], v[40:43]
    s_waitcnt lgkmcnt(2)
    v_mfma_f32_16x16x32_bf16 v[32:35], a[204:207], v[8:11], v[32:35]
    v_mfma_f32_16x16x32_bf16 v[36:39], a[208:211], v[8:11], v[36:39]
    v_mfma_f32_16x16x32_bf16 v[40:43], a[212:215], v[8:11], v[40:43]
    s_waitcnt lgkmcnt(1)
    v_mfma_f32_16x16x32_bf16 v[32:35], a[216:219], v[12:15], v[32:35]
    v_mfma_f32_16x16x32_bf16 v[36:39], a[220:223], v[12:15], v[36:39]
    s_waitcnt vmcnt(11)
    s_mov_b64 exec, 1
    buffer_store_dword v138, off, s[4:7], s43 sc1
    s_mov_b64 exec, -1
    v_mfma_f32_16x16x32_bf16 v[40:43], a[224:227], v[12:15], v[40:43]
    s_add_u32 s43, s43, 131072
    s_waitcnt lgkmcnt(0)
    v_mfma_f32_16x16x32_bf16 v[32:35], a[228:231], v[16:19], v[32:35]
    v_mfma_f32_16x16x32_bf16 v[36:39], a[232:235], v[16:19], v[36:39]
    v_mfma_f32_16x16x32_bf16 v[40:43], a[236:239], v[16:19], v[40:43]
    s_waitcnt lgkmcnt(0)
    s_min_u32 s92, s92, s93
    s_min_u32 s94, s94, s95
    s_min_u32 s96, s96, s97
    s_min_u32 s98, s98, s99
    s_min_u32 s92, s92, s94
    s_min_u32 s96, s96, s98
    s_min_u32 s92, s92, s96
    s_cmp_eq_u32 s92, 0
    s_cbranch_scc1 slow_kp_kernel_45
back_kp_kernel_46:
    s_add_u32 s45, s45, 131072
    buffer_load_dwordx4 a[60:63], v3, s[4:7], s26 offen offset:0 sc1
    v_mfma_f32_16x16x32_bf16 a[128:131], v[140:143], a[0:3], 0
    v_mfma_f32_16x16x32_bf16 a[132:135], v[144:147], a[0:3], 0
    v_mfma_f32_16x16x32_bf16 a[136:139], v[148:151], a[0:3], 0
    buffer_load_dwordx4 a[64:67], v3, s[4:7], s26 offen offset:1024 sc1
    v_cvt_pk_bf16_f32 v44, v32, v33
    v_cvt_pk_bf16_f32 v45, v34, v35
    v_mfma_f32_16x16x32_bf16 a[140:143], v[152:155], a[0:3], 0
    v_cvt_pk_bf16_f32 v46, v36, v37
    v_cvt_pk_bf16_f32 v47, v38, v39
    v_pk_max_i16 v44, v44, 0
    v_mfma_f32_16x16x32_bf16 a[144:147], v[156:159], a[0:3], 0
    v_pk_max_i16 v45, v45, 0
    v_pk_max_i16 v46, v46, 0
    v_pk_max_i16 v47, v47, 0
    v_mfma_f32_16x16x32_bf16 a[128:131], v[160:163], a[4:7], a[128:131]
    buffer_load_dwordx4 a[68:71], v3, s[4:7], s26 offen offset:2048 sc1
    v_cvt_pk_bf16_f32 v50, v40, v41
    v_cvt_pk_bf16_f32 v51, v42, v43
    v_mfma_f32_16x16x32_bf16 a[132:135], v[164:167], a[4:7], a[132:135]
    buffer_store_dwordx4 v[44:47], v3, s[4:7], s41 offen sc1
    v_pk_max_i16 v50, v50, 0
    v_pk_max_i16 v51, v51, 0
    v_mfma_f32_16x16x32_bf16 a[136:139], v[168:171], a[4:7], a[136:139]
    buffer_store_dwordx4 v[48:51], v3, s[4:7], s42 offen sc1
    v_mfma_f32_16x16x32_bf16 a[140:143], v[172:175], a[4:7], a[140:143]
    buffer_load_dwordx4 a[72:75], v3, s[4:7], s26 offen offset:3072 sc1
    s_add_u32 s41, s41, 4096
    v_mfma_f32_16x16x32_bf16 a[144:147], v[176:179], a[4:7], a[144:147]
    s_add_u32 s42, s42, 4096
    v_mfma_f32_16x16x32_bf16 a[128:131], v[180:183], a[8:11], a[128:131]
    v_mfma_f32_16x16x32_bf16 a[132:135], v[184:187], a[8:11], a[132:135]
    buffer_load_dwordx4 a[76:79], v3, s[4:7], s27 offen offset:0 sc1
    v_mfma_f32_16x16x32_bf16 a[136:139], v[188:191], a[8:11], a[136:139]
    v_mfma_f32_16x16x32_bf16 a[140:143], v[192:195], a[8:11], a[140:143]
    v_mfma_f32_16x16x32_bf16 a[144:147], v[196:199], a[8:11], a[144:147]
    buffer_load_dwordx4 a[80:83], v3, s[4:7], s27 offen offset:1024 sc1
    s_waitcnt vmcnt(19)
    v_mfma_f32_16x16x32_bf16 a[128:131], v[200:203], a[12:15], a[128:131]
    v_mfma_f32_16x16x32_bf16 a[132:135], v[204:207], a[12:15], a[132:135]
    v_mfma_f32_16x16x32_bf16 a[136:139], v[208:211], a[12:15], a[136:139]
    buffer_load_dwordx4 a[84:87], v3, s[4:7], s27 offen offset:2048 sc1
    v_mfma_f32_16x16x32_bf16 a[140:143], v[212:215], a[12:15], a[140:143]
    v_mfma_f32_16x16x32_bf16 a[144:147], v[216:219], a[12:15], a[144:147]
    s_waitcnt vmcnt(19)
    v_mfma_f32_16x16x32_bf16 a[128:131], a[244:247], a[16:19], a[128:131]
    buffer_load_dwordx4 a[88:91], v3, s[4:7], s27 offen offset:3072 sc1
    v_mfma_f32_16x16x32_bf16 a[132:135], a[248:251], a[16:19], a[132:135]
    v_mfma_f32_16x16x32_bf16 a[136:139], a[252:255], a[16:19], a[136:139]
    s_add_u32 s26, s26, 4096
    s_add_u32 s27, s27, 4096
    v_mfma_f32_16x16x32_bf16 a[140:143], v[52:55], a[16:19], a[140:143]
    s_add_u32 s46, s26, 8192
    buffer_load_dwordx4 v[4:7], v3, s[4:7], s46 offen offset:0 sc1
    v_mfma_f32_16x16x32_bf16 a[144:147], v[56:59], a[16:19], a[144:147]
    v_bfe_u32 v39, v3, 4, 4
    s_waitcnt vmcnt(20)
    v_mfma_f32_16x16x32_bf16 a[128:131], v[60:63], a[20:23], a[128:131]
    s_buffer_load_dwordx8 s[92:99], s[4:7], s45 glc
    v_mfma_f32_16x16x32_bf16 a[132:135], v[64:67], a[20:23], a[132:135]
    buffer_load_dwordx4 v[8:11], v3, s[4:7], s46 offen offset:1024 sc1
    v_mfma_f32_16x16x32_bf16 a[136:139], v[68:71], a[20:23], a[136:139]
    v_bfe_u32 v38, v3, 8, 1
    v_mfma_f32_16x16x32_bf16 a[140:143], v[72:75], a[20:23], a[140:143]
    v_lshrrev_b32 v37, 9, v3
    v_mfma_f32_16x16x32_bf16 a[144:147], v[76:79], a[20:23], a[144:147]
    buffer_load_dwordx4 v[12:15], v3, s[4:7], s46 offen offset:2048 sc1
    s_waitcnt vmcnt(21)
    v_mfma_f32_16x16x32_bf16 a[128:131], v[80:83], a[24:27], a[128:131]
    v_lshlrev_b32 v37, 4, v37
    v_mfma_f32_16x16x32_bf16 a[132:135], v[84:87], a[24:27], a[132:135]
    v_lshl_add_u32 v38, v38, 5, v37
    v_mfma_f32_16x16x32_bf16 a[136:139], v[88:91], a[24:27], a[136:139]
    buffer_load_dwordx4 v[16:19], v3, s[4:7], s46 offen offset:3072 sc1
    v_mfma_f32_16x16x32_bf16 a[140:143], v[92:95], a[24:27], a[140:143]
    v_mul_u32_u24 v37, 1280, v39
    v_mfma_f32_16x16x32_bf16 a[144:147], v[96:99], a[24:27], a[144:147]
    v_lshrrev_b32 v36, 8, v3
    s_waitcnt vmcnt(21)
    v_mfma_f32_16x16x32_bf16 a[128:131], v[100:103], a[28:31], a[128:131]
    s_add_u32 s46, s27, 8192
    buffer_load_dwordx4 v[20:23], v3, s[4:7], s46 offen offset:0 sc1
    v_mfma_f32_16x16x32_bf16 a[132:135], v[104:107], a[28:31], a[132:135]
    v_lshl_add_u32 v50, v36, 3, v37
    v_mfma_f32_16x16x32_bf16 a[136:139], v[108:111], a[28:31], a[136:139]
    v_add_u32 v37, v37, v38
    v_mfma_f32_16x16x32_bf16 a[140:143], v[112:115], a[28:31], a[140:143]
    buffer_load_dwordx4 v[24:27], v3, s[4:7], s46 offen offset:1024 sc1
    v_mfma_f32_16x16x32_bf16 a[144:147], v[116:119], a[28:31], a[144:147]
    v_mul_lo_u32 v51, v39, s32
    s_waitcnt vmcnt(15)
    v_mfma_f32_16x16x32_bf16 a[148:151], v[140:143], a[60:63], 0
    v_add_u32 v38, v51, v38
    v_mfma_f32_16x16x32_bf16 a[152:155], v[144:147], a[60:63], 0
    buffer_load_dwordx4 v[28:31], v3, s[4:7], s46 offen offset:2048 sc1
    v_mfma_f32_16x16x32_bf16 a[156:159], v[148:151], a[60:63], 0
    v_lshl_add_u32 v51, v36, 3, v51
    v_mfma_f32_16x16x32_bf16 a[160:163], v[152:155], a[60:63], 0
    v_mfma_f32_16x16x32_bf16 a[164:167], v[156:159], a[60:63], 0
    buffer_load_dwordx4 v[32:35], v3, s[4:7], s46 offen offset:3072 sc1
    s_waitcnt vmcnt(16)
    v_mfma_f32_16x16x32_bf16 a[148:151], v[160:163], a[64:67], a[148:151]
    v_mfma_f32_16x16x32_bf16 a[152:155], v[164:167], a[64:67], a[152:155]
    v_mfma_f32_16x16x32_bf16 a[156:159], v[168:171], a[64:67], a[156:159]
    v_mfma_f32_16x16x32_bf16 a[160:163], v[172:175], a[64:67], a[160:163]
    v_mfma_f32_16x16x32_bf16 a[164:167], v[176:179], a[64:67], a[164:167]
    s_waitcnt vmcnt(15)
    v_mfma_f32_16x16x32_bf16 a[148:151], v[180:183], a[68:71], a[148:151]
    v_mfma_f32_16x16x32_bf16 a[152:155], v[184:187], a[68:71], a[152:155]
    v_mfma_f32_16x16x32_bf16 a[156:159], v[188:191], a[68:71], a[156:159]
    s_waitcnt vmcnt(13)
    s_mov_b64 exec, 1
    buffer_store_dword v138, off, s[4:7], s43 sc1
    s_mov_b64 exec, -1
    v_mfma_f32_16x16x32_bf16 a[160:163], v[192:195], a[68:71], a[160:163]
    s_add_u32 s43, s43, 131072
    v_mfma_f32_16x16x32_bf16 a[164:167], v[196:199], a[68:71], a[164:167]
    s_waitcnt vmcnt(13)
    v_mfma_f32_16x16x32_bf16 a[148:151], v[200:203], a[72:75], a[148:151]
    v_mfma_f32_16x16x32_bf16 a[152:155], v[204:207], a[72:75], a[152:155]
    v_mfma_f32_16x16x32_bf16 a[156:159], v[208:211], a[72:75], a[156:159]
    v_mfma_f32_16x16x32_bf16 a[160:163], v[212:215], a[72:75], a[160:163]
    v_mfma_f32_16x16x32_bf16 a[164:167], v[216:219], a[72:75], a[164:167]
    s_waitcnt vmcnt(12)
    v_mfma_f32_16x16x32_bf16 a[148:151], a[244:247], a[76:79], a[148:151]
    v_mfma_f32_16x16x32_bf16 a[152:155], a[248:251], a[76:79], a[152:155]
    s_waitcnt lgkmcnt(0)
    s_min_u32 s92, s92, s93
    s_min_u32 s94, s94, s95
    s_min_u32 s96, s96, s97
    s_min_u32 s98, s98, s99
    s_min_u32 s92, s92, s94
    s_min_u32 s96, s96, s98
    s_min_u32 s92, s92, s96
    s_cmp_eq_u32 s92, 0
    s_cbranch_scc1 slow_kp_kernel_47
back_kp_kernel_48:
    s_add_u32 s45, s45, 131072
    buffer_load_dwordx4 a[0:3], v3, s[4:7], s26 offen offset:0 sc1
    v_mfma_f32_16x16x32_bf16 a[156:159], a[252:255], a[76:79], a[156:159]
    v_mfma_f32_16x16x32_bf16 a[160:163], v[52:55], a[76:79], a[160:163]
    v_mfma_f32_16x16x32_bf16 a[164:167], v[56:59], a[76:79], a[164:167]
    buffer_load_dwordx4 a[4:7], v3, s[4:7], s26 offen offset:1024 sc1
    s_waitcnt vmcnt(13)
    v_mfma_f32_16x16x32_bf16 a[148:151], v[60:63], a[80:83], a[148:151]
    v_mfma_f32_16x16x32_bf16 a[152:155], v[64:67], a[80:83], a[152:155]
    v_mfma_f32_16x16x32_bf16 a[156:159], v[68:71], a[80:83], a[156:159]
    buffer_load_dwordx4 a[8:11], v3, s[4:7], s26 offen offset:2048 sc1
    v_mfma_f32_16x16x32_bf16 a[160:163], v[72:75], a[80:83], a[160:163]
    v_mfma_f32_16x16x32_bf16 a[164:167], v[76:79], a[80:83], a[164:167]
    s_waitcnt vmcnt(13)
    v_mfma_f32_16x16x32_bf16 a[148:151], v[80:83], a[84:87], a[148:151]
    buffer_load_dwordx4 a[12:15], v3, s[4:7], s26 offen offset:3072 sc1
    v_mfma_f32_16x16x32_bf16 a[152:155], v[84:87], a[84:87], a[152:155]
    v_mfma_f32_16x16x32_bf16 a[156:159], v[88:91], a[84:87], a[156:159]
    v_mfma_f32_16x16x32_bf16 a[160:163], v[92:95], a[84:87], a[160:163]
    buffer_load_dwordx4 a[16:19], v3, s[4:7], s27 offen offset:0 sc1
    v_mfma_f32_16x16x32_bf16 a[164:167], v[96:99], a[84:87], a[164:167]
    s_waitcnt vmcnt(14)
    v_mfma_f32_16x16x32_bf16 a[148:151], v[100:103], a[88:91], a[148:151]
    v_mfma_f32_16x16x32_bf16 a[152:155], v[104:107], a[88:91], a[152:155]
    buffer_load_dwordx4 a[20:23], v3, s[4:7], s27 offen offset:1024 sc1
    v_mfma_f32_16x16x32_bf16 a[156:159], v[108:111], a[88:91], a[156:159]
    s_waitcnt vmcnt(13)
    v_mfma_f32_16x16x32_bf16 a[160:163], v[112:115], a[88:91], a[160:163]
    v_swap_b32 v6, v8
    v_swap_b32 v7, v9
    v_mfma_f32_16x16x32_bf16 a[164:167], v[116:119], a[88:91], a[164:167]
    buffer_load_dwordx4 a[24:27], v3, s[4:7], s27 offen offset:2048 sc1
    v_mfma_f32_16x16x32_bf16 a[128:131], v[220:223], v[4:7], a[128:131]
    v_mfma_f32_16x16x32_bf16 a[132:135], v[224:227], v[4:7], a[132:135]
    v_mfma_f32_16x16x32_bf16 a[136:139], v[228:231], v[4:7], a[136:139]
    buffer_load_dwordx4 a[28:31], v3, s[4:7], s27 offen offset:3072 sc1
    s_buffer_load_dwordx8 s[92:99], s[4:7], s45 glc
    s_waitcnt vmcnt(13)
    v_mfma_f32_16x16x32_bf16 a[140:143], v[232:235], v[4:7], a[140:143]
    v_swap_b32 v14, v16
    v_swap_b32 v15, v17
    v_mfma_f32_16x16x32_bf16 a[144:147], v[236:239], v[4:7], a[144:147]
    s_add_u32 s26, s26, 4096
    s_add_u32 s27, s27, 4096
    v_mfma_f32_16x16x32_bf16 a[128:131], v[240:243], v[12:15], a[128:131]
    v_mfma_f32_16x16x32_bf16 a[132:135], v[244:247], v[12:15], a[132:135]
    v_mfma_f32_16x16x32_bf16 a[136:139], v[248:251], v[12:15], a[136:139]
    s_waitcnt vmcnt(11)
    v_mfma_f32_16x16x32_bf16 a[140:143], v[252:255], v[12:15], a[140:143]
    v_swap_b32 v22, v24
    v_swap_b32 v23, v25
    v_mfma_f32_16x16x32_bf16 a[144:147], a[240:243], v[12:15], a[144:147]
    s_nop 0
    v_mfma_f32_16x16x32_bf16 a[128:131], v[120:123], v[20:23], a[128:131]
    v_mfma_f32_16x16x32_bf16 a[132:135], v[124:127], v[20:23], a[132:135]
    v_mfma_f32_16x16x32_bf16 a[136:139], v[128:131], v[20:23], a[136:139]
    s_waitcnt vmcnt(9)
    v_mfma_f32_16x16x32_bf16 a[140:143], v[132:135], v[20:23], a[140:143]
    v_swap_b32 v30, v32
    v_swap_b32 v31, v33
    v_mfma_f32_16x16x32_bf16 a[144:147], a[32:35], v[20:23], a[144:147]
    s_nop 0
    v_mfma_f32_16x16x32_bf16 a[128:131], a[36:39], v[28:31], a[128:131]
    v_mfma_f32_16x16x32_bf16 a[132:135], a[40:43], v[28:31], a[132:135]
    v_mfma_f32_16x16x32_bf16 a[136:139], a[44:47], v[28:31], a[136:139]
    v_mfma_f32_16x16x32_bf16 a[140:143], a[48:51], v[28:31], a[140:143]
    v_mfma_f32_16x16x32_bf16 a[144:147], a[52:55], v[28:31], a[144:147]
    v_mfma_f32_16x16x32_bf16 a[148:151], v[220:223], v[8:11], a[148:151]
    s_sub_u32 s34, s20, 1
    s_and_b32 s34, s34, 3
    s_mul_i32 s34, s34, 5120
    s_add_u32 s34, s34, 81920
    v_add_u32 v36, s34, v3
    v_mfma_f32_16x16x32_bf16 a[152:155], v[224:227], v[8:11], a[152:155]
    v_mfma_f32_16x16x32_bf16 a[156:159], v[228:231], v[8:11], a[156:159]
    v_mfma_f32_16x16x32_bf16 a[160:163], v[232:235], v[8:11], a[160:163]
    v_mfma_f32_16x16x32_bf16 a[164:167], v[236:239], v[8:11], a[164:167]
    ds_write_b128 v36, a[128:131] offset:0
    v_mfma_f32_16x16x32_bf16 a[148:151], v[240:243], v[16:19], a[148:151]
    v_mfma_f32_16x16x32_bf16 a[152:155], v[244:247], v[16:19], a[152:155]
    v_mfma_f32_16x16x32_bf16 a[156:159], v[248:251], v[16:19], a[156:159]
    ds_write_b128 v36, a[132:135] offset:1024
    v_mfma_f32_16x16x32_bf16 a[160:163], v[252:255], v[16:19], a[160:163]
    v_mfma_f32_16x16x32_bf16 a[164:167], a[240:243], v[16:19], a[164:167]
    v_mfma_f32_16x16x32_bf16 a[148:151], v[120:123], v[24:27], a[148:151]
    ds_write_b128 v36, a[136:139] offset:2048
    v_mfma_f32_16x16x32_bf16 a[152:155], v[124:127], v[24:27], a[152:155]
    v_mfma_f32_16x16x32_bf16 a[156:159], v[128:131], v[24:27], a[156:159]
    v_mfma_f32_16x16x32_bf16 a[160:163], v[132:135], v[24:27], a[160:163]
    ds_write_b128 v36, a[140:143] offset:3072
    v_mfma_f32_16x16x32_bf16 a[164:167], a[32:35], v[24:27], a[164:167]
    v_mfma_f32_16x16x32_bf16 a[148:151], a[36:39], v[32:35], a[148:151]
    v_mfma_f32_16x16x32_bf16 a[152:155], a[40:43], v[32:35], a[152:155]
    ds_write_b128 v36, a[144:147] offset:4096
    v_mfma_f32_16x16x32_bf16 a[156:159], a[44:47], v[32:35], a[156:159]
    v_mfma_f32_16x16x32_bf16 a[160:163], a[48:51], v[32:35], a[160:163]
    s_waitcnt lgkmcnt(0)
    s_min_u32 s92, s92, s93
    s_min_u32 s94, s94, s95
    s_min_u32 s96, s96, s97
    s_min_u32 s98, s98, s99
    s_min_u32 s92, s92, s94
    s_min_u32 s96, s96, s98
    s_min_u32 s92, s92, s96
    s_cmp_eq_u32 s92, 0
    s_cbranch_scc1 slow_kp_kernel_49
back_kp_kernel_50:
    s_add_u32 s45, s45, 131072
    buffer_load_dwordx4 a[60:63], v3, s[4:7], s26 offen offset:0 sc1
    v_mfma_f32_16x16x32_bf16 a[164:167], a[52:55], v[32:35], a[164:167]
    s_waitcnt vmcnt(8)
    v_mfma_f32_16x16x32_bf16 a[168:171], v[140:143], a[0:3], 0
    s_sub_u32 s34, s20, 2
    s_and_b32 s34, s34, 3
    s_mul_i32 s34, s34, 5120
    s_add_u32 s34, s34, 102400
    v_add_u32 v36, s34, v3
    v_mfma_f32_16x16x32_bf16 a[172:175], v[144:147], a[0:3], 0
    buffer_load_dwordx4 a[64:67], v3, s[4:7], s26 offen offset:1024 sc1
    v_mfma_f32_16x16x32_bf16 a[176:179], v[148:151], a[0:3], 0
    v_mfma_f32_16x16x32_bf16 a[180:183], v[152:155], a[0:3], 0
    v_mfma_f32_16x16x32_bf16 a[184:187], v[156:159], a[0:3], 0
    buffer_load_dwordx4 a[68:71], v3, s[4:7], s26 offen offset:2048 sc1
    ds_write_b128 v36, a[148:151] offset:0
    s_waitcnt vmcnt(9)
    v_mfma_f32_16x16x32_bf16 a[168:171], v[160:163], a[4:7], a[168:171]
    v_mfma_f32_16x16x32_bf16 a[172:175], v[164:167], a[4:7], a[172:175]
    v_mfma_f32_16x16x32_bf16 a[176:179], v[168:171], a[4:7], a[176:179]
    buffer_load_dwordx4 a[72:75], v3, s[4:7], s26 offen offset:3072 sc1
    ds_write_b128 v36, a[152:155] offset:1024
    v_mfma_f32_16x16x32_bf16 a[180:183], v[172:175], a[4:7], a[180:183]
    v_mfma_f32_16x16x32_bf16 a[184:187], v[176:179], a[4:7], a[184:187]
    s_waitcnt vmcnt(9)
    v_mfma_f32_16x16x32_bf16 a[168:171], v[180:183], a[8:11], a[168:171]
    buffer_load_dwordx4 a[76:79], v3, s[4:7], s27 offen offset:0 sc1
    ds_write_b128 v36, a[156:159] offset:2048
    v_mfma_f32_16x16x32_bf16 a[172:175], v[184:187], a[8:11], a[172:175]
    v_mfma_f32_16x16x32_bf16 a[176:179], v[188:191], a[8:11], a[176:179]
    v_mfma_f32_16x16x32_bf16 a[180:183], v[192:195], a[8:11], a[180:183]
    buffer_load_dwordx4 a[80:83], v3, s[4:7], s27 offen offset:1024 sc1
    ds_write_b128 v36, a[160:163] offset:3072
    v_mfma_f32_16x16x32_bf16 a[184:187], v[196:199], a[8:11], a[184:187]
    s_waitcnt vmcnt(10)
    v_mfma_f32_16x16x32_bf16 a[168:171], v[200:203], a[12:15], a[168:171]
    v_mfma_f32_16x16x32_bf16 a[172:175], v[204:207], a[12:15], a[172:175]
    buffer_load_dwordx4 a[84:87], v3, s[4:7], s27 offen offset:2048 sc1
    ds_write_b128 v36, a[164:167] offset:4096
    v_mfma_f32_16x16x32_bf16 a[176:179], v[208:211], a[12:15], a[176:179]
    v_mfma_f32_16x16x32_bf16 a[180:183], v[212:215], a[12:15], a[180:183]
    v_mfma_f32_16x16x32_bf16 a[184:187], v[216:219], a[12:15], a[184:187]
    buffer_load_dwordx4 a[88:91], v3, s[4:7], s27 offen offset:3072 sc1
    s_waitcnt vmcnt(11)
    v_mfma_f32_16x16x32_bf16 a[168:171], a[244:247], a[16:19], a[168:171]
    v_mfma_f32_16x16x32_bf16 a[172:175], a[248:251], a[16:19], a[172:175]
    s_add_u32 s26, s26, 4096
    s_add_u32 s27, s27, 4096
    v_mfma_f32_16x16x32_bf16 a[176:179], a[252:255], a[16:19], a[176:179]
    s_add_u32 s46, s26, 4096
    buffer_load_dwordx4 v[4:7], v3, s[4:7], s46 offen offset:0 sc1
    v_mfma_f32_16x16x32_bf16 a[180:183], v[52:55], a[16:19], a[180:183]
    v_mfma_f32_16x16x32_bf16 a[184:187], v[56:59], a[16:19], a[184:187]
    s_waitcnt vmcnt(11)
    v_mfma_f32_16x16x32_bf16 a[168:171], v[60:63], a[20:23], a[168:171]
    buffer_load_dwordx4 v[8:11], v3, s[4:7], s46 offen offset:1024 sc1
    v_mfma_f32_16x16x32_bf16 a[172:175], v[64:67], a[20:23], a[172:175]
    v_mfma_f32_16x16x32_bf16 a[176:179], v[68:71], a[20:23], a[176:179]
    v_mfma_f32_16x16x32_bf16 a[180:183], v[72:75], a[20:23], a[180:183]
    buffer_load_dwordx4 v[12:15], v3, s[4:7], s46 offen offset:2048 sc1
    v_mfma_f32_16x16x32_bf16 a[184:187], v[76:79], a[20:23], a[184:187]
    s_waitcnt vmcnt(12)
    v_mfma_f32_16x16x32_bf16 a[168:171], v[80:83], a[24:27], a[168:171]
    v_mfma_f32_16x16x32_bf16 a[172:175], v[84:87], a[24:27], a[172:175]
    buffer_load_dwordx4 v[16:19], v3, s[4:7], s46 offen offset:3072 sc1
    v_mfma_f32_16x16x32_bf16 a[176:179], v[88:91], a[24:27], a[176:179]
    v_mfma_f32_16x16x32_bf16 a[180:183], v[92:95], a[24:27], a[180:183]
    v_mfma_f32_16x16x32_bf16 a[184:187], v[96:99], a[24:27], a[184:187]
    s_add_u32 s46, s27, 4096
    buffer_load_dwordx4 v[20:23], v3, s[4:7], s46 offen offset:0 sc1
    s_waitcnt vmcnt(13)
    v_mfma_f32_16x16x32_bf16 a[168:171], v[100:103], a[28:31], a[168:171]
    v_mfma_f32_16x16x32_bf16 a[172:175], v[104:107], a[28:31], a[172:175]
    v_mfma_f32_16x16x32_bf16 a[176:179], v[108:111], a[28:31], a[176:179]
    buffer_load_dwordx4 v[24:27], v3, s[4:7], s46 offen offset:1024 sc1
    v_mfma_f32_16x16x32_bf16 a[180:183], v[112:115], a[28:31], a[180:183]
    v_mfma_f32_16x16x32_bf16 a[184:187], v[116:119], a[28:31], a[184:187]
    s_waitcnt vmcnt(13)
    v_mfma_f32_16x16x32_bf16 a[188:191], v[140:143], a[60:63], 0
    buffer_load_dwordx4 v[28:31], v3, s[4:7], s46 offen offset:2048 sc1
    v_mfma_f32_16x16x32_bf16 a[192:195], v[144:147], a[60:63], 0
    v_mfma_f32_16x16x32_bf16 a[196:199], v[148:151], a[60:63], 0
    v_mfma_f32_16x16x32_bf16 a[200:203], v[152:155], a[60:63], 0
    buffer_load_dwordx4 v[32:35], v3, s[4:7], s46 offen offset:3072 sc1
    v_mfma_f32_16x16x32_bf16 a[204:207], v[156:159], a[60:63], 0
    s_waitcnt vmcnt(14)
    v_mfma_f32_16x16x32_bf16 a[188:191], v[160:163], a[64:67], a[188:191]
    v_mfma_f32_16x16x32_bf16 a[192:195], v[164:167], a[64:67], a[192:195]
    v_mfma_f32_16x16x32_bf16 a[196:199], v[168:171], a[64:67], a[196:199]
    v_mfma_f32_16x16x32_bf16 a[200:203], v[172:175], a[64:67], a[200:203]
    buffer_load_dwordx4 v[40:43], v37, s[4:7], s48 offen offset:0 sc1
    v_mfma_f32_16x16x32_bf16 a[204:207], v[176:179], a[64:67], a[204:207]
    s_waitcnt vmcnt(14)
    v_mfma_f32_16x16x32_bf16 a[188:191], v[180:183], a[68:71], a[188:191]
    v_mfma_f32_16x16x32_bf16 a[192:195], v[184:187], a[68:71], a[192:195]
    buffer_load_dwordx4 v[44:47], v37, s[4:7], s48 offen offset:64 sc1
    v_mfma_f32_16x16x32_bf16 a[196:199], v[188:191], a[68:71], a[196:199]
    v_mfma_f32_16x16x32_bf16 a[200:203], v[192:195], a[68:71], a[200:203]
    v_mfma_f32_16x16x32_bf16 a[204:207], v[196:199], a[68:71], a[204:207]
    buffer_load_dwordx2 v[48:49], v50, s[4:7], s48 offen offset:128 sc1
    s_waitcnt vmcnt(15)
    v_mfma_f32_16x16x32_bf16 a[188:191], v[200:203], a[72:75], a[188:191]
    v_mfma_f32_16x16x32_bf16 a[192:195], v[204:207], a[72:75], a[192:195]
    v_mfma_f32_16x16x32_bf16 a[196:199], v[208:211], a[72:75], a[196:199]
    v_mfma_f32_16x16x32_bf16 a[200:203], v[212:215], a[72:75], a[200:203]
    v_mfma_f32_16x16x32_bf16 a[204:207], v[216:219], a[72:75], a[204:207]
    s_waitcnt vmcnt(14)
    v_mfma_f32_16x16x32_bf16 a[188:191], a[244:247], a[76:79], a[188:191]
    v_mfma_f32_16x16x32_bf16 a[192:195], a[248:251], a[76:79], a[192:195]
    v_mfma_f32_16x16x32_bf16 a[196:199], a[252:255], a[76:79], a[196:199]
    v_mfma_f32_16x16x32_bf16 a[200:203], v[52:55], a[76:79], a[200:203]
    v_mfma_f32_16x16x32_bf16 a[204:207], v[56:59], a[76:79], a[204:207]
    s_waitcnt vmcnt(13)
    v_mfma_f32_16x16x32_bf16 a[188:191], v[60:63], a[80:83], a[188:191]
    v_mfma_f32_16x16x32_bf16 a[192:195], v[64:67], a[80:83], a[192:195]
    v_mfma_f32_16x16x32_bf16 a[196:199], v[68:71], a[80:83], a[196:199]
    v_mfma_f32_16x16x32_bf16 a[200:203], v[72:75], a[80:83], a[200:203]
    v_mfma_f32_16x16x32_bf16 a[204:207], v[76:79], a[80:83], a[204:207]
    s_waitcnt vmcnt(12)
    v_mfma_f32_16x16x32_bf16 a[188:191], v[80:83], a[84:87], a[188:191]
    v_mfma_f32_16x16x32_bf16 a[192:195], v[84:87], a[84:87], a[192:195]
    v_mfma_f32_16x16x32_bf16 a[196:199], v[88:91], a[84:87], a[196:199]
    v_mfma_f32_16x16x32_bf16 a[200:203], v[92:95], a[84:87], a[200:203]
    v_mfma_f32_16x16x32_bf16 a[204:207], v[96:99], a[84:87], a[204:207]
    s_waitcnt vmcnt(11)
    v_mfma_f32_16x16x32_bf16 a[188:191], v[100:103], a[88:91], a[188:191]
    v_mfma_f32_16x16x32_bf16 a[192:195], v[104:107], a[88:91], a[192:195]
    v_mfma_f32_16x16x32_bf16 a[196:199], v[108:111], a[88:91], a[196:199]
    s_waitcnt vmcnt(9)
    v_mfma_f32_16x16x32_bf16 a[200:203], v[112:115], a[88:91], a[200:203]
    v_swap_b32 v6, v8
    v_swap_b32 v7, v9
    v_mfma_f32_16x16x32_bf16 a[204:207], v[116:119], a[88:91], a[204:207]
    s_nop 0
    v_mfma_f32_16x16x32_bf16 a[168:171], v[220:223], v[4:7], a[168:171]
    v_mfma_f32_16x16x32_bf16 a[172:175], v[224:227], v[4:7], a[172:175]
    v_mfma_f32_16x16x32_bf16 a[176:179], v[228:231], v[4:7], a[176:179]
    s_waitcnt vmcnt(7)
    v_mfma_f32_16x16x32_bf16 a[180:183], v[232:235], v[4:7], a[180:183]
    v_swap_b32 v14, v16
    v_swap_b32 v15, v17
    v_mfma_f32_16x16x32_bf16 a[184:187], v[236:239], v[4:7], a[184:187]
    s_nop 0
    v_mfma_f32_16x16x32_bf16 a[168:171], v[240:243], v[12:15], a[168:171]
    v_mfma_f32_16x16x32_bf16 a[172:175], v[244:247], v[12:15], a[172:175]
    v_mfma_f32_16x16x32_bf16 a[176:179], v[248:251], v[12:15], a[176:179]
    s_waitcnt vmcnt(5)
    v_mfma_f32_16x16x32_bf16 a[180:183], v[252:255], v[12:15], a[180:183]
    v_swap_b32 v22, v24
    v_swap_b32 v23, v25
    v_mfma_f32_16x16x32_bf16 a[184:187], a[240:243], v[12:15], a[184:187]
    s_nop 0
    v_mfma_f32_16x16x32_bf16 a[168:171], v[120:123], v[20:23], a[168:171]
    v_mfma_f32_16x16x32_bf16 a[172:175], v[124:127], v[20:23], a[172:175]
    v_mfma_f32_16x16x32_bf16 a[176:179], v[128:131], v[20:23], a[176:179]
    s_waitcnt vmcnt(3)
    v_mfma_f32_16x16x32_bf16 a[180:183], v[132:135], v[20:23], a[180:183]
    v_swap_b32 v30, v32
    v_swap_b32 v31, v33
    v_mfma_f32_16x16x32_bf16 a[184:187], a[32:35], v[20:23], a[184:187]
    s_nop 0
    v_mfma_f32_16x16x32_bf16 a[168:171], a[36:39], v[28:31], a[168:171]
    v_mfma_f32_16x16x32_bf16 a[172:175], a[40:43], v[28:31], a[172:175]
    v_mfma_f32_16x16x32_bf16 a[176:179], a[44:47], v[28:31], a[176:179]
    v_mfma_f32_16x16x32_bf16 a[180:183], a[48:51], v[28:31], a[180:183]
    v_mfma_f32_16x16x32_bf16 a[184:187], a[52:55], v[28:31], a[184:187]
    v_mfma_f32_16x16x32_bf16 a[188:191], v[220:223], v[8:11], a[188:191]
    s_sub_u32 s34, s20, 3
    s_and_b32 s34, s34, 3
    s_mul_i32 s34, s34, 5120
    s_add_u32 s34, s34, 122880
    v_add_u32 v36, s34, v3
    v_mfma_f32_16x16x32_bf16 a[192:195], v[224:227], v[8:11], a[192:195]
    v_mfma_f32_16x16x32_bf16 a[196:199], v[228:231], v[8:11], a[196:199]
    v_mfma_f32_16x16x32_bf16 a[200:203], v[232:235], v[8:11], a[200:203]
    v_mfma_f32_16x16x32_bf16 a[204:207], v[236:239], v[8:11], a[204:207]
    ds_write_b128 v36, a[168:171] offset:0
    v_mfma_f32_16x16x32_bf16 a[188:191], v[240:243], v[16:19], a[188:191]
    v_mfma_f32_16x16x32_bf16 a[192:195], v[244:247], v[16:19], a[192:195]
    v_mfma_f32_16x16x32_bf16 a[196:199], v[248:251], v[16:19], a[196:199]
    ds_write_b128 v36, a[172:175] offset:1024
    v_mfma_f32_16x16x32_bf16 a[200:203], v[252:255], v[16:19], a[200:203]
    v_mfma_f32_16x16x32_bf16 a[204:207], a[240:243], v[16:19], a[204:207]
    v_mfma_f32_16x16x32_bf16 a[188:191], v[120:123], v[24:27], a[188:191]
    ds_write_b128 v36, a[176:179] offset:2048
    v_mfma_f32_16x16x32_bf16 a[192:195], v[124:127], v[24:27], a[192:195]
    v_mfma_f32_16x16x32_bf16 a[196:199], v[128:131], v[24:27], a[196:199]
    v_mfma_f32_16x16x32_bf16 a[200:203], v[132:135], v[24:27], a[200:203]
    ds_write_b128 v36, a[180:183] offset:3072
    v_mfma_f32_16x16x32_bf16 a[204:207], a[32:35], v[24:27], a[204:207]
    v_mfma_f32_16x16x32_bf16 a[188:191], a[36:39], v[32:35], a[188:191]
    v_mfma_f32_16x16x32_bf16 a[192:195], a[40:43], v[32:35], a[192:195]
    ds_write_b128 v36, a[184:187] offset:4096
    v_mfma_f32_16x16x32_bf16 a[196:199], a[44:47], v[32:35], a[196:199]
    v_mfma_f32_16x16x32_bf16 a[200:203], a[48:51], v[32:35], a[200:203]
    s_sub_u32 s34, s20, 4
    s_and_b32 s34, s34, 3
    s_mul_i32 s34, s34, 5120
    s_add_u32 s34, s34, 143360
    v_add_u32 v36, s34, v3
    v_mfma_f32_16x16x32_bf16 a[204:207], a[52:55], v[32:35], a[204:207]
    ds_write_b128 v36, a[188:191] offset:0
    ds_write_b128 v36, a[192:195] offset:1024
    ds_write_b128 v36, a[196:199] offset:2048
    ds_write_b128 v36, a[200:203] offset:3072
    s_nop 3
    ds_write_b128 v36, a[204:207] offset:4096
own_kp_kernel_51:
    s_cmp_lg_u32 s20, 0
    s_cbranch_scc1 own_kp_kernel_52
    v_accvgpr_read_b32 v52, a128
    v_accvgpr_read_b32 v53, a129
    v_accvgpr_read_b32 v54, a130
    v_accvgpr_read_b32 v55, a131
    v_accvgpr_read_b32 v56, a132
    v_accvgpr_read_b32 v57, a133
    v_accvgpr_read_b32 v58, a134
    v_accvgpr_read_b32 v59, a135
    v_accvgpr_read_b32 v60, a136
    v_accvgpr_read_b32 v61, a137
    v_accvgpr_read_b32 v62, a138
    v_accvgpr_read_b32 v63, a139
    v_accvgpr_read_b32 v64, a140
    v_accvgpr_read_b32 v65, a141
    v_accvgpr_read_b32 v66, a142
    v_accvgpr_read_b32 v67, a143
    v_accvgpr_read_b32 v68, a144
    v_accvgpr_read_b32 v69, a145
    v_accvgpr_read_b32 v70, a146
    v_accvgpr_read_b32 v71, a147
    s_branch own_kp_kernel_55
own_kp_kernel_52:
    s_cmp_lg_u32 s20, 1
    s_cbranch_scc1 own_kp_kernel_53
    v_accvgpr_read_b32 v52, a148
    v_accvgpr_read_b32 v53, a149
    v_accvgpr_read_b32 v54, a150
    v_accvgpr_read_b32 v55, a151
    v_accvgpr_read_b32 v56, a152
    v_accvgpr_read_b32 v57, a153
    v_accvgpr_read_b32 v58, a154
    v_accvgpr_read_b32 v59, a155
    v_accvgpr_read_b32 v60, a156
    v_accvgpr_read_b32 v61, a157
    v_accvgpr_read_b32 v62, a158
    v_accvgpr_read_b32 v63, a159
    v_accvgpr_read_b32 v64, a160
    v_accvgpr_read_b32 v65, a161
    v_accvgpr_read_b32 v66, a162
    v_accvgpr_read_b32 v67, a163
    v_accvgpr_read_b32 v68, a164
    v_accvgpr_read_b32 v69, a165
    v_accvgpr_read_b32 v70, a166
    v_accvgpr_read_b32 v71, a167
    s_branch own_kp_kernel_55
own_kp_kernel_53:
    s_cmp_lg_u32 s20, 2
    s_cbranch_scc1 own_kp_kernel_54
    v_accvgpr_read_b32 v52, a168
    v_accvgpr_read_b32 v53, a169
    v_accvgpr_read_b32 v54, a170
    v_accvgpr_read_b32 v55, a171
    v_accvgpr_read_b32 v56, a172
    v_accvgpr_read_b32 v57, a173
    v_accvgpr_read_b32 v58, a174
    v_accvgpr_read_b32 v59, a175
    v_accvgpr_read_b32 v60, a176
    v_accvgpr_read_b32 v61, a177
    v_accvgpr_read_b32 v62, a178
    v_accvgpr_read_b32 v63, a179
    v_accvgpr_read_b32 v64, a180
    v_accvgpr_read_b32 v65, a181
    v_accvgpr_read_b32 v66, a182
    v_accvgpr_read_b32 v67, a183
    v_accvgpr_read_b32 v68, a184
    v_accvgpr_read_b32 v69, a185
    v_accvgpr_read_b32 v70, a186
    v_accvgpr_read_b32 v71, a187
    s_branch own_kp_kernel_55
own_kp_kernel_54:
    v_accvgpr_read_b32 v52, a188
    v_accvgpr_read_b32 v53, a189
    v_accvgpr_read_b32 v54, a190
    v_accvgpr_read_b32 v55, a191
    v_accvgpr_read_b32 v56, a192
    v_accvgpr_read_b32 v57, a193
    v_accvgpr_read_b32 v58, a194
    v_accvgpr_read_b32 v59, a195
    v_accvgpr_read_b32 v60, a196
    v_accvgpr_read_b32 v61, a197
    v_accvgpr_read_b32 v62, a198
    v_accvgpr_read_b32 v63, a199
    v_accvgpr_read_b32 v64, a200
    v_accvgpr_read_b32 v65, a201
    v_accvgpr_read_b32 v66, a202
    v_accvgpr_read_b32 v67, a203
    v_accvgpr_read_b32 v68, a204
    v_accvgpr_read_b32 v69, a205
    v_accvgpr_read_b32 v70, a206
    v_accvgpr_read_b32 v71, a207
own_kp_kernel_55:
    s_mul_i32 s34, s20, 20480
    s_add_u32 s34, s34, 81920
    v_add_u32 v36, s34, v3
    s_waitcnt vmcnt(0)
    s_waitcnt lgkmcnt(0)
    s_barrier
    ds_read_b128 v[72:75], v36 offset:0
    ds_read_b128 v[76:79], v36 offset:1024
    ds_read_b128 v[80:83], v36 offset:2048
    ds_read_b128 v[84:87], v36 offset:3072
    ds_read_b128 v[88:91], v36 offset:4096
    ds_read_b128 v[92:95], v36 offset:5120
    ds_read_b128 v[96:99], v36 offset:6144
    ds_read_b128 v[100:103], v36 offset:7168
    ds_read_b128 v[104:107], v36 offset:8192
    ds_read_b128 v[108:111], v36 offset:9216
    ds_read_b128 v[112:115], v36 offset:10240
    ds_read_b128 v[116:119], v36 offset:11264
    ds_read_b128 v[120:123], v36 offset:12288
    ds_read_b128 v[124:127], v36 offset:13312
    ds_read_b128 v[128:131], v36 offset:14336
    v_permlane16_swap_b32 v40, v42
    v_permlane16_swap_b32 v41, v43
    v_permlane16_swap_b32 v44, v46
    v_permlane16_swap_b32 v45, v47
    v_lshlrev_b32 v4, 16, v40
    v_and_b32 v5, 0xffff0000, v40
    v_lshlrev_b32 v6, 16, v41
    v_and_b32 v7, 0xffff0000, v41
    v_lshlrev_b32 v8, 16, v42
    v_and_b32 v9, 0xffff0000, v42
    v_lshlrev_b32 v10, 16, v43
    v_and_b32 v11, 0xffff0000, v43
    v_lshlrev_b32 v12, 16, v44
    v_and_b32 v13, 0xffff0000, v44
    v_lshlrev_b32 v14, 16, v45
    v_and_b32 v15, 0xffff0000, v45
    v_lshlrev_b32 v16, 16, v46
    v_and_b32 v17, 0xffff0000, v46
    v_lshlrev_b32 v18, 16, v47
    v_and_b32 v19, 0xffff0000, v47
    v_lshlrev_b32 v20, 16, v48
    v_and_b32 v21, 0xffff0000, v48
    v_lshlrev_b32 v22, 16, v49
    v_and_b32 v23, 0xffff0000, v49
    v_pk_add_f32 v[52:53], v[52:53], v[4:5]
    v_pk_add_f32 v[54:55], v[54:55], v[6:7]
    v_pk_add_f32 v[56:57], v[56:57], v[8:9]
    v_pk_add_f32 v[58:59], v[58:59], v[10:11]
    v_pk_add_f32 v[60:61], v[60:61], v[12:13]
    v_pk_add_f32 v[62:63], v[62:63], v[14:15]
    v_pk_add_f32 v[64:65], v[64:65], v[16:17]
    v_pk_add_f32 v[66:67], v[66:67], v[18:19]
    v_pk_add_f32 v[68:69], v[68:69], v[20:21]
    v_pk_add_f32 v[70:71], v[70:71], v[22:23]
    s_waitcnt lgkmcnt(14)
    v_pk_add_f32 v[52:53], v[52:53], v[72:73]
    v_pk_add_f32 v[54:55], v[54:55], v[74:75]
    s_waitcnt lgkmcnt(13)
    v_pk_add_f32 v[56:57], v[56:57], v[76:77]
    v_pk_add_f32 v[58:59], v[58:59], v[78:79]
    s_waitcnt lgkmcnt(12)
    v_pk_add_f32 v[60:61], v[60:61], v[80:81]
    v_pk_add_f32 v[62:63], v[62:63], v[82:83]
    s_waitcnt lgkmcnt(11)
    v_pk_add_f32 v[64:65], v[64:65], v[84:85]
    v_pk_add_f32 v[66:67], v[66:67], v[86:87]
    s_waitcnt lgkmcnt(10)
    v_pk_add_f32 v[68:69], v[68:69], v[88:89]
    v_pk_add_f32 v[70:71], v[70:71], v[90:91]
    s_waitcnt lgkmcnt(9)
    v_pk_add_f32 v[52:53], v[52:53], v[92:93]
    v_pk_add_f32 v[54:55], v[54:55], v[94:95]
    s_waitcnt lgkmcnt(8)
    v_pk_add_f32 v[56:57], v[56:57], v[96:97]
    v_pk_add_f32 v[58:59], v[58:59], v[98:99]
    s_waitcnt lgkmcnt(7)
    v_pk_add_f32 v[60:61], v[60:61], v[100:101]
    v_pk_add_f32 v[62:63], v[62:63], v[102:103]
    s_waitcnt lgkmcnt(6)
    v_pk_add_f32 v[64:65], v[64:65], v[104:105]
    v_pk_add_f32 v[66:67], v[66:67], v[106:107]
    s_waitcnt lgkmcnt(5)
    v_pk_add_f32 v[68:69], v[68:69], v[108:109]
    v_pk_add_f32 v[70:71], v[70:71], v[110:111]
    s_waitcnt lgkmcnt(4)
    v_pk_add_f32 v[52:53], v[52:53], v[112:113]
    v_pk_add_f32 v[54:55], v[54:55], v[114:115]
    s_waitcnt lgkmcnt(3)
    v_pk_add_f32 v[56:57], v[56:57], v[116:117]
    v_pk_add_f32 v[58:59], v[58:59], v[118:119]
    s_waitcnt lgkmcnt(2)
    v_pk_add_f32 v[60:61], v[60:61], v[120:121]
    v_pk_add_f32 v[62:63], v[62:63], v[122:123]
    s_waitcnt lgkmcnt(1)
    v_pk_add_f32 v[64:65], v[64:65], v[124:125]
    v_pk_add_f32 v[66:67], v[66:67], v[126:127]
    s_waitcnt lgkmcnt(0)
    v_pk_add_f32 v[68:69], v[68:69], v[128:129]
    v_pk_add_f32 v[70:71], v[70:71], v[130:131]
    v_cvt_pk_bf16_f32 v40, v52, v53
    v_cvt_pk_bf16_f32 v41, v54, v55
    v_cvt_pk_bf16_f32 v42, v56, v57
    v_cvt_pk_bf16_f32 v43, v58, v59
    v_cvt_pk_bf16_f32 v44, v60, v61
    v_cvt_pk_bf16_f32 v45, v62, v63
    v_cvt_pk_bf16_f32 v46, v64, v65
    v_cvt_pk_bf16_f32 v47, v66, v67
    v_cvt_pk_bf16_f32 v48, v68, v69
    v_cvt_pk_bf16_f32 v49, v70, v71
    v_permlane16_swap_b32 v40, v42
    v_permlane16_swap_b32 v41, v43
    buffer_store_dwordx4 v[40:43], v38, s[12:15], s31 offen offset:0
    v_permlane16_swap_b32 v44, v46
    v_permlane16_swap_b32 v45, v47
    buffer_store_dwordx4 v[44:47], v38, s[12:15], s31 offen offset:64
    buffer_store_dwordx2 v[48:49], v51, s[12:15], s31 offen offset:128
done_kp_kernel_1:
    s_endpgm
rd_kp_kernel_36:
    s_add_u32 s53, s53, 1
    s_cmp_gt_u32 s53, 200
    s_cbranch_scc1 rb_kp_kernel_37
    s_waitcnt vmcnt(0) lgkmcnt(0)
    s_barrier
    s_branch redo_kp_kernel_26
slow_kp_kernel_11:
    s_mov_b32 s57, 0
sp_kp_kernel_56:
    s_buffer_load_dwordx8 s[92:99], s[4:7], s45 glc
    s_waitcnt lgkmcnt(0)
    s_min_u32 s92, s92, s93
    s_min_u32 s94, s94, s95
    s_min_u32 s96, s96, s97
    s_min_u32 s98, s98, s99
    s_min_u32 s92, s92, s94
    s_min_u32 s96, s96, s98
    s_min_u32 s92, s92, s96
    s_cmp_eq_u32 s92, 0
    s_cbranch_scc1 ag_kp_kernel_57
    s_branch back_kp_kernel_12
ag_kp_kernel_57:
    s_add_u32 s57, s57, 1
    s_cmp_lt_u32 s57, 48
    s_cbranch_scc1 sp_kp_kernel_56
    s_mov_b32 s57, 0
poll_kp_kernel_58:
    buffer_load_dword v136, v0, s[4:7], s45 offen sc1
    s_add_u32 s57, s57, 1
    s_waitcnt vmcnt(0)
    s_cmp_gt_u32 s57, 524288
    s_cbranch_scc1 back_kp_kernel_12
    v_cmp_gt_u32 vcc, 1, v136
    s_cbranch_vccnz poll_kp_kernel_58
    s_branch back_kp_kernel_12
slow_kp_kernel_13:
    s_mov_b32 s57, 0
sp_kp_kernel_59:
    s_buffer_load_dwordx8 s[92:99], s[4:7], s45 glc
    s_waitcnt lgkmcnt(0)
    s_min_u32 s92, s92, s93
    s_min_u32 s94, s94, s95
    s_min_u32 s96, s96, s97
    s_min_u32 s98, s98, s99
    s_min_u32 s92, s92, s94
    s_min_u32 s96, s96, s98
    s_min_u32 s92, s92, s96
    s_cmp_eq_u32 s92, 0
    s_cbranch_scc1 ag_kp_kernel_60
    s_branch back_kp_kernel_14
ag_kp_kernel_60:
    s_add_u32 s57, s57, 1
    s_cmp_lt_u32 s57, 48
    s_cbranch_scc1 sp_kp_kernel_59
    s_mov_b32 s57, 0
poll_kp_kernel_61:
    buffer_load_dword v136, v0, s[4:7], s45 offen sc1
    s_add_u32 s57, s57, 1
    s_waitcnt vmcnt(0)
    s_cmp_gt_u32 s57, 524288
    s_cbranch_scc1 back_kp_kernel_14
    v_cmp_gt_u32 vcc, 1, v136
    s_cbranch_vccnz poll_kp_kernel_61
    s_branch back_kp_kernel_14
slow_kp_kernel_15:
    s_mov_b32 s57, 0
sp_kp_kernel_62:
    s_buffer_load_dwordx8 s[92:99], s[4:7], s45 glc
    s_waitcnt lgkmcnt(0)
    s_min_u32 s92, s92, s93
    s_min_u32 s94, s94, s95
    s_min_u32 s96, s96, s97
    s_min_u32 s98, s98, s99
    s_min_u32 s92, s92, s94
    s_min_u32 s96, s96, s98
    s_min_u32 s92, s92, s96
    s_cmp_eq_u32 s92, 0
    s_cbranch_scc1 ag_kp_kernel_63
    s_branch back_kp_kernel_16
ag_kp_kernel_63:
    s_add_u32 s57, s57, 1
    s_cmp_lt_u32 s57, 48
    s_cbranch_scc1 sp_kp_kernel_62
    s_mov_b32 s57, 0
poll_kp_kernel_64:
    buffer_load_dword v136, v0, s[4:7], s45 offen sc1
    s_add_u32 s57, s57, 1
    s_waitcnt vmcnt(0)
    s_cmp_gt_u32 s57, 524288
    s_cbranch_scc1 back_kp_kernel_16
    v_cmp_gt_u32 vcc, 1, v136
    s_cbranch_vccnz poll_kp_kernel_64
    s_branch back_kp_kernel_16
slow_kp_kernel_17:
    s_mov_b32 s57, 0
sp_kp_kernel_65:
    s_buffer_load_dwordx8 s[92:99], s[4:7], s45 glc
    s_waitcnt lgkmcnt(0)
    s_min_u32 s92, s92, s93
    s_min_u32 s94, s94, s95
    s_min_u32 s96, s96, s97
    s_min_u32 s98, s98, s99
    s_min_u32 s92, s92, s94
    s_min_u32 s96, s96, s98
    s_min_u32 s92, s92, s96
    s_cmp_eq_u32 s92, 0
    s_cbranch_scc1 ag_kp_kernel_66
    s_branch back_kp_kernel_18
ag_kp_kernel_66:
    s_add_u32 s57, s57, 1
    s_cmp_lt_u32 s57, 48
    s_cbranch_scc1 sp_kp_kernel_65
    s_mov_b32 s57, 0
poll_kp_kernel_67:
    buffer_load_dword v136, v0, s[4:7], s45 offen sc1
    s_add_u32 s57, s57, 1
    s_waitcnt vmcnt(0)
    s_cmp_gt_u32 s57, 524288
    s_cbranch_scc1 back_kp_kernel_18
    v_cmp_gt_u32 vcc, 1, v136
    s_cbranch_vccnz poll_kp_kernel_67
    s_branch back_kp_kernel_18
slow_kp_kernel_43:
    s_mov_b32 s57, 0
sp_kp_kernel_68:
    s_buffer_load_dwordx8 s[92:99], s[4:7], s45 glc
    s_waitcnt lgkmcnt(0)
    s_min_u32 s92, s92, s93
    s_min_u32 s94, s94, s95
    s_min_u32 s96, s96, s97
    s_min_u32 s98, s98, s99
    s_min_u32 s92, s92, s94
    s_min_u32 s96, s96, s98
    s_min_u32 s92, s92, s96
    s_cmp_eq_u32 s92, 0
    s_cbranch_scc1 ag_kp_kernel_69
    s_branch back_kp_kernel_44
ag_kp_kernel_69:
    s_add_u32 s57, s57, 1
    s_cmp_lt_u32 s57, 48
    s_cbranch_scc1 sp_kp_kernel_68
    s_mov_b32 s57, 0
poll_kp_kernel_70:
    buffer_load_dword v136, v0, s[4:7], s45 offen sc1
    s_add_u32 s57, s57, 1
    s_waitcnt vmcnt(0)
    s_cmp_gt_u32 s57, 524288
    s_cbranch_scc1 back_kp_kernel_44
    v_cmp_gt_u32 vcc, 1, v136
    s_cbranch_vccnz poll_kp_kernel_70
    s_branch back_kp_kernel_44
slow_kp_kernel_45:
    s_mov_b32 s57, 0
sp_kp_kernel_71:
    s_buffer_load_dwordx8 s[92:99], s[4:7], s45 glc
    s_waitcnt lgkmcnt(0)
    s_min_u32 s92, s92, s93
    s_min_u32 s94, s94, s95
    s_min_u32 s96, s96, s97
    s_min_u32 s98, s98, s99
    s_min_u32 s92, s92, s94
    s_min_u32 s96, s96, s98
    s_min_u32 s92, s92, s96
    s_cmp_eq_u32 s92, 0
    s_cbranch_scc1 ag_kp_kernel_72
    s_branch back_kp_kernel_46
ag_kp_kernel_72:
    s_add_u32 s57, s57, 1
    s_cmp_lt_u32 s57, 48
    s_cbranch_scc1 sp_kp_kernel_71
    s_mov_b32 s57, 0
poll_kp_kernel_73:
    buffer_load_dword v136, v0, s[4:7], s45 offen sc1
    s_add_u32 s57, s57, 1
    s_waitcnt vmcnt(0)
    s_cmp_gt_u32 s57, 524288
    s_cbranch_scc1 back_kp_kernel_46
    v_cmp_gt_u32 vcc, 1, v136
    s_cbranch_vccnz poll_kp_kernel_73
    s_branch back_kp_kernel_46
slow_kp_kernel_47:
    s_mov_b32 s57, 0
sp_kp_kernel_74:
    s_buffer_load_dwordx8 s[92:99], s[4:7], s45 glc
    s_waitcnt lgkmcnt(0)
    s_min_u32 s92, s92, s93
    s_min_u32 s94, s94, s95
    s_min_u32 s96, s96, s97
    s_min_u32 s98, s98, s99
    s_min_u32 s92, s92, s94
    s_min_u32 s96, s96, s98
    s_min_u32 s92, s92, s96
    s_cmp_eq_u32 s92, 0
    s_cbranch_scc1 ag_kp_kernel_75
    s_branch back_kp_kernel_48
ag_kp_kernel_75:
    s_add_u32 s57, s57, 1
    s_cmp_lt_u32 s57, 48
    s_cbranch_scc1 sp_kp_kernel_74
    s_mov_b32 s57, 0
poll_kp_kernel_76:
    buffer_load_dword v136, v0, s[4:7], s45 offen sc1
    s_add_u32 s57, s57, 1
    s_waitcnt vmcnt(0)
    s_cmp_gt_u32 s57, 524288
    s_cbranch_scc1 back_kp_kernel_48
    v_cmp_gt_u32 vcc, 1, v136
    s_cbranch_vccnz poll_kp_kernel_76
    s_branch back_kp_kernel_48
slow_kp_kernel_49:
    s_mov_b32 s57, 0
sp_kp_kernel_77:
    s_buffer_load_dwordx8 s[92:99], s[4:7], s45 glc
    s_waitcnt lgkmcnt(0)
    s_min_u32 s92, s92, s93
    s_min_u32 s94, s94, s95
    s_min_u32 s96, s96, s97
    s_min_u32 s98, s98, s99
    s_min_u32 s92, s92, s94
    s_min_u32 s96, s96, s98
    s_min_u32 s92, s92, s96
    s_cmp_eq_u32 s92, 0
    s_cbranch_scc1 ag_kp_kernel_78
    s_branch back_kp_kernel_50
ag_kp_kernel_78:
    s_add_u32 s57, s57, 1
    s_cmp_lt_u32 s57, 48
    s_cbranch_scc1 sp_kp_kernel_77
    s_mov_b32 s57, 0
poll_kp_kernel_79:
    buffer_load_dword v136, v0, s[4:7], s45 offen sc1
    s_add_u32 s57, s57, 1
    s_waitcnt vmcnt(0)
    s_cmp_gt_u32 s57, 524288
    s_cbranch_scc1 back_kp_kernel_50
    v_cmp_gt_u32 vcc, 1, v136
    s_cbranch_vccnz poll_kp_kernel_79
    s_branch back_kp_kernel_50
.p2align 8
.type tbl,@object
tbl:
.long 0x3c003c00,0x3c003c00,0x3c003c00,0x3c003c00,0x3c003c00,0x3c003c00,0x3c003c00,0x3c003c00
.long 0x3bd93c00,0x3aa73b64,0xbbd9bc00,0xbaa7bb64,0xb23e8000,0xb872b61f,0x323e8000,0x3872361f
.long 0x3b643c00,0x361f39a8,0x3b643c00,0x361f39a8,0xb61f8000,0xbb64b9a8,0xb61f0000,0xbb64b9a8
.long 0x3aa73c00,0xb23e361f,0xbaa7bc00,0x323eb61f,0xb8728000,0xbbd9bb64,0x38728000,0x3bd93b64
.long 0x39a83c00,0xb9a80000,0x39a83c00,0xb9a80000,0xb9a88000,0xb9a8bc00,0xb9a80000,0xb9a8bc00
.long 0x38723c00,0xbbd9b61f,0xb872bc00,0x3bd9361f,0xbaa78000,0xb23ebb64,0x3aa78000,0x323e3b64
.long 0x361f3c00,0xbb64b9a8,0x361f3c00,0xbb64b9a8,0xbb648000,0x361fb9a8,0xbb640000,0x361fb9a8
.long 0x323e3c00,0xb872bb64,0xb23ebc00,0x38723b64,0xbbd98000,0x3aa7b61f,0x3bd98000,0xbaa7361f
.long 0x3c003c00,0x3c003c00,0x3c003c00,0x3c003c00,0x3c003c00,0x3c003c00,0x3c003c00,0x3c003c00
.long 0x387239a8,0x323e361f,0xb872b9a8,0xb23eb61f,0xbaa7b9a8,0xbbd9bb64,0x3aa739a8,0x3bd93b64
.long 0xb61f0000,0xbb64b9a8,0xb61f0000,0xbb64b9a8,0xbb64bc00,0xb61fb9a8,0xbb64bc00,0xb61fb9a8
.long 0xbbd9b9a8,0xb872bb64,0x3bd939a8,0x38723b64,0xb23eb9a8,0x3aa7361f,0x323e39a8,0xbaa7b61f
.long 0xb9a8bc00,0x39a88000,0xb9a8bc00,0x39a88000,0x39a88000,0x39a83c00,0x39a88000,0x39a83c00
.long 0x323eb9a8,0x3aa73b64,0xb23e39a8,0xbaa7bb64,0x3bd939a8,0xb872361f,0xbbd9b9a8,0x3872b61f
.long 0x3b648000,0xb61f39a8,0x3b648000,0xb61f39a8,0x361f3c00,0xbb64b9a8,0x361f3c00,0xbb64b9a8
.long 0x3aa739a8,0xbbd9b61f,0xbaa7b9a8,0x3bd9361f,0xb87239a8,0x323ebb64,0x3872b9a8,0xb23e3b64
.long 0x3c003c00,0x3c003c00,0x3c003c00,0x3c003c00,0x3c003c00,0x3c003c00,0x3c003c00,0x3c003c00
.long 0xb23e0000,0xb872b61f,0x323e8000,0x3872361f,0xbbd9bc00,0xbaa7bb64,0x3bd93c00,0x3aa73b64
.long 0xbb64bc00,0xb61fb9a8,0xbb64bc00,0xb61fb9a8,0x361f8000,0x3b6439a8,0x361f8000,0x3b6439a8
.long 0x38728000,0x3bd93b64,0xb8720000,0xbbd9bb64,0x3aa73c00,0xb23e361f,0xbaa7bc00,0x323eb61f
.long 0x39a83c00,0xb9a80000,0x39a83c00,0xb9a88000,0xb9a80000,0xb9a8bc00,0xb9a80000,0xb9a8bc00
.long 0xbaa70000,0xb23ebb64,0x3aa78000,0x323e3b64,0xb872bc00,0x3bd9361f,0x38723c00,0xbbd9b61f
.long 0xb61fbc00,0x3b6439a8,0xb61fbc00,0x3b6439a8,0x3b648000,0xb61f39a8,0x3b648000,0xb61f39a8
.long 0x3bd98000,0xbaa7361f,0xbbd98000,0x3aa7b61f,0x323e3c00,0xb872bb64,0xb23ebc00,0x38723b64
.long 0x3c003c00,0x3c003c00,0x3c003c00,0x3c003c00,0x3c003c00,0x3c003c00,0x3c003c00,0x3c003c00
.long 0xbaa7b9a8,0xbbd9bb64,0x3aa739a8,0x3bd93b64,0xb872b9a8,0xb23eb61f,0x387239a8,0x323e361f
.long 0x361f8000,0x3b6439a8,0x361f8000,0x3b6439a8,0x3b643c00,0x361f39a8,0x3b643c00,0x361f39a8
.long 0x323e39a8,0xbaa7b61f,0xb23eb9a8,0x3aa7361f,0xbbd9b9a8,0xb872bb64,0x3bd939a8,0x38723b64
.long 0xb9a8bc00,0x39a88000,0xb9a8bc00,0x39a88000,0x39a88000,0x39a83c00,0x39a88000,0x39a83c00
.long 0x3bd939a8,0xb872361f,0xbbd9b9a8,0x3872b61f,0xb23e39a8,0xbaa7bb64,0x323eb9a8,0x3aa73b64
.long 0xbb640000,0x361fb9a8,0xbb648000,0x361fb9a8,0xb61fbc00,0x3b6439a8,0xb61fbc00,0x3b6439a8
.long 0x3872b9a8,0xb23e3b64,0xb87239a8,0x323ebb64,0x3aa739a8,0xbbd9b61f,0xbaa7b9a8,0x3bd9361f
.long 0x3c003c00,0x3c003c00,0x3c003c00,0x3c003c00,0xbc00bc00,0xbc00bc00,0xbc00bc00,0xbc00bc00
.long 0x3ba83bf6,0x3a2f3b0e,0xbba8bbf6,0xba2fbb0e,0xb4a5ae46,0xb913b78b,0x34a52e46,0x3913378b
.long 0x3aa73bd9,0x323e3872,0x3aa73bd9,0x323e3872,0xb872b23e,0xbbd9baa7,0xb872b23e,0xbbd9baa7
.long 0x39133ba8,0xb78b2e46,0xb913bba8,0x378bae46,0xba2fb4a5,0xbb0ebbf6,0x3a2f34a5,0x3b0e3bf6
.long 0x361f3b64,0xbb64b61f,0x361f3b64,0xbb64b61f,0xbb64b61f,0xb61fbb64,0xbb64b61f,0xb61fbb64
.long 0x2e463b0e,0xbba8ba2f,0xae46bb0e,0x3ba83a2f,0xbbf6b78b,0x34a5b913,0x3bf6378b,0xb4a53913
.long 0xb23e3aa7,0xb872bbd9,0xb23e3aa7,0xb872bbd9,0xbbd9b872,0x3aa7b23e,0xbbd9b872,0x3aa7b23e
.long 0xb78b3a2f,0x2e46bba8,0x378bba2f,0xae463ba8,0xbb0eb913,0x3bf634a5,0x3b0e3913,0xbbf6b4a5
.long 0x3c003c00,0x3c003c00,0x3c003c00,0x3c003c00,0xbc00bc00,0xbc00bc00,0xbc00bc00,0xbc00bc00
.long 0x378b3913,0x2e4634a5,0xb78bb913,0xae46b4a5,0xbb0eba2f,0xbbf6bba8,0x3b0e3a2f,0x3bf63ba8
.long 0xb872b23e,0xbbd9baa7,0xb872b23e,0xbbd9baa7,0xbaa7bbd9,0xb23eb872,0xbaa7bbd9,0xb23eb872
.long 0xbbf6bb0e,0xb4a5ba2f,0x3bf63b0e,0x34a53a2f,0x2e46b78b,0x3ba83913,0xae46378b,0xbba8b913
.long 0xb61fbb64,0x3b64361f,0xb61fbb64,0x3b64361f,0x3b64361f,0x361f3b64,0x3b64361f,0x361f3b64
.long 0x3913b4a5,0x378b3bf6,0xb91334a5,0xb78bbbf6,0x3a2f3ba8,0xbb0eae46,0xba2fbba8,0x3b0e2e46
.long 0x3bd93872,0xbaa7323e,0x3bd93872,0xbaa7323e,0xb23e3aa7,0xb872bbd9,0xb23e3aa7,0xb872bbd9
.long 0x34a53bf6,0xb913bb0e,0xb4a5bbf6,0x39133b0e,0xbba82e46,0x3a2fb78b,0x3ba8ae46,0xba2f378b
.long 0x3c003c00,0x3c003c00,0x3c003c00,0x3c003c00,0xbc00bc00,0xbc00bc00,0xbc00bc00,0xbc00bc00
.long 0xb4a5ae46,0xb913b78b,0x34a52e46,0x3913378b,0xbba8bbf6,0xba2fbb0e,0x3ba83bf6,0x3a2f3b0e
.long 0xbaa7bbd9,0xb23eb872,0xbaa7bbd9,0xb23eb872,0x3872323e,0x3bd93aa7,0x3872323e,0x3bd93aa7
.long 0x3a2f34a5,0x3b0e3bf6,0xba2fb4a5,0xbb0ebbf6,0x39133ba8,0xb78b2e46,0xb913bba8,0x378bae46
.long 0x361f3b64,0xbb64b61f,0x361f3b64,0xbb64b61f,0xbb64b61f,0xb61fbb64,0xbb64b61f,0xb61fbb64
.long 0xbbf6b78b,0x34a5b913,0x3bf6378b,0xb4a53913,0xae46bb0e,0x3ba83a2f,0x2e463b0e,0xbba8ba2f
.long 0x323ebaa7,0x38723bd9,0x323ebaa7,0x38723bd9,0x3bd93872,0xbaa7323e,0x3bd93872,0xbaa7323e
.long 0x3b0e3913,0xbbf6b4a5,0xbb0eb913,0x3bf634a5,0xb78b3a2f,0x2e46bba8,0x378bba2f,0xae463ba8
.long 0x3c003c00,0x3c003c00,0x3c003c00,0x3c003c00,0xbc00bc00,0xbc00bc00,0xbc00bc00,0xbc00bc00
.long 0xbb0eba2f,0xbbf6bba8,0x3b0e3a2f,0x3bf63ba8,0xb78bb913,0xae46b4a5,0x378b3913,0x2e4634a5
.long 0x3872323e,0x3bd93aa7,0x3872323e,0x3bd93aa7,0x3aa73bd9,0x323e3872,0x3aa73bd9,0x323e3872
.long 0xae46378b,0xbba8b913,0x2e46b78b,0x3ba83913,0xbbf6bb0e,0xb4a5ba2f,0x3bf63b0e,0x34a53a2f
.long 0xb61fbb64,0x3b64361f,0xb61fbb64,0x3b64361f,0x3b64361f,0x361f3b64,0x3b64361f,0x361f3b64
.long 0x3a2f3ba8,0xbb0eae46,0xba2fbba8,0x3b0e2e46,0xb91334a5,0xb78bbbf6,0x3913b4a5,0x378b3bf6
.long 0xbbd9b872,0x3aa7b23e,0xbbd9b872,0x3aa7b23e,0x323ebaa7,0x38723bd9,0x323ebaa7,0x38723bd9
.long 0x3ba8ae46,0xba2f378b,0xbba82e46,0x3a2fb78b,0x34a53bf6,0xb913bb0e,0xb4a5bbf6,0x39133b0e
.long 0x3c00,0x8000bc00,0x80003c00,0x8000bc00,0xbc008000,0x3c008000,0xbc000000,0x3c008000
.long 0xb23e3c00,0x3872bb64,0x323ebc00,0xb8723b64,0xbbd98000,0x3aa7361f,0x3bd98000,0xbaa7b61f
.long 0xb61f3c00,0x3b64b9a8,0xb61f3c00,0x3b64b9a8,0xbb648000,0x361f39a8,0xbb640000,0x361f39a8
.long 0xb8723c00,0x3bd9b61f,0x3872bc00,0xbbd9361f,0xbaa78000,0xb23e3b64,0x3aa78000,0x323ebb64
.long 0xb9a83c00,0x39a88000,0xb9a83c00,0x39a88000,0xb9a88000,0xb9a83c00,0xb9a80000,0xb9a83c00
.long 0xbaa73c00,0x323e361f,0x3aa7bc00,0xb23eb61f,0xb8728000,0xbbd93b64,0x38720000,0x3bd9bb64
.long 0xbb643c00,0xb61f39a8,0xbb643c00,0xb61f39a8,0xb61f8000,0xbb6439a8,0xb61f0000,0xbb6439a8
.long 0xbbd93c00,0xbaa73b64,0x3bd9bc00,0x3aa7bb64,0xb23e8000,0xb872361f,0x323e8000,0x3872b61f
.long 0x3c00,0x8000bc00,0x80003c00,0x8000bc00,0xbc000000,0x3c008000,0xbc000000,0x3c008000
.long 0xbaa739a8,0x3bd9b61f,0x3aa7b9a8,0xbbd9361f,0xb872b9a8,0x323e3b64,0x387239a8,0xb23ebb64
.long 0xbb640000,0x361f39a8,0xbb648000,0x361f39a8,0x361fbc00,0xbb6439a8,0x361fbc00,0xbb6439a8
.long 0xb23eb9a8,0xbaa73b64,0x323e39a8,0x3aa7bb64,0x3bd9b9a8,0xb872b61f,0xbbd939a8,0x3872361f
.long 0x39a8bc00,0xb9a80000,0x39a8bc00,0xb9a80000,0x39a88000,0x39a8bc00,0x39a88000,0x39a8bc00
.long 0x3bd9b9a8,0x3872bb64,0xbbd939a8,0xb8723b64,0xb23e39a8,0x3aa7b61f,0x323eb9a8,0xbaa7361f
.long 0x361f8000,0x3b64b9a8,0x361f8000,0x3b64b9a8,0xbb643c00,0xb61f39a8,0xbb643c00,0xb61f39a8
.long 0xb87239a8,0xb23e361f,0x3872b9a8,0x323eb61f,0xbaa739a8,0xbbd93b64,0x3aa7b9a8,0x3bd9bb64
.long 0x3c00,0x8000bc00,0x80003c00,0x8000bc00,0xbc000000,0x3c008000,0xbc000000,0x3c000000
.long 0xbbd90000,0x3aa7361f,0x3bd98000,0xbaa7b61f,0x323ebc00,0xb8723b64,0xb23e3c00,0x3872bb64
.long 0x361fbc00,0xbb6439a8,0x361fbc00,0xbb6439a8,0x3b648000,0xb61fb9a8,0x3b648000,0xb61fb9a8
.long 0x3aa78000,0x323ebb64,0xbaa70000,0xb23e3b64,0xb8723c00,0x3bd9b61f,0x3872bc00,0xbbd9361f
.long 0xb9a83c00,0x39a88000,0xb9a83c00,0x39a88000,0xb9a80000,0xb9a83c00,0xb9a80000,0xb9a83c00
.long 0xb8728000,0xbbd93b64,0x38720000,0x3bd9bb64,0x3aa7bc00,0xb23eb61f,0xbaa73c00,0x323e361f
.long 0x3b64bc00,0x361fb9a8,0x3b64bc00,0x361fb9a8,0x361f8000,0x3b64b9a8,0x361f0000,0x3b64b9a8
.long 0x323e8000,0x3872b61f,0xb23e0000,0xb872361f,0xbbd93c00,0xbaa73b64,0x3bd9bc00,0x3aa7bb64
.long 0x80003c00,0x8000bc00,0x80003c00,0x8000bc00,0xbc000000,0x3c008000,0xbc000000,0x3c008000
.long 0xb872b9a8,0x323e3b64,0x387239a8,0xb23ebb64,0x3aa7b9a8,0xbbd9361f,0xbaa739a8,0x3bd9b61f
.long 0x3b648000,0xb61fb9a8,0x3b648000,0xb61fb9a8,0xb61f3c00,0x3b64b9a8,0xb61f3c00,0x3b64b9a8
.long 0xbbd939a8,0x3872361f,0x3bd9b9a8,0xb872b61f,0xb23eb9a8,0xbaa73b64,0x323e39a8,0x3aa7bb64
.long 0x39a8bc00,0xb9a88000,0x39a8bc00,0xb9a80000,0x39a88000,0x39a8bc00,0x39a80000,0x39a8bc00
.long 0xb23e39a8,0x3aa7b61f,0x323eb9a8,0xbaa7361f,0xbbd939a8,0xb8723b64,0x3bd9b9a8,0x3872bb64
.long 0xb61f8000,0xbb6439a8,0xb61f0000,0xbb6439a8,0x3b64bc00,0x361fb9a8,0x3b64bc00,0x361fb9a8
.long 0x3aa7b9a8,0x3bd9bb64,0xbaa739a8,0xbbd93b64,0xb87239a8,0xb23e361f,0x3872b9a8,0x323eb61f
.long 0xb9a839a8,0x39a8b9a8,0xb9a839a8,0x39a8b9a8,0xb9a8b9a8,0x39a839a8,0xb9a8b9a8,0x39a839a8
.long 0xbb0e3913,0x3bf6b4a5,0x3b0eb913,0xbbf634a5,0xb78bba2f,0x2e463ba8,0x378b3a2f,0xae46bba8
.long 0xbbd93872,0x3aa7323e,0xbbd93872,0x3aa7323e,0xb23ebaa7,0xb8723bd9,0xb23ebaa7,0xb8723bd9
.long 0xbbf6378b,0x34a53913,0x3bf6b78b,0xb4a5b913,0x2e46bb0e,0xbba83a2f,0xae463b0e,0x3ba8ba2f
.long 0xbb64361f,0xb61f3b64,0xbb64361f,0xb61f3b64,0x361fbb64,0xbb64361f,0x361fbb64,0xbb64361f
.long 0xba2f34a5,0xbb0e3bf6,0x3a2fb4a5,0x3b0ebbf6,0x3913bba8,0xb78bae46,0xb9133ba8,0x378b2e46
.long 0xb872323e,0xbbd93aa7,0xb872323e,0xbbd93aa7,0x3aa7bbd9,0x323eb872,0x3aa7bbd9,0x323eb872
.long 0xb4a52e46,0xb913378b,0x34a5ae46,0x3913b78b,0x3ba8bbf6,0x3a2fbb0e,0xbba83bf6,0xba2f3b0e
.long 0xb9a839a8,0x39a8b9a8,0xb9a839a8,0x39a8b9a8,0xb9a8b9a8,0x39a839a8,0xb9a8b9a8,0x39a839a8
.long 0xbba8ae46,0x3a2f378b,0x3ba82e46,0xba2fb78b,0x34a5bbf6,0xb9133b0e,0xb4a53bf6,0x3913bb0e
.long 0xb23ebaa7,0xb8723bd9,0xb23ebaa7,0xb8723bd9,0x3bd9b872,0xbaa7b23e,0x3bd9b872,0xbaa7b23e
.long 0x3a2fbba8,0xbb0e2e46,0xba2f3ba8,0x3b0eae46,0x391334a5,0x378bbbf6,0xb913b4a5,0xb78b3bf6
.long 0x3b64b61f,0x361fbb64,0x3b64b61f,0x361fbb64,0xb61f3b64,0x3b64b61f,0xb61f3b64,0x3b64b61f
.long 0x2e46378b,0x3ba8b913,0xae46b78b,0xbba83913,0xbbf63b0e,0xb4a53a2f,0x3bf6bb0e,0x34a5ba2f
.long 0xbaa73bd9,0xb23e3872,0xbaa73bd9,0xb23e3872,0xb872323e,0xbbd93aa7,0xb872323e,0xbbd93aa7
.long 0xbb0e3a2f,0xbbf63ba8,0x3b0eba2f,0x3bf6bba8,0x378bb913,0x2e46b4a5,0xb78b3913,0xae4634a5
.long 0xb9a839a8,0x39a8b9a8,0xb9a839a8,0x39a8b9a8,0xb9a8b9a8,0x39a839a8,0xb9a8b9a8,0x39a839a8
.long 0xb78bba2f,0x2e463ba8,0x378b3a2f,0xae46bba8,0x3b0eb913,0xbbf634a5,0xbb0e3913,0x3bf6b4a5
.long 0x3bd9b872,0xbaa7b23e,0x3bd9b872,0xbaa7b23e,0x323e3aa7,0x3872bbd9,0x323e3aa7,0x3872bbd9
.long 0xae463b0e,0x3ba8ba2f,0x2e46bb0e,0xbba83a2f,0xbbf6378b,0x34a53913,0x3bf6b78b,0xb4a5b913
.long 0xbb64361f,0xb61f3b64,0xbb64361f,0xb61f3b64,0x361fbb64,0xbb64361f,0x361fbb64,0xbb64361f
.long 0x3913bba8,0xb78bae46,0xb9133ba8,0x378b2e46,0x3a2fb4a5,0x3b0ebbf6,0xba2f34a5,0xbb0e3bf6
.long 0x3872b23e,0x3bd9baa7,0x3872b23e,0x3bd9baa7,0xbaa73bd9,0xb23e3872,0xbaa73bd9,0xb23e3872
.long 0xbba83bf6,0xba2f3b0e,0x3ba8bbf6,0x3a2fbb0e,0xb4a52e46,0xb913378b,0x34a5ae46,0x3913b78b
.long 0xb9a839a8,0x39a8b9a8,0xb9a839a8,0x39a8b9a8,0xb9a8b9a8,0x39a839a8,0xb9a8b9a8,0x39a839a8
.long 0x34a5bbf6,0xb9133b0e,0xb4a53bf6,0x3913bb0e,0x3ba82e46,0xba2fb78b,0xbba8ae46,0x3a2f378b
.long 0x323e3aa7,0x3872bbd9,0x323e3aa7,0x3872bbd9,0xbbd93872,0x3aa7323e,0xbbd93872,0x3aa7323e
.long 0xb913b4a5,0xb78b3bf6,0x391334a5,0x378bbbf6,0x3a2fbba8,0xbb0e2e46,0xba2f3ba8,0x3b0eae46
.long 0x3b64b61f,0x361fbb64,0x3b64b61f,0x361fbb64,0xb61f3b64,0x3b64b61f,0xb61f3b64,0x3b64b61f
.long 0xbbf63b0e,0xb4a53a2f,0x3bf6bb0e,0x34a5ba2f,0xae46b78b,0xbba83913,0x2e46378b,0x3ba8b913
.long 0x3aa7bbd9,0x323eb872,0x3aa7bbd9,0x323eb872,0x3872b23e,0x3bd9baa7,0x3872b23e,0x3bd9baa7
.long 0xb78b3913,0xae4634a5,0x378bb913,0x2e46b4a5,0xbb0e3a2f,0xbbf63ba8,0x3b0eba2f,0x3bf6bba8
.long 0xbc003c00,0xbc003c00,0xbc003c00,0xbc003c00,0x80008000,0x80000000,0x0,0x80000000
.long 0xbbd93c00,0xbaa73b64,0x3bd9bc00,0x3aa7bb64,0x323e8000,0x3872b61f,0xb23e0000,0xb872361f
.long 0xbb643c00,0xb61f39a8,0xbb643c00,0xb61f39a8,0x361f8000,0x3b64b9a8,0x361f0000,0x3b64b9a8
.long 0xbaa73c00,0x323e361f,0x3aa7bc00,0xb23eb61f,0x38728000,0x3bd9bb64,0xb8728000,0xbbd93b64
.long 0xb9a83c00,0x39a80000,0xb9a83c00,0x39a80000,0x39a88000,0x39a8bc00,0x39a80000,0x39a8bc00
.long 0xb8723c00,0x3bd9b61f,0x3872bc00,0xbbd9361f,0x3aa78000,0x323ebb64,0xbaa70000,0xb23e3b64
.long 0xb61f3c00,0x3b64b9a8,0xb61f3c00,0x3b64b9a8,0x3b648000,0xb61fb9a8,0x3b640000,0xb61fb9a8
.long 0xb23e3c00,0x3872bb64,0x323ebc00,0xb8723b64,0x3bd98000,0xbaa7b61f,0xbbd98000,0x3aa7361f
.long 0xbc003c00,0xbc003c00,0xbc003c00,0xbc003c00,0x80000000,0x80000000,0x0,0x80000000
.long 0xb87239a8,0xb23e361f,0x3872b9a8,0x323eb61f,0x3aa7b9a8,0x3bd9bb64,0xbaa739a8,0xbbd93b64
.long 0x361f0000,0x3b64b9a8,0x361f0000,0x3b64b9a8,0x3b64bc00,0x361fb9a8,0x3b64bc00,0x361fb9a8
.long 0x3bd9b9a8,0x3872bb64,0xbbd939a8,0xb8723b64,0x323eb9a8,0xbaa7361f,0xb23e39a8,0x3aa7b61f
.long 0x39a8bc00,0xb9a88000,0x39a8bc00,0xb9a80000,0xb9a88000,0xb9a83c00,0xb9a80000,0xb9a83c00
.long 0xb23eb9a8,0xbaa73b64,0x323e39a8,0x3aa7bb64,0xbbd939a8,0x3872361f,0x3bd9b9a8,0xb872b61f
.long 0xbb648000,0x361f39a8,0xbb648000,0x361f39a8,0xb61f3c00,0x3b64b9a8,0xb61f3c00,0x3b64b9a8
.long 0xbaa739a8,0x3bd9b61f,0x3aa7b9a8,0xbbd9361f,0x387239a8,0xb23ebb64,0xb872b9a8,0x323e3b64
.long 0xbc003c00,0xbc003c00,0xbc003c00,0xbc003c00,0x80000000,0x80000000,0x0,0x80008000
.long 0x323e8000,0x3872b61f,0xb23e0000,0xb872361f,0x3bd9bc00,0x3aa7bb64,0xbbd93c00,0xbaa73b64
.long 0x3b64bc00,0x361fb9a8,0x3b64bc00,0x361fb9a8,0xb61f8000,0xbb6439a8,0xb61f8000,0xbb6439a8
.long 0xb8728000,0xbbd93b64,0x38720000,0x3bd9bb64,0xbaa73c00,0x323e361f,0x3aa7bc00,0xb23eb61f
.long 0xb9a83c00,0x39a88000,0xb9a83c00,0x39a80000,0x39a80000,0x39a8bc00,0x39a80000,0x39a8bc00
.long 0x3aa78000,0x323ebb64,0xbaa70000,0xb23e3b64,0x3872bc00,0xbbd9361f,0xb8723c00,0x3bd9b61f
.long 0x361fbc00,0xbb6439a8,0x361fbc00,0xbb6439a8,0xbb648000,0x361f39a8,0xbb648000,0x361f39a8
.long 0xbbd98000,0x3aa7361f,0x3bd90000,0xbaa7b61f,0xb23e3c00,0x3872bb64,0x323ebc00,0xb8723b64
.long 0xbc003c00,0xbc003c00,0xbc003c00,0xbc003c00,0x0,0x80000000,0x0,0x80000000
.long 0x3aa7b9a8,0x3bd9bb64,0xbaa739a8,0xbbd93b64,0x3872b9a8,0x323eb61f,0xb87239a8,0xb23e361f
.long 0xb61f8000,0xbb6439a8,0xb61f0000,0xbb6439a8,0xbb643c00,0xb61f39a8,0xbb643c00,0xb61f39a8
.long 0xb23e39a8,0x3aa7b61f,0x323eb9a8,0xbaa7361f,0x3bd9b9a8,0x3872bb64,0xbbd939a8,0xb8723b64
.long 0x39a8bc00,0xb9a88000,0x39a8bc00,0xb9a88000,0xb9a88000,0xb9a83c00,0xb9a88000,0xb9a83c00
.long 0xbbd939a8,0x3872361f,0x3bd9b9a8,0xb872b61f,0x323e39a8,0x3aa7bb64,0xb23eb9a8,0xbaa73b64
.long 0x3b640000,0xb61fb9a8,0x3b640000,0xb61fb9a8,0x361fbc00,0xbb6439a8,0x361fbc00,0xbb6439a8
.long 0xb872b9a8,0x323e3b64,0x387239a8,0xb23ebb64,0xbaa739a8,0x3bd9b61f,0x3aa7b9a8,0xbbd9361f
.long 0x80000000,0x80000000,0x80000000,0x80000000,0x3c00bc00,0x3c00bc00,0x3c00bc00,0x3c00bc00
.long 0x34a5ae46,0x3913b78b,0xb4a52e46,0xb913378b,0x3ba8bbf6,0x3a2fbb0e,0xbba83bf6,0xba2f3b0e
.long 0x3872b23e,0x3bd9baa7,0x3872b23e,0x3bd9baa7,0x3aa7bbd9,0x323eb872,0x3aa7bbd9,0x323eb872
.long 0x3a2fb4a5,0x3b0ebbf6,0xba2f34a5,0xbb0e3bf6,0x3913bba8,0xb78bae46,0xb9133ba8,0x378b2e46
.long 0x3b64b61f,0x361fbb64,0x3b64b61f,0x361fbb64,0x361fbb64,0xbb64361f,0x361fbb64,0xbb64361f
.long 0x3bf6b78b,0xb4a5b913,0xbbf6378b,0x34a53913,0x2e46bb0e,0xbba83a2f,0xae463b0e,0x3ba8ba2f
.long 0x3bd9b872,0xbaa7b23e,0x3bd9b872,0xbaa7b23e,0xb23ebaa7,0xb8723bd9,0xb23ebaa7,0xb8723bd9
.long 0x3b0eb913,0xbbf634a5,0xbb0e3913,0x3bf6b4a5,0xb78bba2f,0x2e463ba8,0x378b3a2f,0xae46bba8
.long 0x80000000,0x80008000,0x80000000,0x0,0x3c00bc00,0x3c00bc00,0x3c00bc00,0x3c00bc00
.long 0x3b0eba2f,0x3bf6bba8,0xbb0e3a2f,0xbbf63ba8,0x378bb913,0x2e46b4a5,0xb78b3913,0xae4634a5
.long 0x3aa7bbd9,0x323eb872,0x3aa7bbd9,0x323eb872,0xb872323e,0xbbd93aa7,0xb872323e,0xbbd93aa7
.long 0xae46b78b,0xbba83913,0x2e46378b,0x3ba8b913,0xbbf63b0e,0xb4a53a2f,0x3bf6bb0e,0x34a5ba2f
.long 0xbb64361f,0xb61f3b64,0xbb64361f,0xb61f3b64,0xb61f3b64,0x3b64b61f,0xb61f3b64,0x3b64b61f
.long 0xba2f3ba8,0x3b0eae46,0x3a2fbba8,0xbb0e2e46,0x391334a5,0x378bbbf6,0xb913b4a5,0xb78b3bf6
.long 0x323e3aa7,0x3872bbd9,0x323e3aa7,0x3872bbd9,0x3bd9b872,0xbaa7b23e,0x3bd9b872,0xbaa7b23e
.long 0x3ba82e46,0xba2fb78b,0xbba8ae46,0x3a2f378b,0x34a5bbf6,0xb9133b0e,0xb4a53bf6,0x3913bb0e
.long 0x80008000,0x80008000,0x80000000,0x0,0x3c00bc00,0x3c00bc00,0x3c00bc00,0x3c00bc00
.long 0x3ba8bbf6,0x3a2fbb0e,0xbba83bf6,0xba2f3b0e,0xb4a52e46,0xb913378b,0x34a5ae46,0x3913b78b
.long 0xb872323e,0xbbd93aa7,0xb872323e,0xbbd93aa7,0xbaa73bd9,0xb23e3872,0xbaa73bd9,0xb23e3872
.long 0xb9133ba8,0x378b2e46,0x3913bba8,0xb78bae46,0x3a2fb4a5,0x3b0ebbf6,0xba2f34a5,0xbb0e3bf6
.long 0x3b64b61f,0x361fbb64,0x3b64b61f,0x361fbb64,0x361fbb64,0xbb64361f,0x361fbb64,0xbb64361f
.long 0x2e46bb0e,0xbba83a2f,0xae463b0e,0x3ba8ba2f,0xbbf6378b,0x34a53913,0x3bf6b78b,0xb4a5b913
.long 0xbbd93872,0x3aa7323e,0xbbd93872,0x3aa7323e,0x323e3aa7,0x3872bbd9,0x323e3aa7,0x3872bbd9
.long 0x378b3a2f,0xae46bba8,0xb78bba2f,0x2e463ba8,0x3b0eb913,0xbbf634a5,0xbb0e3913,0x3bf6b4a5
.long 0x80008000,0x80008000,0x80000000,0x0,0x3c00bc00,0x3c00bc00,0x3c00bc00,0x3c00bc00
.long 0x378bb913,0x2e46b4a5,0xb78b3913,0xae4634a5,0xbb0e3a2f,0xbbf63ba8,0x3b0eba2f,0x3bf6bba8
.long 0xbaa73bd9,0xb23e3872,0xbaa73bd9,0xb23e3872,0x3872b23e,0x3bd9baa7,0x3872b23e,0x3bd9baa7
.long 0x3bf6bb0e,0x34a5ba2f,0xbbf63b0e,0xb4a53a2f,0xae46b78b,0xbba83913,0x2e46378b,0x3ba8b913
.long 0xbb64361f,0xb61f3b64,0xbb64361f,0xb61f3b64,0xb61f3b64,0x3b64b61f,0xb61f3b64,0x3b64b61f
.long 0x391334a5,0x378bbbf6,0xb913b4a5,0xb78b3bf6,0x3a2fbba8,0xbb0e2e46,0xba2f3ba8,0x3b0eae46
.long 0xb23ebaa7,0xb8723bd9,0xb23ebaa7,0xb8723bd9,0xbbd93872,0x3aa7323e,0xbbd93872,0x3aa7323e
.long 0xb4a53bf6,0x3913bb0e,0x34a5bbf6,0xb9133b0e,0x3ba82e46,0xba2fb78b,0xbba8ae46,0x3a2f378b
.long 0x80003c00,0xbc00,0x80003c00,0xbc00,0x3c008000,0xbc008000,0x3c000000,0xbc008000
.long 0x323e3c00,0xb872bb64,0xb23ebc00,0x38723b64,0x3bd98000,0xbaa7361f,0xbbd90000,0x3aa7b61f
.long 0x361f3c00,0xbb64b9a8,0x361f3c00,0xbb64b9a8,0x3b648000,0xb61f39a8,0x3b648000,0xb61f39a8
.long 0x38723c00,0xbbd9b61f,0xb872bc00,0x3bd9361f,0x3aa78000,0x323e3b64,0xbaa78000,0xb23ebb64
.long 0x39a83c00,0xb9a88000,0x39a83c00,0xb9a80000,0x39a88000,0x39a83c00,0x39a80000,0x39a83c00
.long 0x3aa73c00,0xb23e361f,0xbaa7bc00,0x323eb61f,0x38728000,0x3bd93b64,0xb8720000,0xbbd9bb64
.long 0x3b643c00,0x361f39a8,0x3b643c00,0x361f39a8,0x361f8000,0x3b6439a8,0x361f0000,0x3b6439a8
.long 0x3bd93c00,0x3aa73b64,0xbbd9bc00,0xbaa7bb64,0x323e8000,0x3872361f,0xb23e8000,0xb872b61f
.long 0x80003c00,0x8000bc00,0x3c00,0xbc00,0x3c000000,0xbc008000,0x3c000000,0xbc008000
.long 0x3aa739a8,0xbbd9b61f,0xbaa7b9a8,0x3bd9361f,0x3872b9a8,0xb23e3b64,0xb87239a8,0x323ebb64
.long 0x3b648000,0xb61f39a8,0x3b648000,0xb61f39a8,0xb61fbc00,0x3b6439a8,0xb61fbc00,0x3b6439a8
.long 0x323eb9a8,0x3aa73b64,0xb23e39a8,0xbaa7bb64,0xbbd9b9a8,0x3872b61f,0x3bd939a8,0xb872361f
.long 0xb9a8bc00,0x39a88000,0xb9a8bc00,0x39a80000,0xb9a88000,0xb9a8bc00,0xb9a88000,0xb9a8bc00
.long 0xbbd9b9a8,0xb872bb64,0x3bd939a8,0x38723b64,0x323e39a8,0xbaa7b61f,0xb23eb9a8,0x3aa7361f
.long 0xb61f8000,0xbb64b9a8,0xb61f8000,0xbb64b9a8,0x3b643c00,0x361f39a8,0x3b643c00,0x361f39a8
.long 0x387239a8,0x323e361f,0xb872b9a8,0xb23eb61f,0x3aa739a8,0x3bd93b64,0xbaa7b9a8,0xbbd9bb64
.long 0x80003c00,0xbc00,0x80003c00,0xbc00,0x3c000000,0xbc008000,0x3c000000,0xbc008000
.long 0x3bd98000,0xbaa7361f,0xbbd98000,0x3aa7b61f,0xb23ebc00,0x38723b64,0x323e3c00,0xb872bb64
.long 0xb61fbc00,0x3b6439a8,0xb61fbc00,0x3b6439a8,0xbb640000,0x361fb9a8,0xbb640000,0x361fb9a8
.long 0xbaa78000,0xb23ebb64,0x3aa70000,0x323e3b64,0x38723c00,0xbbd9b61f,0xb872bc00,0x3bd9361f
.long 0x39a83c00,0xb9a88000,0x39a83c00,0xb9a88000,0x39a80000,0x39a83c00,0x39a88000,0x39a83c00
.long 0x38728000,0x3bd93b64,0xb8728000,0xbbd9bb64,0xbaa7bc00,0x323eb61f,0x3aa73c00,0xb23e361f
.long 0xbb64bc00,0xb61fb9a8,0xbb64bc00,0xb61fb9a8,0xb61f8000,0xbb64b9a8,0xb61f8000,0xbb64b9a8
.long 0xb23e8000,0xb872b61f,0x323e0000,0x3872361f,0x3bd93c00,0x3aa73b64,0xbbd9bc00,0xbaa7bb64
.long 0x80003c00,0xbc00,0x80003c00,0xbc00,0x3c000000,0xbc000000,0x3c008000,0xbc008000
.long 0x3872b9a8,0xb23e3b64,0xb87239a8,0x323ebb64,0xbaa7b9a8,0x3bd9361f,0x3aa739a8,0xbbd9b61f
.long 0xbb640000,0x361fb9a8,0xbb640000,0x361fb9a8,0x361f3c00,0xbb64b9a8,0x361f3c00,0xbb64b9a8
.long 0x3bd939a8,0xb872361f,0xbbd9b9a8,0x3872b61f,0x323eb9a8,0x3aa73b64,0xb23e39a8,0xbaa7bb64
.long 0xb9a8bc00,0x39a80000,0xb9a8bc00,0x39a88000,0xb9a80000,0xb9a8bc00,0xb9a88000,0xb9a8bc00
.long 0x323e39a8,0xbaa7b61f,0xb23eb9a8,0x3aa7361f,0x3bd939a8,0x38723b64,0xbbd9b9a8,0xb872bb64
.long 0x361f0000,0x3b6439a8,0x361f0000,0x3b6439a8,0xbb64bc00,0xb61fb9a8,0xbb64bc00,0xb61fb9a8
.long 0xbaa7b9a8,0xbbd9bb64,0x3aa739a8,0x3bd93b64,0x387239a8,0x323e361f,0xb872b9a8,0xb23eb61f
.long 0x39a8b9a8,0xb9a839a8,0x39a8b9a8,0xb9a839a8,0xb9a8b9a8,0x39a839a8,0xb9a8b9a8,0x39a839a8
.long 0x378bba2f,0xae463ba8,0xb78b3a2f,0x2e46bba8,0xbb0eb913,0x3bf634a5,0x3b0e3913,0xbbf6b4a5
.long 0x323ebaa7,0x38723bd9,0x323ebaa7,0x38723bd9,0xbbd9b872,0x3aa7b23e,0xbbd9b872,0x3aa7b23e
.long 0xae46bb0e,0x3ba83a2f,0x2e463b0e,0xbba8ba2f,0xbbf6b78b,0x34a5b913,0x3bf6378b,0xb4a53913
.long 0xb61fbb64,0x3b64361f,0xb61fbb64,0x3b64361f,0xbb64b61f,0xb61fbb64,0xbb64b61f,0xb61fbb64
.long 0xb913bba8,0x378bae46,0x39133ba8,0xb78b2e46,0xba2fb4a5,0xbb0ebbf6,0x3a2f34a5,0x3b0e3bf6
.long 0xbaa7bbd9,0xb23eb872,0xbaa7bbd9,0xb23eb872,0xb872b23e,0xbbd9baa7,0xb872b23e,0xbbd9baa7
.long 0xbba8bbf6,0xba2fbb0e,0x3ba83bf6,0x3a2f3b0e,0xb4a5ae46,0xb913b78b,0x34a52e46,0x3913378b
.long 0x39a8b9a8,0xb9a839a8,0x39a8b9a8,0xb9a839a8,0xb9a8b9a8,0x39a839a8,0xb9a8b9a8,0x39a839a8
.long 0xb4a5bbf6,0x39133b0e,0x34a53bf6,0xb913bb0e,0xbba82e46,0x3a2fb78b,0x3ba8ae46,0xba2f378b
.long 0xbbd9b872,0x3aa7b23e,0xbbd9b872,0x3aa7b23e,0xb23e3aa7,0xb872bbd9,0xb23e3aa7,0xb872bbd9
.long 0xb91334a5,0xb78bbbf6,0x3913b4a5,0x378b3bf6,0x3a2f3ba8,0xbb0eae46,0xba2fbba8,0x3b0e2e46
.long 0x361f3b64,0xbb64b61f,0x361f3b64,0xbb64b61f,0x3b64361f,0x361f3b64,0x3b64361f,0x361f3b64
.long 0x3bf63b0e,0x34a53a2f,0xbbf6bb0e,0xb4a5ba2f,0x2e46b78b,0x3ba83913,0xae46378b,0xbba8b913
.long 0x3872323e,0x3bd93aa7,0x3872323e,0x3bd93aa7,0xbaa7bbd9,0xb23eb872,0xbaa7bbd9,0xb23eb872
.long 0xb78bb913,0xae46b4a5,0x378b3913,0x2e4634a5,0xbb0eba2f,0xbbf6bba8,0x3b0e3a2f,0x3bf63ba8
.long 0x39a8b9a8,0xb9a839a8,0x39a8b9a8,0xb9a839a8,0xb9a8b9a8,0x39a839a8,0xb9a8b9a8,0x39a839a8
.long 0xbb0eb913,0x3bf634a5,0x3b0e3913,0xbbf6b4a5,0xb78b3a2f,0x2e46bba8,0x378bba2f,0xae463ba8
.long 0xb23e3aa7,0xb872bbd9,0xb23e3aa7,0xb872bbd9,0x3bd93872,0xbaa7323e,0x3bd93872,0xbaa7323e
.long 0x3bf6378b,0xb4a53913,0xbbf6b78b,0x34a5b913,0xae46bb0e,0x3ba83a2f,0x2e463b0e,0xbba8ba2f
.long 0xb61fbb64,0x3b64361f,0xb61fbb64,0x3b64361f,0xbb64b61f,0xb61fbb64,0xbb64b61f,0xb61fbb64
.long 0xba2fb4a5,0xbb0ebbf6,0x3a2f34a5,0x3b0e3bf6,0x39133ba8,0xb78b2e46,0xb913bba8,0x378bae46
.long 0x3aa73bd9,0x323e3872,0x3aa73bd9,0x323e3872,0x3872323e,0x3bd93aa7,0x3872323e,0x3bd93aa7
.long 0x34a52e46,0x3913378b,0xb4a5ae46,0xb913b78b,0xbba8bbf6,0xba2fbb0e,0x3ba83bf6,0x3a2f3b0e
.long 0x39a8b9a8,0xb9a839a8,0x39a8b9a8,0xb9a839a8,0xb9a8b9a8,0x39a839a8,0xb9a8b9a8,0x39a839a8
.long 0xbba82e46,0x3a2fb78b,0x3ba8ae46,0xba2f378b,0x34a53bf6,0xb913bb0e,0xb4a5bbf6,0x39133b0e
.long 0x3bd93872,0xbaa7323e,0x3bd93872,0xbaa7323e,0x323ebaa7,0x38723bd9,0x323ebaa7,0x38723bd9
.long 0xba2fbba8,0x3b0e2e46,0x3a2f3ba8,0xbb0eae46,0xb91334a5,0xb78bbbf6,0x3913b4a5,0x378b3bf6
.long 0x361f3b64,0xbb64b61f,0x361f3b64,0xbb64b61f,0x3b64361f,0x361f3b64,0x3b64361f,0x361f3b64
.long 0x2e46b78b,0x3ba83913,0xae46378b,0xbba8b913,0xbbf6bb0e,0xb4a5ba2f,0x3bf63b0e,0x34a53a2f
.long 0xb872b23e,0xbbd9baa7,0xb872b23e,0xbbd9baa7,0x3aa73bd9,0x323e3872,0x3aa73bd9,0x323e3872
.long 0x3b0e3a2f,0x3bf63ba8,0xbb0eba2f,0xbbf6bba8,0xb78bb913,0xae46b4a5,0x378b3913,0x2e4634a5
.long 0x3c003c00,0x3c003c00,0x0,0x0,0x80008000,0x80008000,0x3c003c00,0x3c003c00
.long 0x3c00,0x8000bc00,0x3c000000,0xbc000000,0xbc008000,0x3c008000,0x3c00,0x8000bc00
.long 0xbc003c00,0xbc003c00,0x0,0x8000,0x80008000,0x80000000,0xbc003c00,0xbc003c00
.long 0x80003c00,0xbc00,0xbc000000,0x3c000000,0x3c008000,0xbc008000,0x80003c00,0xbc00
.long 0x3c003c00,0x3c003c00,0x80000000,0x80008000,0x8000,0x0,0x3c003c00,0x3c003c00
.long 0x3c00,0x8000bc00,0x3c000000,0xbc000000,0xbc008000,0x3c008000,0x3c00,0x8000bc00
.long 0xbc003c00,0xbc003c00,0x0,0x8000,0x80008000,0x80000000,0xbc003c00,0xbc003c00
.long 0x80003c00,0x8000bc00,0xbc000000,0x3c000000,0x3c008000,0xbc008000,0x80003c00,0x8000bc00
.long 0x3c003c00,0x3c003c00,0x0,0x0,0x80008000,0x80008000,0x3c003c00,0x3c003c00
.long 0xb61f3b64,0x361fbb64,0x3b64361f,0xbb64b61f,0xbb64b61f,0x3b64361f,0xb61f3b64,0x361fbb64
.long 0xb9a839a8,0xb9a839a8,0xb9a839a8,0xb9a839a8,0x39a8b9a8,0x39a8b9a8,0xb9a839a8,0xb9a839a8
.long 0x3b64361f,0xbb64b61f,0xb61f3b64,0x361fbb64,0x361fbb64,0xb61f3b64,0x3b64361f,0xbb64b61f
.long 0x0,0x80000000,0x3c003c00,0x3c003c00,0xbc00bc00,0xbc00bc00,0x0,0x80000000
.long 0xbb64b61f,0x3b64361f,0xb61f3b64,0x361fbb64,0x361fbb64,0xb61f3b64,0xbb64b61f,0x3b64361f
.long 0x39a8b9a8,0x39a8b9a8,0xb9a839a8,0xb9a839a8,0x39a8b9a8,0x39a8b9a8,0x39a8b9a8,0x39a8b9a8
.long 0x361fbb64,0xb61f3b64,0x3b64361f,0xbb64b61f,0xbb64b61f,0x3b64361f,0x361fbb64,0xb61f3b64
.long 0x3c003c00,0x3c003c00,0x0,0x0,0x80008000,0x80008000,0x3c003c00,0x3c003c00
.long 0xb9a839a8,0x39a8b9a8,0x39a839a8,0xb9a8b9a8,0xb9a8b9a8,0x39a839a8,0xb9a839a8,0x39a8b9a8
.long 0x80000000,0x80000000,0xbc003c00,0xbc003c00,0x3c00bc00,0x3c00bc00,0x80000000,0x80000000
.long 0x39a8b9a8,0xb9a839a8,0x39a839a8,0xb9a8b9a8,0xb9a8b9a8,0x39a839a8,0x39a8b9a8,0xb9a839a8
.long 0xbc00bc00,0xbc00bc00,0x0,0x0,0x80008000,0x80008000,0xbc00bc00,0xbc00bc00
.long 0x39a8b9a8,0xb9a839a8,0xb9a8b9a8,0x39a839a8,0x39a839a8,0xb9a8b9a8,0x39a8b9a8,0xb9a839a8
.long 0x8000,0x80008000,0x3c00bc00,0x3c00bc00,0xbc003c00,0xbc003c00,0x8000,0x80008000
.long 0xb9a839a8,0x39a8b9a8,0xb9a8b9a8,0x39a839a8,0x39a839a8,0xb9a8b9a8,0xb9a839a8,0x39a8b9a8
.long 0x3c003c00,0x3c003c00,0x0,0x0,0x80008000,0x80008000,0x3c003c00,0x3c003c00
.long 0xbb64361f,0x3b64b61f,0x361f3b64,0xb61fbb64,0xb61fbb64,0x361f3b64,0xbb64361f,0x3b64b61f
.long 0x39a8b9a8,0x39a8b9a8,0xb9a839a8,0xb9a839a8,0x39a8b9a8,0x39a8b9a8,0x39a8b9a8,0x39a8b9a8
.long 0xb61fbb64,0x361f3b64,0x3b64b61f,0xbb64361f,0xbb64361f,0x3b64b61f,0xb61fbb64,0x361f3b64
.long 0x80008000,0x80008000,0xbc00bc00,0xbc00bc00,0x3c003c00,0x3c003c00,0x80008000,0x80008000
.long 0x361f3b64,0xb61fbb64,0x3b64b61f,0xbb64361f,0xbb64361f,0x3b64b61f,0x361f3b64,0xb61fbb64
.long 0xb9a839a8,0xb9a839a8,0xb9a839a8,0xb9a839a8,0x39a8b9a8,0x39a8b9a8,0xb9a839a8,0xb9a839a8
.long 0x3b64b61f,0xbb64361f,0x361f3b64,0xb61fbb64,0xb61fbb64,0x361f3b64,0x3b64b61f,0xbb64361f
.long 0x3c003c00,0x3c003c00,0x80000000,0x80008000,0x8000,0x0,0x3c003c00,0x3c003c00
.long 0x3c00,0x8000bc00,0x3c000000,0xbc000000,0xbc008000,0x3c008000,0x3c00,0x8000bc00
.long 0xbc003c00,0xbc003c00,0x0,0x8000,0x80008000,0x80000000,0xbc003c00,0xbc003c00
.long 0x80003c00,0xbc00,0xbc000000,0x3c000000,0x3c008000,0xbc008000,0x80003c00,0xbc00
.long 0x3c003c00,0x3c003c00,0x80000000,0x80008000,0x8000,0x0,0x3c003c00,0x3c003c00
.long 0x80003c00,0x8000bc00,0x3c000000,0xbc008000,0xbc008000,0x3c000000,0x80003c00,0x8000bc00
.long 0xbc003c00,0xbc003c00,0x0,0x80008000,0x80008000,0x0,0xbc003c00,0xbc003c00
.long 0x80003c00,0xbc00,0xbc000000,0x3c000000,0x3c008000,0xbc008000,0x80003c00,0xbc00
.long 0xbc00bc00,0xbc00bc00,0x0,0x80000000,0x80008000,0x8000,0xbc00bc00,0xbc00bc00
.long 0x361fbb64,0xb61f3b64,0xbb64b61f,0x3b64361f,0x3b64361f,0xbb64b61f,0x361fbb64,0xb61f3b64
.long 0x39a8b9a8,0x39a8b9a8,0x39a8b9a8,0x39a8b9a8,0xb9a839a8,0xb9a839a8,0x39a8b9a8,0x39a8b9a8
.long 0xbb64b61f,0x3b64361f,0x361fbb64,0xb61f3b64,0xb61f3b64,0x361fbb64,0xbb64b61f,0x3b64361f
.long 0x80008000,0x8000,0xbc00bc00,0xbc00bc00,0x3c003c00,0x3c003c00,0x80008000,0x8000
.long 0x3b64361f,0xbb64b61f,0x361fbb64,0xb61f3b64,0xb61f3b64,0x361fbb64,0x3b64361f,0xbb64b61f
.long 0xb9a839a8,0xb9a839a8,0x39a8b9a8,0x39a8b9a8,0xb9a839a8,0xb9a839a8,0xb9a839a8,0xb9a839a8
.long 0xb61f3b64,0x361fbb64,0xbb64b61f,0x3b64361f,0x3b64361f,0xbb64b61f,0xb61f3b64,0x361fbb64
.long 0x3c003c00,0x3c003c00,0x80008000,0x80008000,0x0,0x0,0x3c003c00,0x3c003c00
.long 0xb9a839a8,0x39a8b9a8,0x39a839a8,0xb9a8b9a8,0xb9a8b9a8,0x39a839a8,0xb9a839a8,0x39a8b9a8
.long 0x80000000,0x80008000,0xbc003c00,0xbc003c00,0x3c00bc00,0x3c00bc00,0x80000000,0x80008000
.long 0x39a8b9a8,0xb9a839a8,0x39a839a8,0xb9a8b9a8,0xb9a8b9a8,0x39a839a8,0x39a8b9a8,0xb9a839a8
.long 0xbc00bc00,0xbc00bc00,0x0,0x80000000,0x80008000,0x8000,0xbc00bc00,0xbc00bc00
.long 0x39a8b9a8,0xb9a839a8,0xb9a8b9a8,0x39a839a8,0x39a839a8,0xb9a8b9a8,0x39a8b9a8,0xb9a839a8
.long 0x80008000,0x8000,0x3c00bc00,0x3c00bc00,0xbc003c00,0xbc003c00,0x80008000,0x8000
.long 0xb9a839a8,0x39a8b9a8,0xb9a8b9a8,0x39a839a8,0x39a839a8,0xb9a8b9a8,0xb9a839a8,0x39a8b9a8
.long 0xbc00bc00,0xbc00bc00,0x0,0x0,0x80008000,0x80008000,0xbc00bc00,0xbc00bc00
.long 0x3b64b61f,0xbb64361f,0xb61fbb64,0x361f3b64,0x361f3b64,0xb61fbb64,0x3b64b61f,0xbb64361f
.long 0xb9a839a8,0xb9a839a8,0x39a8b9a8,0x39a8b9a8,0xb9a839a8,0xb9a839a8,0xb9a839a8,0xb9a839a8
.long 0x361f3b64,0xb61fbb64,0xbb64361f,0x3b64b61f,0x3b64b61f,0xbb64361f,0x361f3b64,0xb61fbb64
.long 0x80000000,0x0,0x3c003c00,0x3c003c00,0xbc00bc00,0xbc00bc00,0x80000000,0x0
.long 0xb61fbb64,0x361f3b64,0xbb64361f,0x3b64b61f,0x3b64b61f,0xbb64361f,0xb61fbb64,0x361f3b64
.long 0x39a8b9a8,0x39a8b9a8,0x39a8b9a8,0x39a8b9a8,0xb9a839a8,0xb9a839a8,0x39a8b9a8,0x39a8b9a8
.long 0xbb64361f,0x3b64b61f,0xb61fbb64,0x361f3b64,0x361f3b64,0xb61fbb64,0xbb64361f,0x3b64b61f
.long 0x3c00,0x3c00,0x3c00,0x3c00,0x3c00,0x34f23b9c,0x31023be7,0x37443b21
.long 0x3c00,0x38b43a79,0x34f23b9c,0x3a7938b4,0x3c00,0x3a7938b4,0x37443b21,0x3be73102
.long 0x3c00,0x3b9c34f2,0x38b43a79,0x3b9cb4f2,0x3c00,0x3c000000,0x39a839a8,0x39a8b9a8
.long 0x3c00,0x3b9cb4f2,0x3a7938b4,0x34f2bb9c,0x3c00,0x3a79b8b4,0x3b213744,0xb102bbe7
.long 0x3c00,0x38b4ba79,0x3b9c34f2,0xb8b4ba79,0x3c00,0x34f2bb9c,0x3be73102,0xbb21b744
.long 0x3c00,0xbc00,0x3c000000,0xbc008000,0x3c00,0xb4f2bb9c,0x3be7b102,0xbb213744
.long 0x3c00,0xb8b4ba79,0x3b9cb4f2,0xb8b43a79,0x3c00,0xba79b8b4,0x3b21b744,0xb1023be7
.long 0x3c00,0xbb9cb4f2,0x3a79b8b4,0x34f23b9c,0x3c00,0xbc008000,0x39a8b9a8,0x39a839a8
.long 0x3c00,0x3c00,0x3c00,0x3c00,0x38b43a79,0x3a7938b4,0x39a839a8,0x3b213744
.long 0x3b9c34f2,0x3b9cb4f2,0x3c000000,0x3a79b8b4,0x3b9cb4f2,0x34f2bb9c,0x39a8b9a8,0xb102bbe7
.long 0x38b4ba79,0xb8b4ba79,0xbc00,0xbb9cb4f2,0xbc00,0xbc008000,0xb9a8b9a8,0xb9a839a8
.long 0xb8b4ba79,0xb8b43a79,0xbc008000,0x34f23b9c,0xbb9cb4f2,0x34f23b9c,0xb9a839a8,0x3be73102
.long 0xbb9c34f2,0x3b9c34f2,0x80003c00,0x38b4ba79,0xb8b43a79,0x3a79b8b4,0x39a839a8,0xb744bb21
.long 0x80003c00,0xbc00,0x3c000000,0xbc008000,0x38b43a79,0xba79b8b4,0x39a8b9a8,0xb7443b21
.long 0x3b9c34f2,0xbb9c34f2,0xbc00,0x38b43a79,0x3b9cb4f2,0xb4f23b9c,0xb9a8b9a8,0x3be7b102
.long 0x38b4ba79,0x38b43a79,0xbc008000,0x34f2bb9c,0xbc00,0x3c000000,0xb9a839a8,0xb9a8b9a8
.long 0x3c00,0x3c00,0x3c00,0x3c00,0x3b9c34f2,0x3c000000,0x3be73102,0x3be7b102
.long 0x38b4ba79,0xbc00,0x34f2bb9c,0xb4f2bb9c,0xb8b4ba79,0xbc008000,0xbb21b744,0xbb213744
.long 0xbb9c34f2,0x80003c00,0xb8b43a79,0x38b43a79,0x80003c00,0x3c000000,0x39a839a8,0x39a8b9a8
.long 0x3b9c34f2,0xbc00,0x3a79b8b4,0xba79b8b4,0x38b4ba79,0xbc008000,0xb744bb21,0xb7443b21
.long 0xb8b4ba79,0x80003c00,0xbb9c34f2,0x3b9c34f2,0xbb9c34f2,0x3c000000,0x31023be7,0x3102bbe7
.long 0x80003c00,0xbc00,0x3c000000,0xbc008000,0x3b9c34f2,0xbc000000,0x3102bbe7,0x31023be7
.long 0x38b4ba79,0x80003c00,0xbb9cb4f2,0x3b9cb4f2,0xb8b4ba79,0x3c000000,0xb7443b21,0xb744bb21
.long 0xbb9c34f2,0xbc00,0x3a7938b4,0xba7938b4,0x80003c00,0xbc008000,0x39a8b9a8,0x39a839a8
.long 0x3c00,0x3c00,0x3c00,0x3c00,0x3b9cb4f2,0x3a79b8b4,0x3b21b744,0x39a8b9a8
.long 0xb8b4ba79,0xbb9cb4f2,0xba79b8b4,0xbc008000,0xb8b43a79,0x34f23b9c,0xb1023be7,0x39a839a8
.long 0x3b9c34f2,0x38b4ba79,0x3b9cb4f2,0xbc00,0xbc00,0xbc008000,0xb9a8b9a8,0xb9a839a8
.long 0xbb9c34f2,0x38b43a79,0xb4f23b9c,0x3c000000,0x38b43a79,0x34f2bb9c,0x3be7b102,0xb9a8b9a8
.long 0x38b4ba79,0xbb9c34f2,0xb8b4ba79,0x80003c00,0xbb9cb4f2,0x3a7938b4,0xb7443b21,0x39a8b9a8
.long 0x80003c00,0xbc00,0x3c008000,0xbc008000,0x3b9cb4f2,0xba7938b4,0xb744bb21,0x39a839a8
.long 0xb8b4ba79,0x3b9c34f2,0xb8b43a79,0xbc00,0xb8b43a79,0xb4f2bb9c,0x3be73102,0xb9a839a8
.long 0x3b9c34f2,0xb8b43a79,0xb4f2bb9c,0x3c000000,0xbc00,0x3c008000,0xb9a839a8,0xb9a8b9a8
.long 0x3c00,0x3c00,0x3c00,0x3c00,0x38b4ba79,0x34f2bb9c,0x3744bb21,0x3102bbe7
.long 0xbb9c34f2,0xb8b43a79,0xba7938b4,0xb4f23b9c,0x3b9c34f2,0x3a79b8b4,0x3be7b102,0x3744bb21
.long 0xb8b4ba79,0xbb9c34f2,0xbb9cb4f2,0xb8b43a79,0x80003c00,0x3c000000,0x39a839a8,0x39a8b9a8
.long 0x38b4ba79,0xbb9cb4f2,0xb4f2bb9c,0xba7938b4,0xbb9c34f2,0x3a7938b4,0xb1023be7,0x3b21b744
.long 0x3b9c34f2,0xb8b4ba79,0x38b4ba79,0xbb9c34f2,0xb8b4ba79,0x34f23b9c,0xbb213744,0x3be7b102
.long 0x80003c00,0xbc00,0x3c008000,0xbc000000,0x38b4ba79,0xb4f23b9c,0xbb21b744,0x3be73102
.long 0xbb9c34f2,0x38b4ba79,0x38b43a79,0xbb9cb4f2,0x3b9c34f2,0xba7938b4,0xb102bbe7,0x3b213744
.long 0xb8b4ba79,0x3b9cb4f2,0xb4f23b9c,0xba79b8b4,0x80003c00,0xbc008000,0x39a8b9a8,0x39a839a8
.long 0x3c00,0x3c00,0x3c00,0x3c00,0xbc00,0xb4f2bb9c,0xb102bbe7,0xb744bb21
.long 0x80003c00,0x38b43a79,0x34f23b9c,0x3a7938b4,0xbc00,0xba79b8b4,0xb744bb21,0xbbe7b102
.long 0x80003c00,0x3b9c34f2,0x38b43a79,0x3b9cb4f2,0xbc00,0xbc008000,0xb9a8b9a8,0xb9a839a8
.long 0x80003c00,0x3b9cb4f2,0x3a7938b4,0x34f2bb9c,0xbc00,0xba7938b4,0xbb21b744,0x31023be7
.long 0x80003c00,0x38b4ba79,0x3b9c34f2,0xb8b4ba79,0xbc00,0xb4f23b9c,0xbbe7b102,0x3b213744
.long 0x80003c00,0xbc00,0x3c008000,0xbc008000,0x8000bc00,0x34f23b9c,0xbbe73102,0x3b21b744
.long 0x80003c00,0xb8b4ba79,0x3b9cb4f2,0xb8b43a79,0xbc00,0x3a7938b4,0xbb213744,0x3102bbe7
.long 0x80003c00,0xbb9cb4f2,0x3a79b8b4,0x34f23b9c,0xbc00,0x3c000000,0xb9a839a8,0xb9a8b9a8
.long 0x3c00,0x3c00,0x3c00,0x3c00,0xb8b4ba79,0xba79b8b4,0xb9a8b9a8,0xbb21b744
.long 0x3b9c34f2,0x3b9cb4f2,0x3c000000,0x3a79b8b4,0xbb9c34f2,0xb4f23b9c,0xb9a839a8,0x31023be7
.long 0x38b4ba79,0xb8b4ba79,0xbc00,0xbb9cb4f2,0x80003c00,0x3c008000,0x39a839a8,0x39a8b9a8
.long 0xb8b4ba79,0xb8b43a79,0xbc008000,0x34f23b9c,0x3b9c34f2,0xb4f2bb9c,0x39a8b9a8,0xbbe7b102
.long 0xbb9c34f2,0x3b9c34f2,0x80003c00,0x38b4ba79,0x38b4ba79,0xba7938b4,0xb9a8b9a8,0x37443b21
.long 0x80003c00,0x8000bc00,0x3c008000,0xbc008000,0xb8b4ba79,0x3a7938b4,0xb9a839a8,0x3744bb21
.long 0x3b9c34f2,0xbb9c34f2,0xbc00,0x38b43a79,0xbb9c34f2,0x34f2bb9c,0x39a839a8,0xbbe73102
.long 0x38b4ba79,0x38b43a79,0xbc000000,0x34f2bb9c,0x80003c00,0xbc000000,0x39a8b9a8,0x39a839a8
.long 0x3c00,0x3c00,0x3c00,0x3c00,0xbb9cb4f2,0xbc008000,0xbbe7b102,0xbbe73102
.long 0x38b4ba79,0xbc00,0x34f2bb9c,0xb4f2bb9c,0x38b43a79,0x3c000000,0x3b213744,0x3b21b744
.long 0xbb9c34f2,0x80003c00,0xb8b43a79,0x38b43a79,0xbc00,0xbc008000,0xb9a8b9a8,0xb9a839a8
.long 0x3b9c34f2,0xbc00,0x3a79b8b4,0xba79b8b4,0xb8b43a79,0x3c000000,0x37443b21,0x3744bb21
.long 0xb8b4ba79,0x80003c00,0xbb9c34f2,0x3b9c34f2,0x3b9cb4f2,0xbc008000,0xb102bbe7,0xb1023be7
.long 0x80003c00,0xbc00,0x3c008000,0xbc008000,0xbb9cb4f2,0x3c000000,0xb1023be7,0xb102bbe7
.long 0x38b4ba79,0x80003c00,0xbb9cb4f2,0x3b9cb4f2,0x38b43a79,0xbc008000,0x3744bb21,0x37443b21
.long 0xbb9c34f2,0xbc00,0x3a7938b4,0xba7938b4,0x8000bc00,0x3c000000,0xb9a839a8,0xb9a8b9a8
.long 0x3c00,0x3c00,0x3c00,0x3c00,0xbb9c34f2,0xba7938b4,0xbb213744,0xb9a839a8
.long 0xb8b4ba79,0xbb9cb4f2,0xba79b8b4,0xbc008000,0x38b4ba79,0xb4f2bb9c,0x3102bbe7,0xb9a8b9a8
.long 0x3b9c34f2,0x38b4ba79,0x3b9cb4f2,0xbc00,0x80003c00,0x3c008000,0x39a839a8,0x39a8b9a8
.long 0xbb9c34f2,0x38b43a79,0xb4f23b9c,0x3c008000,0xb8b4ba79,0xb4f23b9c,0xbbe73102,0x39a839a8
.long 0x38b4ba79,0xbb9c34f2,0xb8b4ba79,0x80003c00,0x3b9c34f2,0xba79b8b4,0x3744bb21,0xb9a839a8
.long 0x80003c00,0x8000bc00,0x3c008000,0xbc008000,0xbb9c34f2,0x3a79b8b4,0x37443b21,0xb9a8b9a8
.long 0xb8b4ba79,0x3b9c34f2,0xb8b43a79,0x8000bc00,0x38b4ba79,0x34f23b9c,0xbbe7b102,0x39a8b9a8
.long 0x3b9c34f2,0xb8b43a79,0xb4f2bb9c,0x3c000000,0x80003c00,0xbc008000,0x39a8b9a8,0x39a839a8
.long 0x3c00,0x3c00,0x3c00,0x3c00,0xb8b43a79,0xb4f23b9c,0xb7443b21,0xb1023be7
.long 0xbb9c34f2,0xb8b43a79,0xba7938b4,0xb4f23b9c,0xbb9cb4f2,0xba7938b4,0xbbe73102,0xb7443b21
.long 0xb8b4ba79,0xbb9c34f2,0xbb9cb4f2,0xb8b43a79,0xbc00,0xbc000000,0xb9a8b9a8,0xb9a839a8
.long 0x38b4ba79,0xbb9cb4f2,0xb4f2bb9c,0xba7938b4,0x3b9cb4f2,0xba79b8b4,0x3102bbe7,0xbb213744
.long 0x3b9c34f2,0xb8b4ba79,0x38b4ba79,0xbb9c34f2,0x38b43a79,0xb4f2bb9c,0x3b21b744,0xbbe73102
.long 0x80003c00,0x8000bc00,0x3c000000,0xbc008000,0xb8b43a79,0x34f2bb9c,0x3b213744,0xbbe7b102
.long 0xbb9c34f2,0x38b4ba79,0x38b43a79,0xbb9cb4f2,0xbb9cb4f2,0x3a79b8b4,0x31023be7,0xbb21b744
.long 0xb8b4ba79,0x3b9cb4f2,0xb4f23b9c,0xba79b8b4,0xbc00,0x3c000000,0xb9a839a8,0xb9a8b9a8
.long 0x0,0x0,0x0,0x0,0x0,0x0,0x0,0x0
.long 0x0,0x0,0x0,0x0,0x0,0x0,0x0,0x0
.long 0x0,0x0,0x0,0x0,0x0,0x0,0x0,0x0
.long 0x0,0x0,0x0,0x0,0x0,0x0,0x0,0x0
.long 0x0,0x0,0x0,0x0,0x0,0x0,0x0,0x0
.long 0x0,0x0,0x0,0x0,0x0,0x0,0x0,0x0
.long 0x0,0x0,0x0,0x0,0x0,0x0,0x0,0x0
.long 0x0,0x0,0x0,0x0,0x0,0x0,0x0,0x0
.long 0x0,0x0,0x0,0x0,0x0,0x0,0x0,0x0
.long 0x0,0x0,0x0,0x0,0x0,0x0,0x0,0x0
.long 0x0,0x0,0x0,0x0,0x0,0x0,0x0,0x0
.long 0x0,0x0,0x0,0x0,0x0,0x0,0x0,0x0
.long 0x0,0x0,0x0,0x0,0x0,0x0,0x0,0x0
.long 0x0,0x0,0x0,0x0,0x0,0x0,0x0,0x0
.long 0x0,0x0,0x0,0x0,0x0,0x0,0x0,0x0
.long 0x0,0x0,0x0,0x0,0x0,0x0,0x0,0x0
.long 0x3c00,0xbb9c34f2,0x38b4ba79,0x3b9c34f2,0x3c00,0xba7938b4,0x3744bb21,0x3be7b102
.long 0x3c00,0xb8b43a79,0x34f2bb9c,0x3a79b8b4,0x3c00,0xb4f23b9c,0x3102bbe7,0x3744bb21
.long 0x3c00,0x80003c00,0xbc00,0xbc00,0x3c00,0x34f23b9c,0xb102bbe7,0xb744bb21
.long 0x3c00,0x38b43a79,0xb4f2bb9c,0xba79b8b4,0x3c00,0x3a7938b4,0xb744bb21,0xbbe7b102
.long 0x3c00,0x3b9c34f2,0xb8b4ba79,0xbb9c34f2,0x3c00,0x3c000000,0xb9a8b9a8,0xb9a839a8
.long 0x3c00,0x3b9cb4f2,0xba79b8b4,0xb4f23b9c,0x3c00,0x3a79b8b4,0xbb21b744,0x31023be7
.long 0x3c00,0x38b4ba79,0xbb9cb4f2,0x38b43a79,0x3c00,0x34f2bb9c,0xbbe7b102,0x3b213744
.long 0x3c00,0xbc00,0xbc008000,0x3c000000,0x3c00,0xb4f2bb9c,0xbbe73102,0x3b21b744
.long 0xb8b4ba79,0x38b4ba79,0x80003c00,0xbb9c34f2,0xbb9cb4f2,0xb4f2bb9c,0x39a839a8,0xb1023be7
.long 0xbb9c34f2,0xbb9cb4f2,0x3c000000,0x3a7938b4,0xb8b43a79,0xba7938b4,0x39a8b9a8,0x3b21b744
.long 0x80003c00,0x80003c00,0xbc00,0xbc00,0x38b43a79,0x3a7938b4,0xb9a8b9a8,0xbb21b744
.long 0x3b9c34f2,0x3b9cb4f2,0xbc000000,0xba7938b4,0x3b9cb4f2,0x34f2bb9c,0xb9a839a8,0x31023be7
.long 0x38b4ba79,0xb8b4ba79,0x80003c00,0x3b9c34f2,0xbc00,0xbc008000,0x39a839a8,0x39a8b9a8
.long 0xb8b4ba79,0xb8b43a79,0x3c000000,0xb4f2bb9c,0xbb9cb4f2,0x34f23b9c,0x39a8b9a8,0xbbe7b102
.long 0xbb9c34f2,0x3b9c34f2,0xbc00,0xb8b43a79,0xb8b43a79,0x3a79b8b4,0xb9a8b9a8,0x37443b21
.long 0x80003c00,0xbc00,0xbc008000,0x3c008000,0x38b43a79,0xba79b8b4,0xb9a839a8,0x3744bb21
.long 0x3b9c34f2,0x80003c00,0xb8b4ba79,0x38b4ba79,0x38b4ba79,0x3c008000,0xbb213744,0xbb21b744
.long 0xb8b4ba79,0xbc00,0x34f23b9c,0xb4f23b9c,0xbb9c34f2,0xbc000000,0x3be7b102,0x3be73102
.long 0x80003c00,0x80003c00,0xbc00,0xbc00,0x3b9c34f2,0x3c008000,0xbbe7b102,0xbbe73102
.long 0x38b4ba79,0x8000bc00,0xb4f23b9c,0x34f23b9c,0xb8b4ba79,0xbc000000,0x3b213744,0x3b21b744
.long 0xbb9c34f2,0x80003c00,0x38b4ba79,0xb8b4ba79,0x80003c00,0x3c000000,0xb9a8b9a8,0xb9a839a8
.long 0x3b9c34f2,0xbc00,0xba7938b4,0x3a7938b4,0x38b4ba79,0xbc008000,0x37443b21,0x3744bb21
.long 0xb8b4ba79,0x80003c00,0x3b9cb4f2,0xbb9cb4f2,0xbb9c34f2,0x3c008000,0xb102bbe7,0xb1023be7
.long 0x80003c00,0xbc00,0xbc008000,0x3c000000,0x3b9c34f2,0xbc008000,0xb1023be7,0xb102bbe7
.long 0xbb9c34f2,0xb8b4ba79,0x3b9c34f2,0x80003c00,0x38b43a79,0xb4f23b9c,0xb102bbe7,0x39a8b9a8
.long 0x38b4ba79,0x3b9cb4f2,0xba7938b4,0xbc008000,0xbb9cb4f2,0xba79b8b4,0x3b213744,0x39a839a8
.long 0x80003c00,0x80003c00,0x8000bc00,0xbc00,0x3b9cb4f2,0x3a79b8b4,0xbb213744,0xb9a839a8
.long 0xb8b4ba79,0xbb9cb4f2,0x3a7938b4,0x3c000000,0xb8b43a79,0x34f23b9c,0x3102bbe7,0xb9a8b9a8
.long 0x3b9c34f2,0x38b4ba79,0xbb9c34f2,0x80003c00,0xbc00,0xbc008000,0x39a839a8,0x39a8b9a8
.long 0xbb9c34f2,0x38b43a79,0x34f2bb9c,0xbc008000,0x38b43a79,0x34f2bb9c,0xbbe73102,0x39a839a8
.long 0x38b4ba79,0xbb9c34f2,0x38b43a79,0xbc00,0xbb9cb4f2,0x3a7938b4,0x3744bb21,0xb9a839a8
.long 0x80003c00,0x8000bc00,0xbc000000,0x3c000000,0x3b9cb4f2,0xba7938b4,0x37443b21,0xb9a8b9a8
.long 0x38b4ba79,0x3b9c34f2,0xbb9c34f2,0xb8b4ba79,0xbb9c34f2,0xba79b8b4,0x3be73102,0x37443b21
.long 0x3b9c34f2,0x38b43a79,0xba79b8b4,0xb4f2bb9c,0xb8b4ba79,0xb4f2bb9c,0x37443b21,0x31023be7
.long 0x80003c00,0x80003c00,0x8000bc00,0x8000bc00,0x38b4ba79,0x34f2bb9c,0xb7443b21,0xb1023be7
.long 0xbb9c34f2,0xb8b43a79,0x3a79b8b4,0x34f2bb9c,0x3b9c34f2,0x3a79b8b4,0xbbe73102,0xb7443b21
.long 0xb8b4ba79,0xbb9c34f2,0x3b9c34f2,0x38b4ba79,0x80003c00,0x3c000000,0xb9a8b9a8,0xb9a839a8
.long 0x38b4ba79,0xbb9cb4f2,0x34f23b9c,0x3a79b8b4,0xbb9c34f2,0x3a7938b4,0x3102bbe7,0xbb213744
.long 0x3b9c34f2,0xb8b4ba79,0xb8b43a79,0x3b9cb4f2,0xb8b4ba79,0x34f23b9c,0x3b21b744,0xbbe73102
.long 0x80003c00,0xbc00,0xbc008000,0x3c000000,0x38b4ba79,0xb4f23b9c,0x3b213744,0xbbe7b102
.long 0x80003c00,0xbb9c34f2,0x38b4ba79,0x3b9c34f2,0x8000bc00,0x3a79b8b4,0xb7443b21,0xbbe73102
.long 0x80003c00,0xb8b43a79,0x34f2bb9c,0x3a79b8b4,0x8000bc00,0x34f2bb9c,0xb1023be7,0xb7443b21
.long 0x80003c00,0x80003c00,0x8000bc00,0xbc00,0x8000bc00,0xb4f2bb9c,0x31023be7,0x37443b21
.long 0x3c00,0x38b43a79,0xb4f2bb9c,0xba79b8b4,0x8000bc00,0xba79b8b4,0x37443b21,0x3be73102
.long 0x80003c00,0x3b9c34f2,0xb8b4ba79,0xbb9c34f2,0xbc00,0xbc008000,0x39a839a8,0x39a8b9a8
.long 0x80003c00,0x3b9cb4f2,0xba79b8b4,0xb4f23b9c,0xbc00,0xba7938b4,0x3b213744,0xb102bbe7
.long 0x80003c00,0x38b4ba79,0xbb9cb4f2,0x38b43a79,0x8000bc00,0xb4f23b9c,0x3be73102,0xbb21b744
.long 0x80003c00,0xbc00,0xbc000000,0x3c000000,0xbc00,0x34f23b9c,0x3be7b102,0xbb213744
.long 0xb8b4ba79,0x38b4ba79,0x80003c00,0xbb9c34f2,0x3b9c34f2,0x34f23b9c,0xb9a8b9a8,0x3102bbe7
.long 0xbb9c34f2,0xbb9cb4f2,0x3c000000,0x3a7938b4,0x38b4ba79,0x3a79b8b4,0xb9a839a8,0xbb213744
.long 0x80003c00,0x3c00,0x8000bc00,0xbc00,0xb8b4ba79,0xba79b8b4,0x39a839a8,0x3b213744
.long 0x3b9c34f2,0x3b9cb4f2,0xbc000000,0xba7938b4,0xbb9c34f2,0xb4f23b9c,0x39a8b9a8,0xb102bbe7
.long 0x38b4ba79,0xb8b4ba79,0x80003c00,0x3b9c34f2,0x80003c00,0x3c008000,0xb9a8b9a8,0xb9a839a8
.long 0xb8b4ba79,0xb8b43a79,0x3c008000,0xb4f2bb9c,0x3b9c34f2,0xb4f2bb9c,0xb9a839a8,0x3be73102
.long 0xbb9c34f2,0x3b9c34f2,0x8000bc00,0xb8b43a79,0x38b4ba79,0xba7938b4,0x39a839a8,0xb744bb21
.long 0x80003c00,0x8000bc00,0xbc008000,0x3c000000,0xb8b4ba79,0x3a7938b4,0x39a8b9a8,0xb7443b21
.long 0x3b9c34f2,0x80003c00,0xb8b4ba79,0x38b4ba79,0xb8b43a79,0xbc008000,0x3b21b744,0x3b213744
.long 0xb8b4ba79,0xbc00,0x34f23b9c,0xb4f23b9c,0x3b9cb4f2,0x3c000000,0xbbe73102,0xbbe7b102
.long 0x80003c00,0x80003c00,0x8000bc00,0xbc00,0xbb9cb4f2,0xbc008000,0x3be73102,0x3be7b102
.long 0x38b4ba79,0xbc00,0xb4f23b9c,0x34f23b9c,0x38b43a79,0x3c000000,0xbb21b744,0xbb213744
.long 0xbb9c34f2,0x80003c00,0x38b4ba79,0xb8b4ba79,0xbc00,0xbc008000,0x39a839a8,0x39a8b9a8
.long 0x3b9c34f2,0xbc00,0xba7938b4,0x3a7938b4,0xb8b43a79,0x3c000000,0xb744bb21,0xb7443b21
.long 0xb8b4ba79,0x80003c00,0x3b9cb4f2,0xbb9cb4f2,0x3b9cb4f2,0xbc008000,0x31023be7,0x3102bbe7
.long 0x3c00,0xbc00,0xbc008000,0x3c000000,0xbb9cb4f2,0x3c000000,0x3102bbe7,0x31023be7
.long 0xbb9c34f2,0xb8b4ba79,0x3b9c34f2,0x80003c00,0xb8b4ba79,0x34f2bb9c,0x31023be7,0xb9a839a8
.long 0x38b4ba79,0x3b9cb4f2,0xba7938b4,0xbc008000,0x3b9c34f2,0x3a7938b4,0xbb21b744,0xb9a8b9a8
.long 0x80003c00,0x3c00,0x8000bc00,0xbc00,0xbb9c34f2,0xba7938b4,0x3b21b744,0x39a8b9a8
.long 0xb8b4ba79,0xbb9cb4f2,0x3a7938b4,0x3c000000,0x38b4ba79,0xb4f2bb9c,0xb1023be7,0x39a839a8
.long 0x3b9c34f2,0x38b4ba79,0xbb9c34f2,0x3c00,0x80003c00,0x3c000000,0xb9a8b9a8,0xb9a839a8
.long 0xbb9c34f2,0x38b43a79,0x34f2bb9c,0xbc008000,0xb8b4ba79,0xb4f23b9c,0x3be7b102,0xb9a8b9a8
.long 0x38b4ba79,0xbb9c34f2,0x38b43a79,0xbc00,0x3b9c34f2,0xba79b8b4,0xb7443b21,0x39a8b9a8
.long 0x80003c00,0xbc00,0xbc000000,0x3c008000,0xbb9c34f2,0x3a79b8b4,0xb744bb21,0x39a839a8
.long 0x38b4ba79,0x3b9c34f2,0xbb9c34f2,0xb8b4ba79,0x3b9cb4f2,0x3a7938b4,0xbbe7b102,0xb744bb21
.long 0x3b9c34f2,0x38b43a79,0xba79b8b4,0xb4f2bb9c,0x38b43a79,0x34f23b9c,0xb744bb21,0xb102bbe7
.long 0x80003c00,0x3c00,0xbc00,0xbc00,0xb8b43a79,0xb4f23b9c,0x3744bb21,0x3102bbe7
.long 0xbb9c34f2,0xb8b43a79,0x3a79b8b4,0x34f2bb9c,0xbb9cb4f2,0xba7938b4,0x3be7b102,0x3744bb21
.long 0xb8b4ba79,0xbb9c34f2,0x3b9c34f2,0x38b4ba79,0xbc00,0xbc008000,0x39a839a8,0x39a8b9a8
.long 0x38b4ba79,0xbb9cb4f2,0x34f23b9c,0x3a79b8b4,0x3b9cb4f2,0xba79b8b4,0xb1023be7,0x3b21b744
.long 0x3b9c34f2,0xb8b4ba79,0xb8b43a79,0x3b9cb4f2,0x38b43a79,0xb4f2bb9c,0xbb213744,0x3be7b102
.long 0x80003c00,0xbc00,0xbc008000,0x3c000000,0xb8b43a79,0x34f2bb9c,0xbb21b744,0x3be73102
.long 0x0,0x0,0x0,0x0,0x0,0x0,0x0,0x0
.long 0x0,0x0,0x0,0x0,0x0,0x0,0x0,0x0
.long 0x0,0x0,0x0,0x0,0x0,0x0,0x0,0x0
.long 0x0,0x0,0x0,0x0,0x0,0x0,0x0,0x0
.long 0x0,0x0,0x0,0x0,0x0,0x0,0x0,0x0
.long 0x0,0x0,0x0,0x0,0x0,0x0,0x0,0x0
.long 0x0,0x0,0x0,0x0,0x0,0x0,0x0,0x0
.long 0x0,0x0,0x0,0x0,0x0,0x0,0x0,0x0
.long 0x0,0x0,0x0,0x0,0x0,0x0,0x0,0x0
.long 0x0,0x0,0x0,0x0,0x0,0x0,0x0,0x0
.long 0x0,0x0,0x0,0x0,0x0,0x0,0x0,0x0
.long 0x0,0x0,0x0,0x0,0x0,0x0,0x0,0x0
.long 0x0,0x0,0x0,0x0,0x0,0x0,0x0,0x0
.long 0x0,0x0,0x0,0x0,0x0,0x0,0x0,0x0
.long 0x0,0x0,0x0,0x0,0x0,0x0,0x0,0x0
.long 0x0,0x0,0x0,0x0,0x0,0x0,0x0,0x0
.long 0x3c00,0xb8b4ba79,0xbb9c34f2,0x38b4ba79,0x3c00,0xba79b8b4,0xbb213744,0x3102bbe7
.long 0x3c00,0xbb9cb4f2,0xba7938b4,0xb4f2bb9c,0x3c00,0xbc008000,0xb9a839a8,0xb9a8b9a8
.long 0x3c00,0xbb9c34f2,0xb8b43a79,0xbb9cb4f2,0x3c00,0xba7938b4,0xb7443b21,0xbbe73102
.long 0x3c00,0xb8b43a79,0xb4f23b9c,0xba7938b4,0x3c00,0xb4f23b9c,0xb1023be7,0xb7443b21
.long 0x0,0x0,0x0,0x0,0x0,0x0,0x0,0x0
.long 0x0,0x0,0x0,0x0,0x0,0x0,0x0,0x0
.long 0x0,0x0,0x0,0x0,0x0,0x0,0x0,0x0
.long 0x0,0x0,0x0,0x0,0x0,0x0,0x0,0x0
.long 0x3b9c34f2,0xbb9c34f2,0x80003c00,0xb8b4ba79,0x3b9cb4f2,0xb4f23b9c,0x39a839a8,0xbbe73102
.long 0x38b4ba79,0x38b43a79,0x3c008000,0xb4f23b9c,0xbc00,0x3c008000,0x39a8b9a8,0x39a839a8
.long 0xb8b4ba79,0x38b4ba79,0xbc00,0x3b9cb4f2,0xbb9cb4f2,0xb4f2bb9c,0xb9a8b9a8,0x3102bbe7
.long 0xbb9c34f2,0xbb9cb4f2,0xbc000000,0xba79b8b4,0xb8b43a79,0xba7938b4,0xb9a839a8,0xbb213744
.long 0x0,0x0,0x0,0x0,0x0,0x0,0x0,0x0
.long 0x0,0x0,0x0,0x0,0x0,0x0,0x0,0x0
.long 0x0,0x0,0x0,0x0,0x0,0x0,0x0,0x0
.long 0x0,0x0,0x0,0x0,0x0,0x0,0x0,0x0
.long 0x38b4ba79,0x80003c00,0x3b9c34f2,0xbb9c34f2,0xb8b4ba79,0x3c000000,0x3744bb21,0x37443b21
.long 0xbb9c34f2,0x8000bc00,0xba79b8b4,0x3a79b8b4,0x80003c00,0xbc008000,0xb9a839a8,0xb9a8b9a8
.long 0x3b9c34f2,0x80003c00,0x38b43a79,0xb8b43a79,0x38b4ba79,0x3c000000,0x3b21b744,0x3b213744
.long 0xb8b4ba79,0x8000bc00,0xb4f2bb9c,0x34f2bb9c,0xbb9c34f2,0xbc008000,0xbbe73102,0xbbe7b102
.long 0x0,0x0,0x0,0x0,0x0,0x0,0x0,0x0
.long 0x0,0x0,0x0,0x0,0x0,0x0,0x0,0x0
.long 0x0,0x0,0x0,0x0,0x0,0x0,0x0,0x0
.long 0x0,0x0,0x0,0x0,0x0,0x0,0x0,0x0
.long 0xb8b4ba79,0x3b9c34f2,0x38b4ba79,0x80003c00,0xb8b43a79,0xb4f2bb9c,0xbbe7b102,0x39a8b9a8
.long 0x3b9c34f2,0xb8b43a79,0x34f23b9c,0xbc008000,0x8000bc00,0x3c000000,0x39a8b9a8,0x39a839a8
.long 0xbb9c34f2,0xb8b4ba79,0xbb9cb4f2,0xbc00,0x38b43a79,0xb4f23b9c,0x31023be7,0xb9a839a8
.long 0x38b4ba79,0x3b9cb4f2,0x3a79b8b4,0x3c000000,0xbb9cb4f2,0xba79b8b4,0xbb21b744,0xb9a8b9a8
.long 0x0,0x0,0x0,0x0,0x0,0x0,0x0,0x0
.long 0x0,0x0,0x0,0x0,0x0,0x0,0x0,0x0
.long 0x0,0x0,0x0,0x0,0x0,0x0,0x0,0x0
.long 0x0,0x0,0x0,0x0,0x0,0x0,0x0,0x0
.long 0xbb9c34f2,0x38b4ba79,0xb8b4ba79,0x3b9c34f2,0x3b9c34f2,0xba7938b4,0x31023be7,0xbb21b744
.long 0xb8b4ba79,0x3b9cb4f2,0x34f2bb9c,0x3a7938b4,0x80003c00,0xbc000000,0xb9a839a8,0xb9a8b9a8
.long 0x38b4ba79,0x3b9c34f2,0x3b9cb4f2,0x38b43a79,0xbb9c34f2,0xba79b8b4,0xbbe7b102,0xb744bb21
.long 0x3b9c34f2,0x38b43a79,0x3a7938b4,0x34f23b9c,0xb8b4ba79,0xb4f2bb9c,0xb744bb21,0xb102bbe7
.long 0x0,0x0,0x0,0x0,0x0,0x0,0x0,0x0
.long 0x0,0x0,0x0,0x0,0x0,0x0,0x0,0x0
.long 0x0,0x0,0x0,0x0,0x0,0x0,0x0,0x0
.long 0x0,0x0,0x0,0x0,0x0,0x0,0x0,0x0
.long 0x80003c00,0xb8b4ba79,0xbb9c34f2,0x38b4ba79,0xbc00,0x3a7938b4,0x3b21b744,0xb1023be7
.long 0x3c00,0xbb9cb4f2,0xba7938b4,0xb4f2bb9c,0xbc00,0x3c000000,0x39a8b9a8,0x39a839a8
.long 0x80003c00,0xbb9c34f2,0xb8b43a79,0xbb9cb4f2,0xbc00,0x3a79b8b4,0x3744bb21,0x3be7b102
.long 0x3c00,0xb8b43a79,0xb4f23b9c,0xba7938b4,0xbc00,0x34f2bb9c,0x3102bbe7,0x3744bb21
.long 0x0,0x0,0x0,0x0,0x0,0x0,0x0,0x0
.long 0x0,0x0,0x0,0x0,0x0,0x0,0x0,0x0
.long 0x0,0x0,0x0,0x0,0x0,0x0,0x0,0x0
.long 0x0,0x0,0x0,0x0,0x0,0x0,0x0,0x0
.long 0x3b9c34f2,0xbb9c34f2,0x80003c00,0xb8b4ba79,0xbb9c34f2,0x34f2bb9c,0xb9a8b9a8,0x3be7b102
.long 0x38b4ba79,0x38b43a79,0x3c000000,0xb4f23b9c,0x3c00,0xbc008000,0xb9a839a8,0xb9a8b9a8
.long 0xb8b4ba79,0x38b4ba79,0xbc00,0x3b9cb4f2,0x3b9c34f2,0x34f23b9c,0x39a839a8,0xb1023be7
.long 0xbb9c34f2,0xbb9cb4f2,0xbc008000,0xba79b8b4,0x38b4ba79,0x3a79b8b4,0x39a8b9a8,0x3b21b744
.long 0x0,0x0,0x0,0x0,0x0,0x0,0x0,0x0
.long 0x0,0x0,0x0,0x0,0x0,0x0,0x0,0x0
.long 0x0,0x0,0x0,0x0,0x0,0x0,0x0,0x0
.long 0x0,0x0,0x0,0x0,0x0,0x0,0x0,0x0
.long 0x38b4ba79,0x80003c00,0x3b9c34f2,0xbb9c34f2,0x38b43a79,0xbc008000,0xb7443b21,0xb744bb21
.long 0xbb9c34f2,0xbc00,0xba79b8b4,0x3a79b8b4,0xbc00,0x3c008000,0x39a8b9a8,0x39a839a8
.long 0x3b9c34f2,0x80003c00,0x38b43a79,0xb8b43a79,0xb8b43a79,0xbc008000,0xbb213744,0xbb21b744
.long 0xb8b4ba79,0xbc00,0xb4f2bb9c,0x34f2bb9c,0x3b9cb4f2,0x3c000000,0x3be7b102,0x3be73102
.long 0x0,0x0,0x0,0x0,0x0,0x0,0x0,0x0
.long 0x0,0x0,0x0,0x0,0x0,0x0,0x0,0x0
.long 0x0,0x0,0x0,0x0,0x0,0x0,0x0,0x0
.long 0x0,0x0,0x0,0x0,0x0,0x0,0x0,0x0
.long 0xb8b4ba79,0x3b9c34f2,0x38b4ba79,0x80003c00,0x38b4ba79,0x34f23b9c,0x3be73102,0xb9a839a8
.long 0x3b9c34f2,0xb8b43a79,0x34f23b9c,0xbc008000,0x80003c00,0xbc000000,0xb9a839a8,0xb9a8b9a8
.long 0xbb9c34f2,0xb8b4ba79,0xbb9cb4f2,0xbc00,0xb8b4ba79,0x34f2bb9c,0xb102bbe7,0x39a8b9a8
.long 0x38b4ba79,0x3b9cb4f2,0x3a79b8b4,0x3c000000,0x3b9c34f2,0x3a7938b4,0x3b213744,0x39a839a8
.long 0x0,0x0,0x0,0x0,0x0,0x0,0x0,0x0
.long 0x0,0x0,0x0,0x0,0x0,0x0,0x0,0x0
.long 0x0,0x0,0x0,0x0,0x0,0x0,0x0,0x0
.long 0x0,0x0,0x0,0x0,0x0,0x0,0x0,0x0
.long 0xbb9c34f2,0x38b4ba79,0xb8b4ba79,0x3b9c34f2,0xbb9cb4f2,0x3a79b8b4,0xb102bbe7,0x3b213744
.long 0xb8b4ba79,0x3b9cb4f2,0x34f2bb9c,0x3a7938b4,0x8000bc00,0x3c000000,0x39a8b9a8,0x39a839a8
.long 0x38b4ba79,0x3b9c34f2,0x3b9cb4f2,0x38b43a79,0x3b9cb4f2,0x3a7938b4,0x3be73102,0x37443b21
.long 0x3b9c34f2,0x38b43a79,0x3a7938b4,0x34f23b9c,0x38b43a79,0x34f23b9c,0x37443b21,0x31023be7
.long 0x0,0x0,0x0,0x0,0x0,0x0,0x0,0x0
.long 0x0,0x0,0x0,0x0,0x0,0x0,0x0,0x0
.long 0x0,0x0,0x0,0x0,0x0,0x0,0x0,0x0
.long 0x0,0x0,0x0,0x0,0x0,0x0,0x0,0x0
.long 0x0,0x0,0x0,0x0,0x0,0x0,0x0,0x0
.long 0x0,0x0,0x0,0x0,0x0,0x0,0x0,0x0
.long 0x0,0x0,0x0,0x0,0x0,0x0,0x0,0x0
.long 0x0,0x0,0x0,0x0,0x0,0x0,0x0,0x0
.long 0x0,0x0,0x0,0x0,0x0,0x0,0x0,0x0
.long 0x0,0x0,0x0,0x0,0x0,0x0,0x0,0x0
.long 0x0,0x0,0x0,0x0,0x0,0x0,0x0,0x0
.long 0x0,0x0,0x0,0x0,0x0,0x0,0x0,0x0
.long 0x0,0x0,0x0,0x0,0x0,0x0,0x0,0x0
.long 0x0,0x0,0x0,0x0,0x0,0x0,0x0,0x0
.long 0x0,0x0,0x0,0x0,0x0,0x0,0x0,0x0
.long 0x0,0x0,0x0,0x0,0x0,0x0,0x0,0x0
.long 0x0,0x0,0x0,0x0,0x0,0x0,0x0,0x0
.long 0x0,0x0,0x0,0x0,0x0,0x0,0x0,0x0
.long 0x0,0x0,0x0,0x0,0x0,0x0,0x0,0x0
.long 0x0,0x0,0x0,0x0,0x0,0x0,0x0,0x0
.long 0x3f800000,0x0,0x3f800000,0x0,0x3f800000,0x0,0x3f800000,0x0
.long 0x3f800000,0x0,0x3f7ff35e,0x3ca0d6d6,0x3f7cd925,0x3e20305b,0x3f7c0361,0x3e3403f1
.long 0x3f800000,0x0,0x3f800000,0x0,0x3f800000,0x0,0x3f800000,0x0
.long 0x3f7fcd79,0x3d20cee7,0x3f7f8e56,0x3d712283,0x3f7b14be,0x3e47c5c2,0x3f7a0d54,0x3e5b73dc
.long 0x3f800000,0x0,0x3f800000,0x0,0x3f800000,0x0,0x3f800000,0x0
.long 0x3f7f35f9,0x3da0af2a,0x3f7ec46d,0x3dc8bd36,0x3f78ed3c,0x3e6f0c4d,0x3f77b493,0x3e814693
.long 0x3f800000,0x0,0x3f800000,0x0,0x3f800000,0x0,0x3f800000,0x0
.long 0x3f7e39bc,0x3df0b772,0x3f7d95f4,0x3e0c4cf7,0x3f766377,0x3e8afa3e,0x3f74fa0b,0x3e94a031
.long 0x3f800000,0x0,0x3f7ffcd7,0x3c20d8d2,0x3f7f35f9,0x3da0af2a,0x3f7f0059,0x3db4b86a
.long 0x3f800000,0x0,0x3f7fe394,0x3cf13d4c,0x3f78ed3c,0x3e6f0c4d,0x3f770f11,0x3e862210
.long 0x3f7ff35e,0x3ca0d6d6,0x3f7fe394,0x3cf13d4c,0x3f7ec46d,0x3dc8bd36,0x3f7e8238,0x3ddcbd0d
.long 0x3f7f8e56,0x3d712283,0x3f7f0059,0x3db4b86a,0x3f74fa0b,0x3e94a031,0x3f72ae9e,0x3ea2fd52
.long 0x3f7fcd79,0x3d20cee7,0x3f7fb10f,0x3d48fb30,0x3f7e39bc,0x3df0b772,0x3f7deafa,0x3e0255f4
.long 0x3f7e39bc,0x3df0b772,0x3f7d3aac,0x3e164083,0x3f702d4f,0x3eb13641,0x3f6d76aa,0x3ebf47d7
.long 0x3f7f8e56,0x3d712283,0x3f7f654e,0x3d8ca1f2,0x3f7d95f4,0x3e0c4cf7,0x3f7d3aac,0x3e164083
.long 0x3f7c0361,0x3e3403f1,0x3f7a9421,0x3e519f65,0x3f6a8b4b,0x3ecd2ef3,0x3f676bd8,0x3edae880
.long 0x3f800000,0x0,0x3f7fcd79,0x3d20cee7,0x3f737871,0x3e9e377a,0x3f702d4f,0x3eb13641
.long 0x3f800000,0x0,0x3f7f8e56,0x3d712283,0x3f641901,0x3ee87171,0x3f5cdc29,0x3f0172c3
.long 0x3f7f35f9,0x3da0af2a,0x3f7e39bc,0x3df0b772,0x3f6c835e,0x3ec3ef15,0x3f687c12,0x3ed65a92
.long 0x3f7e39bc,0x3df0b772,0x3f7c0361,0x3e3403f1,0x3f54db31,0x3f0e39da,0x3f4c1d35,0x3f1a82a4
.long 0x3f7cd925,0x3e20305b,0x3f7b14be,0x3e47c5c2,0x3f641901,0x3ee87171,0x3f5f5be6,0x3efa2c90
.long 0x3f78ed3c,0x3e6f0c4d,0x3f74fa0b,0x3e94a031,0x3f42a9f7,0x3f26423a,0x3f3889dc,0x3f316e2c
.long 0x3f78ed3c,0x3e6f0c4d,0x3f766377,0x3e8afa3e,0x3f5a46a0,0x3f05c277,0x3f54db31,0x3f0e39da
.long 0x3f702d4f,0x3eb13641,0x3f6a8b4b,0x3ecd2ef3,0x3f2dc5e3,0x3f3bfc8f,0x3f226799,0x3f45e403
.long 0x3f800000,0x0,0x3f7fb10f,0x3d48fb30,0x3f6c835e,0x3ec3ef15,0x3f676bd8,0x3edae880
.long 0x3f800000,0x0,0x3f7f654e,0x3d8ca1f2,0x3f5a46a0,0x3f05c277,0x3f50935b,0x3f146eba
.long 0x3f7ec46d,0x3dc8bd36,0x3f7d3aac,0x3e164083,0x3f61c598,0x3ef15aea,0x3f5b941a,0x3f039c3d
.long 0x3f7d95f4,0x3e0c4cf7,0x3f7a9421,0x3e519f65,0x3f45e403,0x3f226799,0x3f3a4582,0x3f2f9c32
.long 0x3f7b14be,0x3e47c5c2,0x3f7853f8,0x3e78cfcc,0x3f54db31,0x3f0e39da,0x3f4d9f02,0x3f187fc0
.long 0x3f766377,0x3e8afa3e,0x3f710908,0x3eac7cd4,0x3f2dc5e3,0x3f3bfc8f,0x3f207440,0x3f4779bc
.long 0x3f74fa0b,0x3e94a031,0x3f710908,0x3eac7cd4,0x3f45e403,0x3f226799,0x3f3daef9,0x3f2beb4a
.long 0x3f6a8b4b,0x3ecd2ef3,0x3f62f219,0x3eece91a,0x3f1260b2,0x3f5205d4,0x3f039c3d,0x3f5b941a
.long 0x3f800000,0x0,0x3f7f35f9,0x3da0af2a,0x3f4f1bbd,0x3f167918,0x3f42a9f7,0x3f26423a
.long 0x3f800000,0x0,0x3f7ec46d,0x3dc8bd36,0x3f3504f3,0x3f3504f3,0x3f226799,0x3f45e403
.long 0x3f7cd925,0x3e20305b,0x3f78ed3c,0x3e6f0c4d,0x3f3504f3,0x3f3504f3,0x3f26423a,0x3f42a9f7
.long 0x3f7b14be,0x3e47c5c2,0x3f74fa0b,0x3e94a031,0x3f0e39da,0x3f54db31,0x3ef15aea,0x3f61c598
.long 0x3f737871,0x3e9e377a,0x3f6c835e,0x3ec3ef15,0x3f167918,0x3f4f1bbd,0x3f05c277,0x3f5a46a0
.long 0x3f6c835e,0x3ec3ef15,0x3f61c598,0x3ef15aea,0x3ec3ef15,0x3f6c835e,0x3e94a031,0x3f74fa0b
.long 0x3f641901,0x3ee87171,0x3f5a46a0,0x3f05c277,0x3ee87171,0x3f641901,0x3ec3ef15,0x3f6c835e
.long 0x3f54db31,0x3f0e39da,0x3f45e403,0x3f226799,0x3e47c5c2,0x3f7b14be,0x3dc8bd36,0x3f7ec46d
.long 0x3f800000,0x0,0x3f7f0059,0x3db4b86a,0x3f42a9f7,0x3f26423a,0x3f333bc6,0x3f36c9a9
.long 0x3f800000,0x0,0x3f7e8238,0x3ddcbd0d,0x3f26423a,0x3f42a9f7,0x3f104f0e,0x3f53731f
.long 0x3f7c0361,0x3e3403f1,0x3f770f11,0x3e862210,0x3f226799,0x3f45e403,0x3f104f0e,0x3f53731f
.long 0x3f7a0d54,0x3e5b73dc,0x3f72ae9e,0x3ea2fd52,0x3ef15aea,0x3f61c598,0x3ebf47d7,0x3f6d76aa
.long 0x3f702d4f,0x3eb13641,0x3f676bd8,0x3edae880,0x3efa2c90,0x3f5f5be6,0x3ed1c759,0x3f698690
.long 0x3f687c12,0x3ed65a92,0x3f5b941a,0x3f039c3d,0x3e8afa3e,0x3f766377,0x3e2a1c3f,0x3f7c7160
.long 0x3f5cdc29,0x3f0172c3,0x3f50935b,0x3f146eba,0x3ea7bf25,0x3f71decf,0x3e78cfcc,0x3f7853f8
.long 0x3f4c1d35,0x3f1a82a4,0x3f3a4582,0x3f2f9c32,0x3d712283,0x3f7f8e56,0xbd48fb30,0x3f7fb10f
.long 0x3f800000,0x0,0x3f7e39bc,0x3df0b772,0x3f167918,0x3f4f1bbd,0x3efa2c90,0x3f5f5be6
.long 0x3f800000,0x0,0x3f7d95f4,0x3e0c4cf7,0x3ee87171,0x3f641901,0x3ea7bf25,0x3f71decf
.long 0x3f78ed3c,0x3e6f0c4d,0x3f702d4f,0x3eb13641,0x3ec3ef15,0x3f6c835e,0x3e8afa3e,0x3f766377
.long 0x3f766377,0x3e8afa3e,0x3f6a8b4b,0x3ecd2ef3,0x3e47c5c2,0x3f7b14be,0x3d712283,0x3f7f8e56
.long 0x3f641901,0x3ee87171,0x3f54db31,0x3f0e39da,0x3e20305b,0x3f7cd925,0x3d20cee7,0x3f7fcd79
.long 0x3f5a46a0,0x3f05c277,0x3f45e403,0x3f226799,0xbda0af2a,0x3f7f35f9,0xbe5b73dc,0x3f7a0d54
.long 0x3f42a9f7,0x3f26423a,0x3f2dc5e3,0x3f3bfc8f,0xbda0af2a,0x3f7f35f9,0xbe47c5c2,0x3f7b14be
.long 0x3f2dc5e3,0x3f3bfc8f,0x3f1260b2,0x3f5205d4,0xbeb13641,0x3f702d4f,0xbef15aea,0x3f61c598
.long 0x3f800000,0x0,0x3f7deafa,0x3e0255f4,0x3f05c277,0x3f5a46a0,0x3ed1c759,0x3f698690
.long 0x3f800000,0x0,0x3f7d3aac,0x3e164083,0x3ec3ef15,0x3f6c835e,0x3e78cfcc,0x3f7853f8
.long 0x3f77b493,0x3e814693,0x3f6d76aa,0x3ebf47d7,0x3e94a031,0x3f74fa0b,0x3e2a1c3f,0x3f7c7160
.long 0x3f74fa0b,0x3e94a031,0x3f676bd8,0x3edae880,0x3dc8bd36,0x3f7ec46d,0xbd48fb30,0x3f7fb10f
.long 0x3f5f5be6,0x3efa2c90,0x3f4d9f02,0x3f187fc0,0x3d20cee7,0x3f7fcd79,0xbdb4b86a,0x3f7f0059
.long 0x3f54db31,0x3f0e39da,0x3f3daef9,0x3f2beb4a,0xbe47c5c2,0x3f7b14be,0xbeac7cd4,0x3f710908
.long 0x3f3889dc,0x3f316e2c,0x3f207440,0x3f4779bc,0xbe5b73dc,0x3f7a0d54,0xbeac7cd4,0x3f710908
.long 0x3f226799,0x3f45e403,0x3f039c3d,0x3f5b941a,0xbef15aea,0x3f61c598,0xbf187fc0,0x3f4d9f02
.long 0x3f800000,0x0,0x3f7cd925,0x3e20305b,0x3e9e377a,0x3f737871,0x3e20305b,0x3f7cd925
.long 0x3f800000,0x0,0x3f7c0361,0x3e3403f1,0x3e20305b,0x3f7cd925,0xbca0d6d6,0x3f7ff35e
.long 0x3f737871,0x3e9e377a,0x3f641901,0x3ee87171,0x248d3132,0x3f800000,0xbe20305b,0x3f7cd925
.long 0x3f702d4f,0x3eb13641,0x3f5cdc29,0x3f0172c3,0xbe47c5c2,0x3f7b14be,0xbeba9be1,0x3f6e641a
.long 0x3f4f1bbd,0x3f167918,0x3f3504f3,0x3f3504f3,0xbe9e377a,0x3f737871,0xbee87171,0x3f641901
.long 0x3f42a9f7,0x3f26423a,0x3f226799,0x3f45e403,0xbf05c277,0x3f5a46a0,0xbf2a0c73,0x3f3f5cb5
.long 0x3f167918,0x3f4f1bbd,0x3ee87171,0x3f641901,0xbf167918,0x3f4f1bbd,0xbf3504f3,0x3f3504f3
.long 0x3efa2c90,0x3f5f5be6,0x3ea7bf25,0x3f71decf,0xbf490a88,0x3f1e7cf1,0xbf61c598,0x3ef15aea
.long 0x3f800000,0x0,0x3f7c7160,0x3e2a1c3f,0x3e6f0c4d,0x3f78ed3c,0x3d8ca1f2,0x3f7f654e
.long 0x3f800000,0x0,0x3f7b8f2a,0x3e3de731,0x3da0af2a,0x3f7f35f9,0xbddcbd0d,0x3f7e8238
.long 0x3f71decf,0x3ea7bf25,0x3f609384,0x3ef5c6c5,0xbdc8bd36,0x3f7ec46d,0xbe862210,0x3f770f11
.long 0x3f6e641a,0x3eba9be1,0x3f58f3c4,0x3f07e565,0xbe94a031,0x3f74fa0b,0xbeece91a,0x3f62f219
.long 0x3f490a88,0x3f1e7cf1,0x3f2beb4a,0x3f3daef9,0xbed65a92,0x3f687c12,0xbf104f0e,0x3f53731f
.long 0x3f3bfc8f,0x3f2dc5e3,0x3f187fc0,0x3f4d9f02,0xbf1e7cf1,0x3f490a88,0xbf4105b8,0x3f28296a
.long 0x3f0a04f8,0x3f579b8c,0x3ec8917e,0x3f6b8a3d,0xbf316e2c,0x3f3889dc,0xbf4d9f02,0x3f187fc0
.long 0x3edf7108,0x3f6655e7,0x3e862210,0x3f770f11,0xbf5cdc29,0x3f0172c3,0xbf710908,0x3eac7cd4
.long 0x3f800000,0x0,0x3f7b14be,0x3e47c5c2,0x248d3132,0x3f800000,0xbe47c5c2,0x3f7b14be
.long 0x3f800000,0x0,0x3f7a0d54,0x3e5b73dc,0xbe20305b,0x3f7cd925,0xbeba9be1,0x3f6e641a
.long 0x3f6c835e,0x3ec3ef15,0x3f54db31,0x3f0e39da,0xbec3ef15,0x3f6c835e,0xbf0e39da,0x3f54db31
.long 0x3f687c12,0x3ed65a92,0x3f4c1d35,0x3f1a82a4,0xbf0e39da,0x3f54db31,0xbf3889dc,0x3f316e2c
.long 0x3f3504f3,0x3f3504f3,0x3f0e39da,0x3f54db31,0xbf3504f3,0x3f3504f3,0xbf54db31,0x3f0e39da
.long 0x3f26423a,0x3f42a9f7,0x3ef15aea,0x3f61c598,0xbf5a46a0,0x3f05c277,0xbf71decf,0x3ea7bf25
.long 0x3ec3ef15,0x3f6c835e,0x3e47c5c2,0x3f7b14be,0xbf6c835e,0x3ec3ef15,0xbf7b14be,0x3e47c5c2
.long 0x3e8afa3e,0x3f766377,0x3d712283,0x3f7f8e56,0xbf7e39bc,0x3df0b772,0xbf7ec46d,0xbdc8bd36
.long 0x3f800000,0x0,0x3f7a9421,0x3e519f65,0xbda0af2a,0x3f7f35f9,0xbe8fcefe,0x3f75b1c9
.long 0x3f800000,0x0,0x3f79805c,0x3e6542e9,0xbe6f0c4d,0x3f78ed3c,0xbee3f40d,0x3f653a48
.long 0x3f6a8b4b,0x3ecd2ef3,0x3f50935b,0x3f146eba,0xbef15aea,0x3f61c598,0xbf2456f1,0x3f444969
.long 0x3f6655e7,0x3edf7108,0x3f4779bc,0x3f207440,0xbf226799,0x3f45e403,0xbf4a965e,0x3f1c81b9
.long 0x3f2dc5e3,0x3f3bfc8f,0x3f039c3d,0x3f5b941a,0xbf490a88,0x3f1e7cf1,0xbf653a48,0x3ee3f40d
.long 0x3f1e7cf1,0x3f490a88,0x3edae880,0x3f676bd8,0xbf687c12,0x3ed65a92,0xbf7a9421,0x3e519f65
.long 0x3ea7bf25,0x3f71decf,0x3e0255f4,0x3f7deafa,0xbf77b493,0x3e814693,0xbf7fb10f,0x3d48fb30
.long 0x3e5b73dc,0x3f7a0d54,0xbc20d8d2,0x3f7ffcd7,0xbf7ff35e,0xbca0d6d6,0xbf7853f8,0xbe78cfcc
.long 0x3f800000,0x0,0x3f78ed3c,0x3e6f0c4d,0xbe9e377a,0x3f737871,0xbf05c277,0x3f5a46a0
.long 0x3f800000,0x0,0x3f77b493,0x3e814693,0xbee87171,0x3f641901,0xbf2a0c73,0x3f3f5cb5
.long 0x3f641901,0x3ee87171,0x3f42a9f7,0x3f26423a,0xbf3504f3,0x3f3504f3,0xbf5a46a0,0x3f05c277
.long 0x3f5f5be6,0x3efa2c90,0x3f3889dc,0x3f316e2c,0xbf54db31,0x3f0e39da,0xbf71decf,0x3ea7bf25
.long 0x3f167918,0x3f4f1bbd,0x3ec3ef15,0x3f6c835e,0xbf737871,0x3e9e377a,0xbf7f35f9,0x3da0af2a
.long 0x3f05c277,0x3f5a46a0,0x3e94a031,0x3f74fa0b,0xbf7f35f9,0x3da0af2a,0xbf7c0361,0xbe3403f1
.long 0x3e20305b,0x3f7cd925,0xbda0af2a,0x3f7f35f9,0xbf7cd925,0xbe20305b,0xbf6c835e,0xbec3ef15
.long 0x3d20cee7,0x3f7fcd79,0xbe5b73dc,0x3f7a0d54,0xbf687c12,0xbed65a92,0xbf45e403,0xbf226799
.long 0x3f800000,0x0,0x3f7853f8,0x3e78cfcc,0xbec3ef15,0x3f6c835e,0xbf187fc0,0x3f4d9f02
.long 0x3f800000,0x0,0x3f770f11,0x3e862210,0xbf05c277,0x3f5a46a0,0xbf3a4582,0x3f2f9c32
.long 0x3f61c598,0x3ef15aea,0x3f3daef9,0x3f2beb4a,0xbf45e403,0x3f226799,0xbf676bd8,0x3edae880
.long 0x3f5cdc29,0x3f0172c3,0x3f333bc6,0x3f36c9a9,0xbf61c598,0x3ef15aea,0xbf79805c,0x3e6542e9
.long 0x3f0e39da,0x3f54db31,0x3eac7cd4,0x3f710908,0xbf7b14be,0x3e47c5c2,0xbf7fb10f,0xbd48fb30
.long 0x3efa2c90,0x3f5f5be6,0x3e78cfcc,0x3f7853f8,0xbf7fcd79,0xbd20cee7,0xbf743c41,0xbe996dba
.long 0x3dc8bd36,0x3f7ec46d,0xbe164083,0x3f7d3aac,0xbf74fa0b,0xbe94a031,0xbf5b941a,0xbf039c3d
.long 0xbca0d6d6,0x3f7ff35e,0xbe8fcefe,0x3f75b1c9,0xbf579b8c,0xbf0a04f8,0xbf2beb4a,0xbf3daef9
.long 0x3f800000,0x0,0x3f766377,0x3e8afa3e,0xbf167918,0x3f4f1bbd,0xbf490a88,0x3f1e7cf1
.long 0x3f800000,0x0,0x3f74fa0b,0x3e94a031,0xbf3504f3,0x3f3504f3,0xbf61c598,0x3ef15aea
.long 0x3f5a46a0,0x3f05c277,0x3f2dc5e3,0x3f3bfc8f,0xbf6c835e,0x3ec3ef15,0xbf7e39bc,0x3df0b772
.long 0x3f54db31,0x3f0e39da,0x3f226799,0x3f45e403,0xbf7b14be,0x3e47c5c2,0xbf7ec46d,0xbdc8bd36
.long 0x3ee87171,0x3f641901,0x3e47c5c2,0x3f7b14be,0xbf7cd925,0xbe20305b,0xbf687c12,0xbed65a92
.long 0x3ec3ef15,0x3f6c835e,0x3dc8bd36,0x3f7ec46d,0xbf6c835e,0xbec3ef15,0xbf45e403,0xbf226799
.long 0xbda0af2a,0x3f7f35f9,0xbeb13641,0x3f702d4f,0xbf42a9f7,0xbf26423a,0xbf0e39da,0xbf54db31
.long 0xbe47c5c2,0x3f7b14be,0xbef15aea,0x3f61c598,0xbf0e39da,0xbf54db31,0xbe94a031,0xbf74fa0b
.long 0x3f800000,0x0,0x3f75b1c9,0x3e8fcefe,0xbf26423a,0x3f42a9f7,0xbf563e03,0x3f0c2124
.long 0x3f800000,0x0,0x3f743c41,0x3e996dba,0xbf42a9f7,0x3f26423a,0xbf6b8a3d,0x3ec8917e
.long 0x3f579b8c,0x3f0a04f8,0x3f28296a,0x3f4105b8,0xbf74fa0b,0x3e94a031,0xbf7ffcd7,0x3c20d8d2
.long 0x3f5205d4,0x3f1260b2,0x3f1c81b9,0x3f4a965e,0xbf7ec46d,0x3dc8bd36,0xbf7a9421,0xbe519f65
.long 0x3ed65a92,0x3f687c12,0x3e164083,0x3f7d3aac,0xbf766377,0xbe8afa3e,0xbf58f3c4,0xbf07e565
.long 0x3eb13641,0x3f702d4f,0x3d48fb30,0x3f7fb10f,0xbf5f5be6,0xbefa2c90,0xbf2f9c32,0xbf3a4582
.long 0xbe0c4cf7,0x3f7d95f4,0xbed1c759,0x3f698690,0xbf2a0c73,0xbf3f5cb5,0xbedae880,0xbf676bd8
.long 0xbe814693,0x3f77b493,0xbf07e565,0x3f58f3c4,0xbedf7108,0xbf6655e7,0xbe164083,0xbf7d3aac
.long 0x3f800000,0x0,0x3f737871,0x3e9e377a,0xbf4f1bbd,0x3f167918,0xbf737871,0x3e9e377a
.long 0x3f800000,0x0,0x3f71decf,0x3ea7bf25,0xbf641901,0x3ee87171,0xbf7d95f4,0x3e0c4cf7
.long 0x3f4f1bbd,0x3f167918,0x3f167918,0x3f4f1bbd,0xbf800000,0x250d3132,0xbf737871,0xbe9e377a
.long 0x3f490a88,0x3f1e7cf1,0x3f0a04f8,0x3f579b8c,0xbf7b14be,0xbe47c5c2,0xbf5cdc29,0xbf0172c3
.long 0x3e9e377a,0x3f737871,0x248d3132,0x3f800000,0xbf4f1bbd,0xbf167918,0xbf167918,0xbf4f1bbd
.long 0x3e6f0c4d,0x3f78ed3c,0xbdc8bd36,0x3f7ec46d,0xbf26423a,0xbf42a9f7,0xbeba9be1,0xbf6e641a
.long 0xbe9e377a,0x3f737871,0xbf167918,0x3f4f1bbd,0xbe9e377a,0xbf737871,0xa553c9ca,0xbf800000
.long 0xbed65a92,0x3f687c12,0xbf316e2c,0x3f3889dc,0xbd20cee7,0xbf7fcd79,0x3e94a031,0xbf74fa0b
.long 0x3f800000,0x0,0x3f72ae9e,0x3ea2fd52,0xbf5a46a0,0x3f05c277,0xbf79805c,0x3e6542e9
.long 0x3f800000,0x0,0x3f710908,0x3eac7cd4,0xbf6c835e,0x3ec3ef15,0xbf7fb10f,0x3d48fb30
.long 0x3f4c1d35,0x3f1a82a4,0x3f104f0e,0x3f53731f,0xbf7ec46d,0xbdc8bd36,0xbf698690,0xbed1c759
.long 0x3f45e403,0x3f226799,0x3f039c3d,0x3f5b941a,0xbf74fa0b,0xbe94a031,0xbf4d9f02,0xbf187fc0
.long 0x3e8afa3e,0x3f766377,0xbd48fb30,0x3f7fb10f,0xbf3bfc8f,0xbf2dc5e3,0xbef5c6c5,0xbf609384
.long 0x3e47c5c2,0x3f7b14be,0xbe164083,0x3f7d3aac,0xbf0e39da,0xbf54db31,0xbe78cfcc,0xbf7853f8
.long 0xbeba9be1,0x3f6e641a,0xbf2456f1,0x3f444969,0xbe3403f1,0xbf7c0361,0x3e164083,0xbf7d3aac
.long 0xbef15aea,0x3f61c598,0xbf3daef9,0x3f2beb4a,0x3dc8bd36,0xbf7ec46d,0x3edae880,0xbf676bd8
.long 0x3f800000,0x0,0x3f702d4f,0x3eb13641,0xbf737871,0x3e9e377a,0xbf7fcd79,0xbd20cee7
.long 0x3f800000,0x0,0x3f6e641a,0x3eba9be1,0xbf7cd925,0x3e20305b,0xbf7a0d54,0xbe5b73dc
.long 0x3f42a9f7,0x3f26423a,0x3efa2c90,0x3f5f5be6,0xbf6c835e,0xbec3ef15,0xbf3bfc8f,0xbf2dc5e3
.long 0x3f3bfc8f,0x3f2dc5e3,0x3edf7108,0x3f6655e7,0xbf54db31,0xbf0e39da,0xbf1260b2,0xbf5205d4
.long 0x3e20305b,0x3f7cd925,0xbe47c5c2,0x3f7b14be,0xbee87171,0xbf641901,0xbdf0b772,0xbf7e39bc
.long 0x3da0af2a,0x3f7f35f9,0xbe94a031,0x3f74fa0b,0xbe6f0c4d,0xbf78ed3c,0x3e0c4cf7,0xbf7d95f4
.long 0xbf05c277,0x3f5a46a0,0xbf490a88,0x3f1e7cf1,0x3e6f0c4d,0xbf78ed3c,0x3f0e39da,0xbf54db31
.long 0xbf1e7cf1,0x3f490a88,0xbf5cdc29,0x3f0172c3,0x3efa2c90,0xbf5f5be6,0x3f45e403,0xbf226799
.long 0x3f800000,0x0,0x3f6f4ba8,0x3eb5eb4f,0xbf78ed3c,0x3e6f0c4d,0xbf7deafa,0xbe0255f4
.long 0x3f800000,0x0,0x3f6d76aa,0x3ebf47d7,0xbf7f35f9,0x3da0af2a,0xbf743c41,0xbe996dba
.long 0x3f3f5cb5,0x3f2a0c73,0x3eece91a,0x3f62f219,0xbf61c598,0xbef15aea,0xbf28296a,0xbf4105b8
.long 0x3f3889dc,0x3f316e2c,0x3ed1c759,0x3f698690,0xbf45e403,0xbf226799,0xbef5c6c5,0xbf609384
.long 0x3df0b772,0x3f7e39bc,0xbe78cfcc,0x3f7853f8,0xbeb13641,0xbf702d4f,0x3c20d8d2,0xbf7ffcd7
.long 0x3d20cee7,0x3f7fcd79,0xbeac7cd4,0x3f710908,0xbdf0b772,0xbf7e39bc,0x3e862210,0xbf770f11
.long 0xbf1260b2,0x3f5205d4,0xbf53731f,0x3f104f0e,0x3eba9be1,0xbf6e641a,0x3f2beb4a,0xbf3daef9
.long 0xbf2a0c73,0x3f3f5cb5,0xbf653a48,0x3ee3f40d,0x3f1a82a4,0xbf4c1d35,0x3f5b941a,0xbf039c3d
code_end:
.section .rodata,"a"
.p2align 6
.amdhsa_kernel ka_kernel
  .amdhsa_next_free_vgpr 104
  .amdhsa_next_free_sgpr 102
  .amdhsa_accum_offset 104
  .amdhsa_group_segment_fixed_size 0
  .amdhsa_kernarg_size 88
  .amdhsa_user_sgpr_count 2
  .amdhsa_user_sgpr_kernarg_segment_ptr 1
  .amdhsa_system_sgpr_workgroup_id_x 1
.end_amdhsa_kernel
.p2align 6
.amdhsa_kernel kp_kernel
  .amdhsa_next_free_vgpr 512
  .amdhsa_next_free_sgpr 102
  .amdhsa_accum_offset 256
  .amdhsa_group_segment_fixed_size 0
  .amdhsa_kernarg_size 88
  .amdhsa_user_sgpr_count 2
  .amdhsa_user_sgpr_kernarg_segment_ptr 1
  .amdhsa_system_sgpr_workgroup_id_x 1
.end_amdhsa_kernel
```
